```python
import torch

def _softmax(x, axis=-1):
    return torch.softmax(x, dim=axis)
def _gelu(x):
    return torch.nn.functional.gelu(x, approximate="tanh")
def _silu(x):
    return torch.nn.functional.silu(x)
def _sigmoid(x):
    return torch.sigmoid(x)
def _layernorm(x, axis=-1, eps=1e-5):
    m = x.mean(dim=axis, keepdim=True)
    v = x.var(dim=axis, keepdim=True, unbiased=False)
    return (x - m) / torch.sqrt(v + eps)
def _scatter_add(tgt, idx, src, axis=0):
    return tgt.clone().index_add_(axis, idx, src)
def _segment_sum(src, seg, n):
    out = torch.zeros((n,) + src.shape[1:], dtype=src.dtype)
    return out.index_add_(0, seg, src)
def _pad(x, pw):
    flat = tuple(v for pair in reversed(pw) for v in pair)
    return torch.nn.functional.pad(x, flat)

kernel_name = 'concat_heads__mha_block_cached__mha_block_cached__near_ridge'

def setup_inputs():

    _w = (lambda a: (lambda t: t.to(torch.bfloat16) if t.is_floating_point() else t)(torch.as_tensor(a)))
    def _A_setup():
        B, Sq, D = 8, 128, 448
        H, Sk, Dh = 16, 512, 256
        return {
            "x": _w((lambda *s: torch.randn(*s, dtype=torch.bfloat16) * 0.8)(B, Sq, D)),
            "k_cache": _w((lambda *s: torch.randn(*s, dtype=torch.bfloat16) * 0.8)(B, H, Sk, Dh)),
            "v_cache": _w((lambda *s: torch.randn(*s, dtype=torch.bfloat16) * 0.05)(B, H, Sk, Dh)),
            "wq": _w((lambda *s: torch.randn(*s, dtype=torch.bfloat16) * 0.8)(D, H * Dh) * (D ** -0.5)),
            "wo": _w((lambda *s: torch.randn(*s, dtype=torch.bfloat16) * 0.05)(H * Dh, D) * ((H * Dh) ** -0.5)),
        }
    _A_in = _A_setup()

    def _B_setup():
        B, Sq, D = 8, 128, 448
        H, Sk, Dh = 16, 512, 256
        return {
            "x": _w((lambda *s: torch.randn(*s, dtype=torch.bfloat16) * 0.8)(B, Sq, D)),
            "k_cache": _w((lambda *s: torch.randn(*s, dtype=torch.bfloat16) * 0.8)(B, H, Sk, Dh)),
            "v_cache": _w((lambda *s: torch.randn(*s, dtype=torch.bfloat16) * 0.05)(B, H, Sk, Dh)),
            "wq": _w((lambda *s: torch.randn(*s, dtype=torch.bfloat16) * 0.8)(D, H * Dh) * (D ** -0.5)),
            "wo": _w((lambda *s: torch.randn(*s, dtype=torch.bfloat16) * 0.05)(H * Dh, D) * ((H * Dh) ** -0.5)),
        }
    _B_in = _B_setup()

    return {
        "A_x": _A_in["x"],
        "A_k_cache": _A_in["k_cache"],
        "A_v_cache": _A_in["v_cache"],
        "A_wq": _A_in["wq"],
        "A_wo": _A_in["wo"],
        "B_x": _B_in["x"],
        "B_k_cache": _B_in["k_cache"],
        "B_v_cache": _B_in["v_cache"],
        "B_wq": _B_in["wq"],
        "B_wo": _B_in["wo"],
    }

def reference(A_x, A_k_cache, A_v_cache, A_wq, A_wo, B_x, B_k_cache, B_v_cache, B_wq, B_wo):
    def _A_ref(x, k_cache, v_cache, wq, wo):
        B, Sq, D = x.shape
        H, Dh = 16, 256
        q = (lambda x, *d: x.permute(*d))((x @ wq).reshape(B, Sq, H, Dh), 0, 2, 1, 3)
        scores = torch.einsum("bhqd,bhkd->bhqk", q, k_cache) * (Dh ** -0.5)
        p = _softmax(scores, axis=-1)
        o = torch.einsum("bhqk,bhkd->bhqd", p, v_cache)
        return (lambda x, *d: x.permute(*d))(o, 0, 2, 1, 3).reshape(B, Sq, H * Dh) @ wo

    def _B_ref(x, k_cache, v_cache, wq, wo):
        B, Sq, D = x.shape
        H, Dh = 16, 256
        q = (lambda x, *d: x.permute(*d))((x @ wq).reshape(B, Sq, H, Dh), 0, 2, 1, 3)
        scores = torch.einsum("bhqd,bhkd->bhqk", q, k_cache) * (Dh ** -0.5)
        p = _softmax(scores, axis=-1)
        o = torch.einsum("bhqk,bhkd->bhqd", p, v_cache)
        return (lambda x, *d: x.permute(*d))(o, 0, 2, 1, 3).reshape(B, Sq, H * Dh) @ wo

    a = _A_ref(A_x, A_k_cache, A_v_cache, A_wq, A_wo)
    b = _B_ref(B_x, B_k_cache, B_v_cache, B_wq, B_wo)
    return torch.concatenate([a, b], axis=-1)
```

```asm
; @launch grid=(256,1,1) block=(256,1,1) lds=163840
.amdgcn_target "amdgcn-amd-amdhsa--gfx950"
.text
.globl concat_heads__mha_block_cached__mha_block_cached__near_ridge_kernel
.p2align 12
.p2align 8
.type concat_heads__mha_block_cached__mha_block_cached__near_ridge_kernel,@function
concat_heads__mha_block_cached__mha_block_cached__near_ridge_kernel:
s_cmp_ge_u32 s2, 256
s_cbranch_scc1 L_end
s_bfe_u32 s36, s2, 0x10002
s_mul_i32 s3, s36, 40
s_add_u32 s54, s0, s3
s_addc_u32 s55, s1, 0
s_load_dwordx8 s[72:79], s[54:55], 0
s_load_dwordx2 s[80:81], s[54:55], 32
s_load_dwordx2 s[82:83], s[0:1], 96
s_load_dwordx4 s[84:87], s[0:1], 80
v_lshrrev_b32 v48, 6, v0
v_and_b32 v62, 63, v0
v_readfirstlane_b32 s32, v48
s_and_b32 s35, s2, 3
s_bfe_u32 s34, s2, 0x30003
s_lshr_b32 s38, s2, 6
s_lshl2_add_u32 s35, s35, s38
s_xor_b32 s3, s38, s34
s_and_b32 s3, s3, 1
s_mul_i32 s3, s3, 4
s_lshl_b32 s40, s3, 7
s_lshl_b32 s41, s3, 19
s_lshl_b32 s33, s32, 12
v_lshrrev_b32 v49, 3, v62
v_lshl_add_u32 v49, v48, 5, v49
v_mul_u32_u24 v49, 896, v49
v_and_b32 v50, 7, v62
v_lshrrev_b32 v51, 4, v62
v_xor_b32 v51, v50, v51
v_lshl_add_u32 v37, v51, 4, v49
v_xor_b32 v38, 64, v37
v_add_u32 v38, 6144, v38
v_add_u32 v39, 12288, v37
v_add_u32 v40, 12288, v38
v_lshrrev_b32 v51, 5, v62
v_lshl_add_u32 v52, v48, 3, v51
v_and_b32 v53, 31, v62
v_lshlrev_b32 v54, 1, v51
v_xor_b32 v54, v53, v54
v_and_b32 v55, 8, v52
v_xor_b32 v55, v54, v55
v_lshlrev_b32 v55, 4, v55
v_lshl_add_u32 v33, v52, 13, v55
v_xor_b32 v34, 64, v33
v_add_u32 v34, 15360, v34
v_add_u32 v35, 30720, v33
v_add_u32 v36, 30720, v34
s_mul_i32 s3, s34, 114688
s_lshl_b32 s39, s35, 9
s_lshl3_add_u32 s37, s36, s34
s_lshl4_add_u32 s54, s37, s35
s_lshl_b32 s54, s54, 18
v_and_b32 v56, 1, v62
v_lshlrev_b32 v56, 12, v56
v_lshl_add_u32 v56, v62, 8, v56
v_mov_b32 v57, 0x7fff0000
v_cmp_gt_u32 vcc, 8, v62
s_nop 1
v_cndmask_b32 v56, v57, v56, vcc
s_and_b32 s70, s35, 1
s_lshl_b32 s70, s70, 13
s_add_u32 s70, s70, 229376
s_xor_b32 s71, s70, 8192
s_waitcnt lgkmcnt(0)
s_add_u32 s82, s82, 262143
s_addc_u32 s83, s83, 0
s_and_b32 s82, s82, 0xfffc0000
s_add_u32 s64, s82, s54
s_addc_u32 s65, s83, 0
s_mov_b32 s66, 262144
s_mov_b32 s67, 0x20000
s_cmp_lg_u32 s32, 2
s_barrier
s_cbranch_scc1 L_oth
buffer_load_dword a254, v56, s[64:67], s70 offen nt
buffer_load_dword a255, v56, s[64:67], s71 offen nt
s_waitcnt vmcnt(1)
s_memtime s[98:99]
s_waitcnt vmcnt(0)
s_memtime s[100:101]
s_add_u32 s4, s72, s3
s_addc_u32 s5, s73, 0
s_mov_b32 s6, 114688
s_mov_b32 s7, 0x20000
s_add_u32 s16, s78, s39
s_addc_u32 s17, s79, 0
s_mov_b32 s18, 3662336
s_mov_b32 s19, 0x20000
s_add_u32 m0, s33, 131072
s_add_u32 s40, s40, 128
s_cmp_eq_u32 s40, 896
s_cselect_b32 s40, 0, s40
s_add_u32 m0, s33, 147456
s_add_u32 s41, s41, 262144
s_add_u32 m0, s33, 114688
s_branch L_join
L_oth:
s_add_u32 s4, s72, s3
s_addc_u32 s5, s73, 0
s_mov_b32 s6, 114688
s_mov_b32 s7, 0x20000
s_add_u32 s16, s78, s39
s_addc_u32 s17, s79, 0
s_mov_b32 s18, 3662336
s_mov_b32 s19, 0x20000
s_cmp_lg_u32 s32, 0
s_cbranch_scc1 L_own
s_add_u32 s70, s40, 57344
s_add_u32 s71, s41, 131072
s_mov_b32 m0, 139264
s_nop 0
buffer_load_dwordx4 v37, s[4:7], s70 offen lds
buffer_load_dwordx4 v38, s[4:7], s70 offen offset:1024 lds
buffer_load_dwordx4 v39, s[4:7], s70 offen offset:2048 lds
buffer_load_dwordx4 v40, s[4:7], s70 offen offset:3072 lds
s_mov_b32 m0, 155648
s_nop 0
buffer_load_dwordx4 v33, s[16:19], s71 offen lds
buffer_load_dwordx4 v34, s[16:19], s71 offen offset:1024 lds
buffer_load_dwordx4 v35, s[16:19], s71 offen offset:2048 lds
buffer_load_dwordx4 v36, s[16:19], s71 offen offset:3072 lds
s_add_u32 s71, s71, 262144
s_mov_b32 m0, 122880
s_nop 0
buffer_load_dwordx4 v33, s[16:19], s71 offen lds
buffer_load_dwordx4 v34, s[16:19], s71 offen offset:1024 lds
L_own:
s_add_u32 m0, s33, 131072
s_nop 0
buffer_load_dwordx4 v37, s[4:7], s40 offen lds
buffer_load_dwordx4 v38, s[4:7], s40 offen offset:1024 lds
buffer_load_dwordx4 v39, s[4:7], s40 offen offset:2048 lds
buffer_load_dwordx4 v40, s[4:7], s40 offen offset:3072 lds
s_add_u32 s40, s40, 128
s_cmp_eq_u32 s40, 896
s_cselect_b32 s40, 0, s40
s_add_u32 m0, s33, 147456
s_nop 0
buffer_load_dwordx4 v33, s[16:19], s41 offen lds
buffer_load_dwordx4 v34, s[16:19], s41 offen offset:1024 lds
buffer_load_dwordx4 v35, s[16:19], s41 offen offset:2048 lds
buffer_load_dwordx4 v36, s[16:19], s41 offen offset:3072 lds
s_add_u32 s41, s41, 262144
s_add_u32 m0, s33, 114688
s_nop 0
buffer_load_dwordx4 v33, s[16:19], s41 offen lds
buffer_load_dwordx4 v34, s[16:19], s41 offen offset:1024 lds
L_join:
v_lshlrev_b32 v54, 4, v54
v_lshl_add_u32 v29, v52, 9, v54
v_xor_b32 v30, 64, v29
v_xor_b32 v31, 128, v29
v_xor_b32 v32, 192, v29
v_and_b32 v54, 15, v52
v_xor_b32 v54, v53, v54
v_lshlrev_b32 v54, 4, v54
v_lshl_add_u32 v25, v52, 9, v54
v_xor_b32 v26, 32, v25
v_xor_b32 v27, 64, v25
v_xor_b32 v28, 96, v25
v_lshrrev_b32 v54, 3, v62
v_and_b32 v54, 6, v54
v_xor_b32 v54, v50, v54
v_lshl_add_u32 v41, v54, 4, v49
v_add_u32 v42, 6144, v41
v_add_u32 v43, 12288, v41
v_add_u32 v44, 18432, v41
s_mov_b32 s3, 0
s_lshl_b32 s42, s3, 14
s_mov_b32 s43, s42
s_lshl4_add_u32 s3, s34, s35
s_lshl_b32 s3, s3, 18
s_add_u32 s8, s74, s3
s_addc_u32 s9, s75, 0
s_mov_b32 s10, 262144
s_mov_b32 s11, 0x20000
s_add_u32 s12, s76, s3
s_addc_u32 s13, s77, 0
s_mov_b32 s14, 262144
s_mov_b32 s15, 0x20000
s_getpc_b64 s[28:29]
L_pc:
s_mov_b32 s30, L_rare1-L_pc
s_mov_b32 s31, 0x20000
s_lshr_b32 s3, s2, 3
s_lshl2_add_u32 s3, s3, s32
s_lshl_b32 s3, s3, 9
v_lshlrev_b32 v56, 7, v62
v_add_u32 v56, s3, v56
v_mov_b32 v57, 0x7fff0000
v_cmp_gt_u32 vcc, 4, v62
s_nop 1
v_cndmask_b32 v56, v57, v56, vcc
buffer_load_dword v57, v56, s[28:31], 0 offen sc1
v_and_b32 v53, 15, v62
v_lshrrev_b32 v51, 4, v62
v_lshlrev_b32 v49, 7, v53
v_lshl_add_u32 v49, v48, 12, v49
v_bfe_u32 v50, v62, 1, 3
v_xor_b32 v50, v50, v51
v_lshl_add_u32 v72, v50, 4, v49
v_xor_b32 v73, 64, v72
v_bfe_u32 v50, v62, 2, 3
v_and_b32 v52, 3, v62
v_lshlrev_b32 v52, 3, v52
v_lshl_add_u32 v49, v50, 5, v52
v_bfe_u32 v54, v62, 2, 2
v_lshl_add_u32 v54, v51, 3, v54
v_lshl_add_u32 v64, v54, 9, v49
v_add_u32 v84, 131072, v64
v_add_u32 v92, 131072, v72
v_add_u32 v93, 131072, v73
v_xor_b32 v85, 32, v84
v_xor_b32 v86, 64, v84
v_xor_b32 v87, 96, v84
v_xor_b32 v88, 128, v84
v_xor_b32 v89, 160, v84
v_xor_b32 v90, 192, v84
v_xor_b32 v91, 224, v84
v_add_u32 v74, 65536, v64
v_add_u32 v82, 65536, v72
v_add_u32 v83, 65536, v73
v_xor_b32 v75, 32, v74
v_xor_b32 v76, 64, v74
v_xor_b32 v77, 96, v74
v_xor_b32 v78, 128, v74
v_xor_b32 v79, 160, v74
v_xor_b32 v80, 192, v74
v_xor_b32 v81, 224, v74
v_xor_b32 v65, 32, v64
v_xor_b32 v66, 64, v64
v_xor_b32 v67, 96, v64
v_xor_b32 v68, 128, v64
v_xor_b32 v69, 160, v64
v_xor_b32 v70, 192, v64
v_xor_b32 v71, 224, v64
s_waitcnt lgkmcnt(0)
s_sub_u32 s100, s100, s98
buffer_load_dwordx4 v35, s[16:19], s41 offen offset:2048 lds
buffer_load_dwordx4 v36, s[16:19], s41 offen offset:3072 lds
s_add_u32 s41, s41, 262144
s_cmp_eq_u32 s41, 3670016
s_cselect_b32 s41, 0, s41
s_add_u32 m0, s33, 49152
s_nop 0
buffer_load_dwordx4 v37, s[4:7], s40 offen lds
buffer_load_dwordx4 v38, s[4:7], s40 offen offset:1024 lds
buffer_load_dwordx4 v39, s[4:7], s40 offen offset:2048 lds
buffer_load_dwordx4 v40, s[4:7], s40 offen offset:3072 lds
s_add_u32 s40, s40, 128
s_cmp_eq_u32 s40, 896
s_cselect_b32 s40, 0, s40
s_add_u32 m0, s33, 98304
s_nop 0
buffer_load_dwordx4 v33, s[16:19], s41 offen lds
buffer_load_dwordx4 v34, s[16:19], s41 offen offset:1024 lds
buffer_load_dwordx4 v35, s[16:19], s41 offen offset:2048 lds
buffer_load_dwordx4 v36, s[16:19], s41 offen offset:3072 lds
s_add_u32 s41, s41, 262144
s_add_u32 m0, s33, 0
s_nop 0
buffer_load_dwordx4 v25, s[8:11], s42 offen nt lds
buffer_load_dwordx4 v26, s[8:11], s42 offen offset:1024 nt lds
buffer_load_dwordx4 v27, s[8:11], s42 offen offset:2048 nt lds
buffer_load_dwordx4 v28, s[8:11], s42 offen offset:3072 nt lds
s_add_u32 s42, s42, 16384
s_and_b32 s42, s42, 0x3ffff
s_waitcnt vmcnt(17) lgkmcnt(0)
s_barrier
ds_read_b128 v[112:115], v92 offset:0
ds_read_b128 v[116:119], v92 offset:2048
ds_read_b128 v[120:123], v93 offset:0
ds_read_b128 v[124:127], v93 offset:2048
ds_read_b64_tr_b16 a[0:1], v84 offset:16384
ds_read_b64_tr_b16 a[2:3], v84 offset:18432
ds_read_b64_tr_b16 a[4:5], v85 offset:16384
ds_read_b64_tr_b16 a[6:7], v85 offset:18432
ds_read_b64_tr_b16 a[8:9], v86 offset:16384
ds_read_b64_tr_b16 a[10:11], v86 offset:18432
ds_read_b64_tr_b16 a[12:13], v87 offset:16384
ds_read_b64_tr_b16 a[14:15], v87 offset:18432
ds_read_b64_tr_b16 a[16:17], v88 offset:16384
ds_read_b64_tr_b16 a[18:19], v88 offset:18432
ds_read_b64_tr_b16 a[20:21], v89 offset:16384
ds_read_b64_tr_b16 a[22:23], v89 offset:18432
ds_read_b64_tr_b16 a[24:25], v90 offset:16384
ds_read_b64_tr_b16 a[26:27], v90 offset:18432
ds_read_b64_tr_b16 a[28:29], v91 offset:16384
ds_read_b64_tr_b16 a[30:31], v91 offset:18432
ds_read_b64_tr_b16 a[32:33], v84 offset:16640
ds_read_b64_tr_b16 a[34:35], v84 offset:18688
ds_read_b64_tr_b16 a[36:37], v85 offset:16640
ds_read_b64_tr_b16 a[38:39], v85 offset:18688
ds_read_b64_tr_b16 a[40:41], v86 offset:16640
ds_read_b64_tr_b16 a[42:43], v86 offset:18688
ds_read_b64_tr_b16 a[44:45], v87 offset:16640
ds_read_b64_tr_b16 a[46:47], v87 offset:18688
ds_read_b64_tr_b16 a[48:49], v88 offset:16640
ds_read_b64_tr_b16 a[50:51], v88 offset:18688
ds_read_b64_tr_b16 a[52:53], v89 offset:16640
ds_read_b64_tr_b16 a[54:55], v89 offset:18688
ds_read_b64_tr_b16 a[56:57], v90 offset:16640
ds_read_b64_tr_b16 a[58:59], v90 offset:18688
ds_read_b64_tr_b16 a[60:61], v91 offset:16640
ds_read_b64_tr_b16 a[62:63], v91 offset:18688
s_waitcnt vmcnt(12) lgkmcnt(0)
s_barrier
v_mfma_f32_16x16x32_bf16 v[128:131], a[0:3], v[112:115], 0
ds_read_b64_tr_b16 a[64:65], v74 offset:49152
ds_read_b64_tr_b16 a[66:67], v74 offset:51200
v_mfma_f32_16x16x32_bf16 v[132:135], a[0:3], v[116:119], 0
ds_read_b64_tr_b16 a[68:69], v75 offset:49152
s_add_u32 m0, s33, 131072
v_mfma_f32_16x16x32_bf16 v[140:143], a[4:7], v[116:119], 0
ds_read_b64_tr_b16 a[70:71], v75 offset:51200
buffer_load_dwordx4 v33, s[16:19], s41 offen lds
v_mfma_f32_16x16x32_bf16 v[136:139], a[4:7], v[112:115], 0
ds_read_b64_tr_b16 a[72:73], v76 offset:49152
ds_read_b64_tr_b16 a[74:75], v76 offset:51200
v_mfma_f32_16x16x32_bf16 v[144:147], a[8:11], v[112:115], 0
ds_read_b64_tr_b16 a[76:77], v77 offset:49152
buffer_load_dwordx4 v34, s[16:19], s41 offen offset:1024 lds
v_mfma_f32_16x16x32_bf16 v[148:151], a[8:11], v[116:119], 0
ds_read_b64_tr_b16 a[78:79], v77 offset:51200
v_lshrrev_b32 v55, 2, v62
v_mfma_f32_16x16x32_bf16 v[156:159], a[12:15], v[116:119], 0
ds_read_b64_tr_b16 a[80:81], v78 offset:49152
ds_read_b64_tr_b16 a[82:83], v78 offset:51200
v_mfma_f32_16x16x32_bf16 v[152:155], a[12:15], v[112:115], 0
ds_read_b64_tr_b16 a[84:85], v79 offset:49152
buffer_load_dwordx4 v35, s[16:19], s41 offen offset:2048 lds
v_mfma_f32_16x16x32_bf16 v[160:163], a[16:19], v[112:115], 0
ds_read_b64_tr_b16 a[86:87], v79 offset:51200
v_lshl_add_u32 v5, v55, 9, v49
v_mfma_f32_16x16x32_bf16 v[164:167], a[16:19], v[116:119], 0
ds_read_b64_tr_b16 a[88:89], v80 offset:49152
ds_read_b64_tr_b16 a[90:91], v80 offset:51200
v_mfma_f32_16x16x32_bf16 v[172:175], a[20:23], v[116:119], 0
ds_read_b64_tr_b16 a[92:93], v81 offset:49152
buffer_load_dwordx4 v36, s[16:19], s41 offen offset:3072 lds
v_mfma_f32_16x16x32_bf16 v[168:171], a[20:23], v[112:115], 0
ds_read_b64_tr_b16 a[94:95], v81 offset:51200
s_add_u32 s41, s41, 262144
v_mfma_f32_16x16x32_bf16 v[176:179], a[24:27], v[112:115], 0
ds_read_b64_tr_b16 a[96:97], v74 offset:49408
ds_read_b64_tr_b16 a[98:99], v74 offset:51456
s_cmp_eq_u32 s41, 3670016
s_cselect_b32 s41, 0, s41
v_mfma_f32_16x16x32_bf16 v[180:183], a[24:27], v[116:119], 0
ds_read_b64_tr_b16 a[100:101], v75 offset:49408
s_add_u32 m0, s33, 147456
v_mfma_f32_16x16x32_bf16 v[188:191], a[28:31], v[116:119], 0
ds_read_b64_tr_b16 a[102:103], v75 offset:51456
buffer_load_dwordx4 v37, s[4:7], s40 offen lds
v_mfma_f32_16x16x32_bf16 v[184:187], a[28:31], v[112:115], 0
ds_read_b64_tr_b16 a[104:105], v76 offset:49408
ds_read_b64_tr_b16 a[106:107], v76 offset:51456
v_mfma_f32_16x16x32_bf16 v[192:195], a[32:35], v[112:115], 0
ds_read_b64_tr_b16 a[108:109], v77 offset:49408
buffer_load_dwordx4 v38, s[4:7], s40 offen offset:1024 lds
v_mfma_f32_16x16x32_bf16 v[196:199], a[32:35], v[116:119], 0
ds_read_b64_tr_b16 a[110:111], v77 offset:51456
s_add_u32 m0, s33, 16384
v_mfma_f32_16x16x32_bf16 v[204:207], a[36:39], v[116:119], 0
ds_read_b64_tr_b16 a[112:113], v78 offset:49408
ds_read_b64_tr_b16 a[114:115], v78 offset:51456
v_mfma_f32_16x16x32_bf16 v[200:203], a[36:39], v[112:115], 0
ds_read_b64_tr_b16 a[116:117], v79 offset:49408
buffer_load_dwordx4 v25, s[8:11], s42 offen nt lds
v_mfma_f32_16x16x32_bf16 v[208:211], a[40:43], v[112:115], 0
ds_read_b64_tr_b16 a[118:119], v79 offset:51456
buffer_load_dwordx4 v26, s[8:11], s42 offen offset:1024 nt lds
v_mfma_f32_16x16x32_bf16 v[212:215], a[40:43], v[116:119], 0
ds_read_b64_tr_b16 a[120:121], v80 offset:49408
ds_read_b64_tr_b16 a[122:123], v80 offset:51456
v_mfma_f32_16x16x32_bf16 v[220:223], a[44:47], v[116:119], 0
ds_read_b64_tr_b16 a[124:125], v81 offset:49408
v_add_u32 v5, 65536, v5
v_mfma_f32_16x16x32_bf16 v[216:219], a[44:47], v[112:115], 0
ds_read_b64_tr_b16 a[126:127], v81 offset:51456
v_xor_b32 v6, 32, v5
v_mfma_f32_16x16x32_bf16 v[224:227], a[48:51], v[112:115], 0
buffer_load_dwordx4 v27, s[8:11], s42 offen offset:2048 nt lds
v_xor_b32 v7, 64, v5
v_mfma_f32_16x16x32_bf16 v[228:231], a[48:51], v[116:119], 0
v_xor_b32 v8, 96, v5
v_xor_b32 v9, 128, v5
v_mfma_f32_16x16x32_bf16 v[236:239], a[52:55], v[116:119], 0
buffer_load_dwordx4 v28, s[8:11], s42 offen offset:3072 nt lds
s_add_u32 s42, s42, 16384
v_mfma_f32_16x16x32_bf16 v[232:235], a[52:55], v[112:115], 0
s_and_b32 s42, s42, 0x3ffff
v_xor_b32 v10, 160, v5
v_xor_b32 v11, 192, v5
v_mfma_f32_16x16x32_bf16 v[240:243], a[56:59], v[112:115], 0
v_xor_b32 v12, 224, v5
v_lshrrev_b32 v50, 1, v50
v_mfma_f32_16x16x32_bf16 v[244:247], a[56:59], v[116:119], 0
v_lshl_add_u32 v54, v50, 5, v52
v_lshl_add_u32 v13, v55, 7, v54
v_mfma_f32_16x16x32_bf16 v[252:255], a[60:63], v[116:119], 0
v_xor_b32 v14, 32, v13
v_xor_b32 v15, 64, v13
v_mfma_f32_16x16x32_bf16 v[248:251], a[60:63], v[112:115], 0
v_xor_b32 v16, 96, v13
s_mov_b64 exec, 0
s_cmp_eq_u32 s32, 0
s_cbranch_scc1 L_pad1
s_cmp_eq_u32 s32, 1
s_cbranch_scc1 L_pad2
s_cmp_eq_u32 s32, 2
s_cbranch_scc1 L_pad3
s_branch L_pad4
L_hr0:
s_mov_b64 exec, -1
s_waitcnt vmcnt(14) lgkmcnt(0)
s_barrier
v_mfma_f32_16x16x32_bf16 v[128:131], a[64:67], v[120:123], v[128:131]
ds_read_b128 v[96:99], v72 offset:49152
ds_read_b128 v[100:103], v72 offset:51200
v_mfma_f32_16x16x32_bf16 v[132:135], a[64:67], v[124:127], v[132:135]
ds_read_b128 v[104:107], v73 offset:49152
s_add_u32 m0, s33, 147456
v_mfma_f32_16x16x32_bf16 v[140:143], a[68:71], v[124:127], v[140:143]
ds_read_b128 v[108:111], v73 offset:51200
ds_read_b64_tr_b16 a[0:1], v74 offset:32768
v_mfma_f32_16x16x32_bf16 v[136:139], a[68:71], v[120:123], v[136:139]
ds_read_b64_tr_b16 a[2:3], v74 offset:34816
buffer_load_dwordx4 v39, s[4:7], s40 offen offset:2048 lds
v_mfma_f32_16x16x32_bf16 v[144:147], a[72:75], v[120:123], v[144:147]
ds_read_b64_tr_b16 a[4:5], v75 offset:32768
ds_read_b64_tr_b16 a[6:7], v75 offset:34816
v_mfma_f32_16x16x32_bf16 v[148:151], a[72:75], v[124:127], v[148:151]
ds_read_b64_tr_b16 a[8:9], v76 offset:32768
buffer_load_dwordx4 v40, s[4:7], s40 offen offset:3072 lds
v_mfma_f32_16x16x32_bf16 v[156:159], a[76:79], v[124:127], v[156:159]
ds_read_b64_tr_b16 a[10:11], v76 offset:34816
ds_read_b64_tr_b16 a[12:13], v77 offset:32768
s_add_u32 s40, s40, 128
v_mfma_f32_16x16x32_bf16 v[152:155], a[76:79], v[120:123], v[152:155]
ds_read_b64_tr_b16 a[14:15], v77 offset:34816
s_cmp_eq_u32 s40, 896
s_cselect_b32 s40, 0, s40
v_mfma_f32_16x16x32_bf16 v[160:163], a[80:83], v[120:123], v[160:163]
ds_read_b64_tr_b16 a[16:17], v78 offset:32768
ds_read_b64_tr_b16 a[18:19], v78 offset:34816
s_add_u32 m0, s33, 114688
v_mfma_f32_16x16x32_bf16 v[164:167], a[80:83], v[124:127], v[164:167]
ds_read_b64_tr_b16 a[20:21], v79 offset:32768
buffer_load_dwordx4 v33, s[16:19], s41 offen lds
v_mfma_f32_16x16x32_bf16 v[172:175], a[84:87], v[124:127], v[172:175]
ds_read_b64_tr_b16 a[22:23], v79 offset:34816
ds_read_b64_tr_b16 a[24:25], v80 offset:32768
v_mfma_f32_16x16x32_bf16 v[168:171], a[84:87], v[120:123], v[168:171]
ds_read_b64_tr_b16 a[26:27], v80 offset:34816
buffer_load_dwordx4 v34, s[16:19], s41 offen offset:1024 lds
v_mfma_f32_16x16x32_bf16 v[176:179], a[88:91], v[120:123], v[176:179]
ds_read_b64_tr_b16 a[28:29], v81 offset:32768
ds_read_b64_tr_b16 a[30:31], v81 offset:34816
v_mfma_f32_16x16x32_bf16 v[180:183], a[88:91], v[124:127], v[180:183]
ds_read_b64_tr_b16 a[32:33], v74 offset:33024
buffer_load_dwordx4 v35, s[16:19], s41 offen offset:2048 lds
v_mfma_f32_16x16x32_bf16 v[188:191], a[92:95], v[124:127], v[188:191]
ds_read_b64_tr_b16 a[34:35], v74 offset:35072
ds_read_b64_tr_b16 a[36:37], v75 offset:33024
v_mfma_f32_16x16x32_bf16 v[184:187], a[92:95], v[120:123], v[184:187]
ds_read_b64_tr_b16 a[38:39], v75 offset:35072
buffer_load_dwordx4 v36, s[16:19], s41 offen offset:3072 lds
v_mfma_f32_16x16x32_bf16 v[192:195], a[96:99], v[120:123], v[192:195]
ds_read_b64_tr_b16 a[40:41], v76 offset:33024
ds_read_b64_tr_b16 a[42:43], v76 offset:35072
v_mfma_f32_16x16x32_bf16 v[196:199], a[96:99], v[124:127], v[196:199]
ds_read_b64_tr_b16 a[44:45], v77 offset:33024
s_add_u32 s41, s41, 262144
v_mfma_f32_16x16x32_bf16 v[204:207], a[100:103], v[124:127], v[204:207]
ds_read_b64_tr_b16 a[46:47], v77 offset:35072
ds_read_b64_tr_b16 a[48:49], v78 offset:33024
v_mfma_f32_16x16x32_bf16 v[200:203], a[100:103], v[120:123], v[200:203]
ds_read_b64_tr_b16 a[50:51], v78 offset:35072
s_add_u32 m0, s33, 65536
v_mfma_f32_16x16x32_bf16 v[208:211], a[104:107], v[120:123], v[208:211]
ds_read_b64_tr_b16 a[52:53], v79 offset:33024
ds_read_b64_tr_b16 a[54:55], v79 offset:35072
buffer_load_dwordx4 v29, s[12:15], s43 offen nt lds
v_mfma_f32_16x16x32_bf16 v[212:215], a[104:107], v[124:127], v[212:215]
ds_read_b64_tr_b16 a[56:57], v80 offset:33024
v_add_u32 v17, 65536, v13
v_mfma_f32_16x16x32_bf16 v[220:223], a[108:111], v[124:127], v[220:223]
ds_read_b64_tr_b16 a[58:59], v80 offset:35072
ds_read_b64_tr_b16 a[60:61], v81 offset:33024
v_mfma_f32_16x16x32_bf16 v[216:219], a[108:111], v[120:123], v[216:219]
L_pad1:
s_cbranch_execz L_hr0
ds_read_b64_tr_b16 a[62:63], v81 offset:35072
buffer_load_dwordx4 v30, s[12:15], s43 offen offset:1024 nt lds
v_mfma_f32_16x16x32_bf16 v[224:227], a[112:115], v[120:123], v[224:227]
buffer_load_dwordx4 v31, s[12:15], s43 offen offset:2048 nt lds
v_xor_b32 v18, 32, v17
v_mfma_f32_16x16x32_bf16 v[228:231], a[112:115], v[124:127], v[228:231]
v_xor_b32 v19, 64, v17
v_xor_b32 v20, 96, v17
v_mfma_f32_16x16x32_bf16 v[236:239], a[116:119], v[124:127], v[236:239]
buffer_load_dwordx4 v32, s[12:15], s43 offen offset:3072 nt lds
s_add_u32 s43, s43, 16384
v_mfma_f32_16x16x32_bf16 v[232:235], a[116:119], v[120:123], v[232:235]
s_and_b32 s43, s43, 0x3ffff
v_add_u32 v21, 131072, v13
v_xor_b32 v22, 32, v21
v_mfma_f32_16x16x32_bf16 v[240:243], a[120:123], v[120:123], v[240:243]
v_xor_b32 v23, 64, v21
v_xor_b32 v24, 96, v21
v_mfma_f32_16x16x32_bf16 v[244:247], a[120:123], v[124:127], v[244:247]
v_bfe_u32 v54, v62, 4, 1
v_lshrrev_b32 v55, 5, v62
v_mfma_f32_16x16x32_bf16 v[252:255], a[124:127], v[124:127], v[252:255]
v_lshl_add_u32 v54, v54, 1, v55
v_xor_b32 v54, v54, v53
v_mfma_f32_16x16x32_bf16 v[248:251], a[124:127], v[120:123], v[248:251]
v_lshlrev_b32 v54, 4, v54
s_mov_b64 exec, 0
s_cmp_eq_u32 s32, 0
s_cbranch_scc1 L_pad5
s_cmp_eq_u32 s32, 1
s_cbranch_scc1 L_pad6
s_cmp_eq_u32 s32, 2
s_cbranch_scc1 L_pad7
s_branch L_pad8
L_hr1:
s_mov_b64 exec, -1
s_waitcnt vmcnt(16) lgkmcnt(0)
s_barrier
v_mfma_f32_16x16x32_bf16 v[128:131], a[0:3], v[96:99], v[128:131]
ds_read_b64_tr_b16 a[64:65], v84 offset:0
ds_read_b64_tr_b16 a[66:67], v84 offset:2048
v_mfma_f32_16x16x32_bf16 v[132:135], a[0:3], v[100:103], v[132:135]
ds_read_b64_tr_b16 a[68:69], v85 offset:0
s_add_u32 m0, s33, 49152
v_mfma_f32_16x16x32_bf16 v[140:143], a[4:7], v[100:103], v[140:143]
ds_read_b64_tr_b16 a[70:71], v85 offset:2048
buffer_load_dwordx4 v33, s[16:19], s41 offen lds
v_mfma_f32_16x16x32_bf16 v[136:139], a[4:7], v[96:99], v[136:139]
ds_read_b64_tr_b16 a[72:73], v86 offset:0
ds_read_b64_tr_b16 a[74:75], v86 offset:2048
v_mfma_f32_16x16x32_bf16 v[144:147], a[8:11], v[96:99], v[144:147]
ds_read_b64_tr_b16 a[76:77], v87 offset:0
buffer_load_dwordx4 v34, s[16:19], s41 offen offset:1024 lds
v_mfma_f32_16x16x32_bf16 v[148:151], a[8:11], v[100:103], v[148:151]
ds_read_b64_tr_b16 a[78:79], v87 offset:2048
v_lshl_add_u32 v1, v53, 9, v54
v_mfma_f32_16x16x32_bf16 v[156:159], a[12:15], v[100:103], v[156:159]
ds_read_b64_tr_b16 a[80:81], v88 offset:0
ds_read_b64_tr_b16 a[82:83], v88 offset:2048
v_mfma_f32_16x16x32_bf16 v[152:155], a[12:15], v[96:99], v[152:155]
ds_read_b64_tr_b16 a[84:85], v89 offset:0
buffer_load_dwordx4 v35, s[16:19], s41 offen offset:2048 lds
v_mfma_f32_16x16x32_bf16 v[160:163], a[16:19], v[96:99], v[160:163]
ds_read_b64_tr_b16 a[86:87], v89 offset:2048
v_xor_b32 v2, 64, v1
v_mfma_f32_16x16x32_bf16 v[164:167], a[16:19], v[100:103], v[164:167]
ds_read_b64_tr_b16 a[88:89], v90 offset:0
ds_read_b64_tr_b16 a[90:91], v90 offset:2048
v_mfma_f32_16x16x32_bf16 v[172:175], a[20:23], v[100:103], v[172:175]
ds_read_b64_tr_b16 a[92:93], v91 offset:0
buffer_load_dwordx4 v36, s[16:19], s41 offen offset:3072 lds
v_mfma_f32_16x16x32_bf16 v[168:171], a[20:23], v[96:99], v[168:171]
ds_read_b64_tr_b16 a[94:95], v91 offset:2048
s_add_u32 s41, s41, 262144
v_mfma_f32_16x16x32_bf16 v[176:179], a[24:27], v[96:99], v[176:179]
ds_read_b64_tr_b16 a[96:97], v84 offset:256
ds_read_b64_tr_b16 a[98:99], v84 offset:2304
s_cmp_eq_u32 s41, 3670016
s_cselect_b32 s41, 0, s41
v_mfma_f32_16x16x32_bf16 v[180:183], a[24:27], v[100:103], v[180:183]
ds_read_b64_tr_b16 a[100:101], v85 offset:256
s_add_u32 m0, s33, 98304
v_mfma_f32_16x16x32_bf16 v[188:191], a[28:31], v[100:103], v[188:191]
ds_read_b64_tr_b16 a[102:103], v85 offset:2304
buffer_load_dwordx4 v37, s[4:7], s40 offen lds
v_mfma_f32_16x16x32_bf16 v[184:187], a[28:31], v[96:99], v[184:187]
ds_read_b64_tr_b16 a[104:105], v86 offset:256
ds_read_b64_tr_b16 a[106:107], v86 offset:2304
v_mfma_f32_16x16x32_bf16 v[192:195], a[32:35], v[96:99], v[192:195]
ds_read_b64_tr_b16 a[108:109], v87 offset:256
buffer_load_dwordx4 v38, s[4:7], s40 offen offset:1024 lds
v_mfma_f32_16x16x32_bf16 v[196:199], a[32:35], v[100:103], v[196:199]
ds_read_b64_tr_b16 a[110:111], v87 offset:2304
s_add_u32 m0, s33, 32768
v_mfma_f32_16x16x32_bf16 v[204:207], a[36:39], v[100:103], v[204:207]
ds_read_b64_tr_b16 a[112:113], v88 offset:256
ds_read_b64_tr_b16 a[114:115], v88 offset:2304
v_mfma_f32_16x16x32_bf16 v[200:203], a[36:39], v[96:99], v[200:203]
ds_read_b64_tr_b16 a[116:117], v89 offset:256
buffer_load_dwordx4 v25, s[8:11], s42 offen nt lds
v_mfma_f32_16x16x32_bf16 v[208:211], a[40:43], v[96:99], v[208:211]
ds_read_b64_tr_b16 a[118:119], v89 offset:2304
buffer_load_dwordx4 v26, s[8:11], s42 offen offset:1024 nt lds
v_mfma_f32_16x16x32_bf16 v[212:215], a[40:43], v[100:103], v[212:215]
ds_read_b64_tr_b16 a[120:121], v90 offset:256
ds_read_b64_tr_b16 a[122:123], v90 offset:2304
v_mfma_f32_16x16x32_bf16 v[220:223], a[44:47], v[100:103], v[220:223]
ds_read_b64_tr_b16 a[124:125], v91 offset:256
v_xor_b32 v3, 128, v1
v_mfma_f32_16x16x32_bf16 v[216:219], a[44:47], v[96:99], v[216:219]
ds_read_b64_tr_b16 a[126:127], v91 offset:2304
v_xor_b32 v4, 192, v1
v_mfma_f32_16x16x32_bf16 v[224:227], a[48:51], v[96:99], v[224:227]
buffer_load_dwordx4 v27, s[8:11], s42 offen offset:2048 nt lds
v_lshrrev_b32 v54, 3, v53
v_mfma_f32_16x16x32_bf16 v[228:231], a[48:51], v[100:103], v[228:231]
v_lshl_add_u32 v54, v48, 2, v54
v_xor_b32 v55, s35, v54
v_mfma_f32_16x16x32_bf16 v[236:239], a[52:55], v[100:103], v[236:239]
buffer_load_dwordx4 v28, s[8:11], s42 offen offset:3072 nt lds
s_add_u32 s42, s42, 16384
v_mfma_f32_16x16x32_bf16 v[232:235], a[52:55], v[96:99], v[232:235]
s_and_b32 s42, s42, 0x3ffff
v_lshlrev_b32 v54, 18, v54
v_lshl_add_u32 v54, v55, 8, v54
v_mfma_f32_16x16x32_bf16 v[240:243], a[56:59], v[96:99], v[240:243]
v_lshrrev_b32 v55, 5, v62
v_lshl_add_u32 v54, v55, 12, v54
v_mfma_f32_16x16x32_bf16 v[244:247], a[56:59], v[100:103], v[244:247]
v_bfe_u32 v55, v62, 4, 1
v_lshl_add_u32 v54, v55, 7, v54
v_mfma_f32_16x16x32_bf16 v[252:255], a[60:63], v[100:103], v[252:255]
v_and_b32 v55, 7, v62
v_lshl_add_u32 v45, v55, 4, v54
v_mfma_f32_16x16x32_bf16 v[248:251], a[60:63], v[96:99], v[248:251]
v_xor_b32 v46, 524800, v45
s_mov_b64 exec, 0
s_cmp_eq_u32 s32, 0
s_cbranch_scc1 L_pad9
s_cmp_eq_u32 s32, 1
s_cbranch_scc1 L_pad10
s_cmp_eq_u32 s32, 2
s_cbranch_scc1 L_pad11
L_hr2:
s_mov_b64 exec, -1
s_waitcnt vmcnt(14) lgkmcnt(0)
s_barrier
v_mfma_f32_16x16x32_bf16 v[128:131], a[64:67], v[104:107], v[128:131]
ds_read_b128 v[112:115], v92 offset:16384
ds_read_b128 v[116:119], v92 offset:18432
v_mfma_f32_16x16x32_bf16 v[132:135], a[64:67], v[108:111], v[132:135]
ds_read_b128 v[120:123], v93 offset:16384
s_add_u32 m0, s33, 98304
v_mfma_f32_16x16x32_bf16 v[140:143], a[68:71], v[108:111], v[140:143]
ds_read_b128 v[124:127], v93 offset:18432
ds_read_b64_tr_b16 a[0:1], v74 offset:49152
v_mfma_f32_16x16x32_bf16 v[136:139], a[68:71], v[104:107], v[136:139]
ds_read_b64_tr_b16 a[2:3], v74 offset:51200
buffer_load_dwordx4 v39, s[4:7], s40 offen offset:2048 lds
v_mfma_f32_16x16x32_bf16 v[144:147], a[72:75], v[104:107], v[144:147]
ds_read_b64_tr_b16 a[4:5], v75 offset:49152
ds_read_b64_tr_b16 a[6:7], v75 offset:51200
v_mfma_f32_16x16x32_bf16 v[148:151], a[72:75], v[108:111], v[148:151]
ds_read_b64_tr_b16 a[8:9], v76 offset:49152
buffer_load_dwordx4 v40, s[4:7], s40 offen offset:3072 lds
v_mfma_f32_16x16x32_bf16 v[156:159], a[76:79], v[108:111], v[156:159]
ds_read_b64_tr_b16 a[10:11], v76 offset:51200
ds_read_b64_tr_b16 a[12:13], v77 offset:49152
v_mfma_f32_16x16x32_bf16 v[152:155], a[76:79], v[104:107], v[152:155]
ds_read_b64_tr_b16 a[14:15], v77 offset:51200
s_add_u32 s40, s40, 128
v_mfma_f32_16x16x32_bf16 v[160:163], a[80:83], v[104:107], v[160:163]
ds_read_b64_tr_b16 a[16:17], v78 offset:49152
ds_read_b64_tr_b16 a[18:19], v78 offset:51200
s_cmp_eq_u32 s40, 896
s_cselect_b32 s40, 0, s40
v_mfma_f32_16x16x32_bf16 v[164:167], a[80:83], v[108:111], v[164:167]
ds_read_b64_tr_b16 a[20:21], v79 offset:49152
s_add_u32 m0, s33, 131072
v_mfma_f32_16x16x32_bf16 v[172:175], a[84:87], v[108:111], v[172:175]
ds_read_b64_tr_b16 a[22:23], v79 offset:51200
ds_read_b64_tr_b16 a[24:25], v80 offset:49152
v_mfma_f32_16x16x32_bf16 v[168:171], a[84:87], v[104:107], v[168:171]
ds_read_b64_tr_b16 a[26:27], v80 offset:51200
buffer_load_dwordx4 v33, s[16:19], s41 offen lds
v_mfma_f32_16x16x32_bf16 v[176:179], a[88:91], v[104:107], v[176:179]
ds_read_b64_tr_b16 a[28:29], v81 offset:49152
ds_read_b64_tr_b16 a[30:31], v81 offset:51200
v_mfma_f32_16x16x32_bf16 v[180:183], a[88:91], v[108:111], v[180:183]
ds_read_b64_tr_b16 a[32:33], v74 offset:49408
v_lshlrev_b32 v13, 4, v62
v_mfma_f32_16x16x32_bf16 v[188:191], a[92:95], v[108:111], v[188:191]
ds_read_b64_tr_b16 a[34:35], v74 offset:51456
ds_read_b64_tr_b16 a[36:37], v75 offset:49408
v_mfma_f32_16x16x32_bf16 v[184:187], a[92:95], v[104:107], v[184:187]
ds_read_b64_tr_b16 a[38:39], v75 offset:51456
buffer_load_dwordx4 v34, s[16:19], s41 offen offset:1024 lds
v_mfma_f32_16x16x32_bf16 v[192:195], a[96:99], v[104:107], v[192:195]
ds_read_b64_tr_b16 a[40:41], v76 offset:49408
ds_read_b64_tr_b16 a[42:43], v76 offset:51456
v_mfma_f32_16x16x32_bf16 v[196:199], a[96:99], v[108:111], v[196:199]
ds_read_b64_tr_b16 a[44:45], v77 offset:49408
v_lshl_add_u32 v13, v48, 12, v13
v_mfma_f32_16x16x32_bf16 v[204:207], a[100:103], v[108:111], v[204:207]
ds_read_b64_tr_b16 a[46:47], v77 offset:51456
ds_read_b64_tr_b16 a[48:49], v78 offset:49408
v_mfma_f32_16x16x32_bf16 v[200:203], a[100:103], v[104:107], v[200:203]
ds_read_b64_tr_b16 a[50:51], v78 offset:51456
buffer_load_dwordx4 v35, s[16:19], s41 offen offset:2048 lds
v_mfma_f32_16x16x32_bf16 v[208:211], a[104:107], v[104:107], v[208:211]
ds_read_b64_tr_b16 a[52:53], v79 offset:49408
ds_read_b64_tr_b16 a[54:55], v79 offset:51456
v_mfma_f32_16x16x32_bf16 v[212:215], a[104:107], v[108:111], v[212:215]
ds_read_b64_tr_b16 a[56:57], v80 offset:49408
v_add_u32 v14, 65536, v13
v_mfma_f32_16x16x32_bf16 v[220:223], a[108:111], v[108:111], v[220:223]
ds_read_b64_tr_b16 a[58:59], v80 offset:51456
ds_read_b64_tr_b16 a[60:61], v81 offset:49408
v_mfma_f32_16x16x32_bf16 v[216:219], a[108:111], v[104:107], v[216:219]
ds_read_b64_tr_b16 a[62:63], v81 offset:51456
v_add_u32 v15, 131072, v13
v_mfma_f32_16x16x32_bf16 v[224:227], a[112:115], v[104:107], v[224:227]
buffer_load_dwordx4 v36, s[16:19], s41 offen offset:3072 lds
s_add_u32 s41, s41, 262144
v_mfma_f32_16x16x32_bf16 v[228:231], a[112:115], v[108:111], v[228:231]
v_mov_b32 v54, 0x3f803f80
v_accvgpr_write_b32 a240, v54
v_mfma_f32_16x16x32_bf16 v[236:239], a[116:119], v[108:111], v[236:239]
v_accvgpr_write_b32 a241, v54
v_accvgpr_write_b32 a242, v54
v_mfma_f32_16x16x32_bf16 v[232:235], a[116:119], v[104:107], v[232:235]
v_accvgpr_write_b32 a243, v54
v_and_b32 v55, 1, v62
v_mfma_f32_16x16x32_bf16 v[240:243], a[120:123], v[104:107], v[240:243]
v_lshlrev_b32 v55, 4, v55
v_mov_b32 v54, 0x3f80
v_mfma_f32_16x16x32_bf16 v[244:247], a[120:123], v[108:111], v[244:247]
v_lshlrev_b32 v55, v55, v54
v_bfe_u32 v54, v62, 1, 3
v_mfma_f32_16x16x32_bf16 v[252:255], a[124:127], v[108:111], v[252:255]
v_cmp_eq_u32 vcc, 0, v54
s_nop 1
v_cndmask_b32 v49, 0, v55, vcc
v_mfma_f32_16x16x32_bf16 v[248:251], a[124:127], v[104:107], v[248:251]
v_accvgpr_write_b32 a244, v49
s_waitcnt vmcnt(12) lgkmcnt(0)
s_barrier
v_mfma_f32_16x16x32_bf16 v[128:131], a[0:3], v[112:115], v[128:131]
ds_read_b64_tr_b16 a[64:65], v64 offset:49152
ds_read_b64_tr_b16 a[66:67], v64 offset:51200
v_mfma_f32_16x16x32_bf16 v[132:135], a[0:3], v[116:119], v[132:135]
ds_read_b64_tr_b16 a[68:69], v65 offset:49152
s_add_u32 m0, s33, 147456
v_mfma_f32_16x16x32_bf16 v[140:143], a[4:7], v[116:119], v[140:143]
ds_read_b64_tr_b16 a[70:71], v65 offset:51200
buffer_load_dwordx4 v33, s[16:19], s41 offen lds
v_mfma_f32_16x16x32_bf16 v[136:139], a[4:7], v[112:115], v[136:139]
ds_read_b64_tr_b16 a[72:73], v66 offset:49152
ds_read_b64_tr_b16 a[74:75], v66 offset:51200
v_mfma_f32_16x16x32_bf16 v[144:147], a[8:11], v[112:115], v[144:147]
ds_read_b64_tr_b16 a[76:77], v67 offset:49152
buffer_load_dwordx4 v34, s[16:19], s41 offen offset:1024 lds
v_mfma_f32_16x16x32_bf16 v[148:151], a[8:11], v[116:119], v[148:151]
ds_read_b64_tr_b16 a[78:79], v67 offset:51200
v_cmp_eq_u32 vcc, 1, v54
v_mfma_f32_16x16x32_bf16 v[156:159], a[12:15], v[116:119], v[156:159]
ds_read_b64_tr_b16 a[80:81], v68 offset:49152
ds_read_b64_tr_b16 a[82:83], v68 offset:51200
v_mfma_f32_16x16x32_bf16 v[152:155], a[12:15], v[112:115], v[152:155]
ds_read_b64_tr_b16 a[84:85], v69 offset:49152
buffer_load_dwordx4 v35, s[16:19], s41 offen offset:2048 lds
v_mfma_f32_16x16x32_bf16 v[160:163], a[16:19], v[112:115], v[160:163]
ds_read_b64_tr_b16 a[86:87], v69 offset:51200
v_cndmask_b32 v49, 0, v55, vcc
v_mfma_f32_16x16x32_bf16 v[164:167], a[16:19], v[116:119], v[164:167]
ds_read_b64_tr_b16 a[88:89], v70 offset:49152
ds_read_b64_tr_b16 a[90:91], v70 offset:51200
v_mfma_f32_16x16x32_bf16 v[172:175], a[20:23], v[116:119], v[172:175]
ds_read_b64_tr_b16 a[92:93], v71 offset:49152
buffer_load_dwordx4 v36, s[16:19], s41 offen offset:3072 lds
v_mfma_f32_16x16x32_bf16 v[168:171], a[20:23], v[112:115], v[168:171]
ds_read_b64_tr_b16 a[94:95], v71 offset:51200
s_add_u32 s41, s41, 262144
v_mfma_f32_16x16x32_bf16 v[176:179], a[24:27], v[112:115], v[176:179]
ds_read_b64_tr_b16 a[96:97], v64 offset:49408
ds_read_b64_tr_b16 a[98:99], v64 offset:51456
s_cmp_eq_u32 s41, 3670016
s_cselect_b32 s41, 0, s41
v_mfma_f32_16x16x32_bf16 v[180:183], a[24:27], v[116:119], v[180:183]
ds_read_b64_tr_b16 a[100:101], v65 offset:49408
s_add_u32 m0, s33, 114688
v_mfma_f32_16x16x32_bf16 v[188:191], a[28:31], v[116:119], v[188:191]
ds_read_b64_tr_b16 a[102:103], v65 offset:51456
buffer_load_dwordx4 v37, s[4:7], s40 offen lds
v_mfma_f32_16x16x32_bf16 v[184:187], a[28:31], v[112:115], v[184:187]
ds_read_b64_tr_b16 a[104:105], v66 offset:49408
ds_read_b64_tr_b16 a[106:107], v66 offset:51456
v_mfma_f32_16x16x32_bf16 v[192:195], a[32:35], v[112:115], v[192:195]
ds_read_b64_tr_b16 a[108:109], v67 offset:49408
buffer_load_dwordx4 v38, s[4:7], s40 offen offset:1024 lds
v_mfma_f32_16x16x32_bf16 v[196:199], a[32:35], v[116:119], v[196:199]
ds_read_b64_tr_b16 a[110:111], v67 offset:51456
s_add_u32 m0, s33, 81920
v_mfma_f32_16x16x32_bf16 v[204:207], a[36:39], v[116:119], v[204:207]
ds_read_b64_tr_b16 a[112:113], v68 offset:49408
ds_read_b64_tr_b16 a[114:115], v68 offset:51456
v_mfma_f32_16x16x32_bf16 v[200:203], a[36:39], v[112:115], v[200:203]
ds_read_b64_tr_b16 a[116:117], v69 offset:49408
buffer_load_dwordx4 v29, s[12:15], s43 offen nt lds
v_mfma_f32_16x16x32_bf16 v[208:211], a[40:43], v[112:115], v[208:211]
ds_read_b64_tr_b16 a[118:119], v69 offset:51456
buffer_load_dwordx4 v30, s[12:15], s43 offen offset:1024 nt lds
v_mfma_f32_16x16x32_bf16 v[212:215], a[40:43], v[116:119], v[212:215]
ds_read_b64_tr_b16 a[120:121], v70 offset:49408
ds_read_b64_tr_b16 a[122:123], v70 offset:51456
v_mfma_f32_16x16x32_bf16 v[220:223], a[44:47], v[116:119], v[220:223]
ds_read_b64_tr_b16 a[124:125], v71 offset:49408
v_accvgpr_write_b32 a245, v49
v_mfma_f32_16x16x32_bf16 v[216:219], a[44:47], v[112:115], v[216:219]
ds_read_b64_tr_b16 a[126:127], v71 offset:51456
v_cmp_eq_u32 vcc, 2, v54
v_mfma_f32_16x16x32_bf16 v[224:227], a[48:51], v[112:115], v[224:227]
buffer_load_dwordx4 v31, s[12:15], s43 offen offset:2048 nt lds
v_cndmask_b32 v49, 0, v55, vcc
v_mfma_f32_16x16x32_bf16 v[228:231], a[48:51], v[116:119], v[228:231]
v_accvgpr_write_b32 a246, v49
v_cmp_eq_u32 vcc, 3, v54
v_mfma_f32_16x16x32_bf16 v[236:239], a[52:55], v[116:119], v[236:239]
buffer_load_dwordx4 v32, s[12:15], s43 offen offset:3072 nt lds
s_add_u32 s43, s43, 16384
v_mfma_f32_16x16x32_bf16 v[232:235], a[52:55], v[112:115], v[232:235]
s_and_b32 s43, s43, 0x3ffff
v_cndmask_b32 v49, 0, v55, vcc
v_accvgpr_write_b32 a247, v49
v_mfma_f32_16x16x32_bf16 v[240:243], a[56:59], v[112:115], v[240:243]
v_cmp_eq_u32 vcc, 4, v54
s_nop 1
v_cndmask_b32 v49, 0, v55, vcc
v_mfma_f32_16x16x32_bf16 v[244:247], a[56:59], v[116:119], v[244:247]
v_accvgpr_write_b32 a248, v49
v_cmp_eq_u32 vcc, 5, v54
v_mfma_f32_16x16x32_bf16 v[252:255], a[60:63], v[116:119], v[252:255]
s_nop 0
v_cndmask_b32 v49, 0, v55, vcc
v_accvgpr_write_b32 a249, v49
v_mfma_f32_16x16x32_bf16 v[248:251], a[60:63], v[112:115], v[248:251]
v_cmp_eq_u32 vcc, 6, v54
s_waitcnt vmcnt(10) lgkmcnt(0)
s_barrier
v_mfma_f32_16x16x32_bf16 v[128:131], a[64:67], v[120:123], v[128:131]
ds_read_b128 v[96:99], v82 offset:32768
ds_read_b128 v[100:103], v82 offset:34816
v_mfma_f32_16x16x32_bf16 v[132:135], a[64:67], v[124:127], v[132:135]
ds_read_b128 v[104:107], v83 offset:32768
s_add_u32 m0, s33, 114688
v_mfma_f32_16x16x32_bf16 v[140:143], a[68:71], v[124:127], v[140:143]
ds_read_b128 v[108:111], v83 offset:34816
ds_read_b64_tr_b16 a[0:1], v84 offset:0
v_mfma_f32_16x16x32_bf16 v[136:139], a[68:71], v[120:123], v[136:139]
ds_read_b64_tr_b16 a[2:3], v84 offset:2048
buffer_load_dwordx4 v39, s[4:7], s40 offen offset:2048 lds
v_mfma_f32_16x16x32_bf16 v[144:147], a[72:75], v[120:123], v[144:147]
ds_read_b64_tr_b16 a[4:5], v85 offset:0
ds_read_b64_tr_b16 a[6:7], v85 offset:2048
v_mfma_f32_16x16x32_bf16 v[148:151], a[72:75], v[124:127], v[148:151]
ds_read_b64_tr_b16 a[8:9], v86 offset:0
buffer_load_dwordx4 v40, s[4:7], s40 offen offset:3072 lds
v_mfma_f32_16x16x32_bf16 v[156:159], a[76:79], v[124:127], v[156:159]
ds_read_b64_tr_b16 a[10:11], v86 offset:2048
ds_read_b64_tr_b16 a[12:13], v87 offset:0
v_mfma_f32_16x16x32_bf16 v[152:155], a[76:79], v[120:123], v[152:155]
ds_read_b64_tr_b16 a[14:15], v87 offset:2048
s_add_u32 s40, s40, 128
v_mfma_f32_16x16x32_bf16 v[160:163], a[80:83], v[120:123], v[160:163]
ds_read_b64_tr_b16 a[16:17], v88 offset:0
ds_read_b64_tr_b16 a[18:19], v88 offset:2048
s_cmp_eq_u32 s40, 896
s_cselect_b32 s40, 0, s40
v_mfma_f32_16x16x32_bf16 v[164:167], a[80:83], v[124:127], v[164:167]
ds_read_b64_tr_b16 a[20:21], v89 offset:0
s_add_u32 m0, s33, 49152
v_mfma_f32_16x16x32_bf16 v[172:175], a[84:87], v[124:127], v[172:175]
ds_read_b64_tr_b16 a[22:23], v89 offset:2048
ds_read_b64_tr_b16 a[24:25], v90 offset:0
v_mfma_f32_16x16x32_bf16 v[168:171], a[84:87], v[120:123], v[168:171]
ds_read_b64_tr_b16 a[26:27], v90 offset:2048
buffer_load_dwordx4 v33, s[16:19], s41 offen lds
v_mfma_f32_16x16x32_bf16 v[176:179], a[88:91], v[120:123], v[176:179]
ds_read_b64_tr_b16 a[28:29], v91 offset:0
ds_read_b64_tr_b16 a[30:31], v91 offset:2048
v_mfma_f32_16x16x32_bf16 v[180:183], a[88:91], v[124:127], v[180:183]
ds_read_b64_tr_b16 a[32:33], v84 offset:256
v_cndmask_b32 v49, 0, v55, vcc
v_mfma_f32_16x16x32_bf16 v[188:191], a[92:95], v[124:127], v[188:191]
ds_read_b64_tr_b16 a[34:35], v84 offset:2304
ds_read_b64_tr_b16 a[36:37], v85 offset:256
v_mfma_f32_16x16x32_bf16 v[184:187], a[92:95], v[120:123], v[184:187]
ds_read_b64_tr_b16 a[38:39], v85 offset:2304
buffer_load_dwordx4 v34, s[16:19], s41 offen offset:1024 lds
v_mfma_f32_16x16x32_bf16 v[192:195], a[96:99], v[120:123], v[192:195]
ds_read_b64_tr_b16 a[40:41], v86 offset:256
ds_read_b64_tr_b16 a[42:43], v86 offset:2304
v_mfma_f32_16x16x32_bf16 v[196:199], a[96:99], v[124:127], v[196:199]
ds_read_b64_tr_b16 a[44:45], v87 offset:256
v_accvgpr_write_b32 a250, v49
v_mfma_f32_16x16x32_bf16 v[204:207], a[100:103], v[124:127], v[204:207]
ds_read_b64_tr_b16 a[46:47], v87 offset:2304
ds_read_b64_tr_b16 a[48:49], v88 offset:256
v_mfma_f32_16x16x32_bf16 v[200:203], a[100:103], v[120:123], v[200:203]
ds_read_b64_tr_b16 a[50:51], v88 offset:2304
buffer_load_dwordx4 v35, s[16:19], s41 offen offset:2048 lds
v_mfma_f32_16x16x32_bf16 v[208:211], a[104:107], v[120:123], v[208:211]
ds_read_b64_tr_b16 a[52:53], v89 offset:256
ds_read_b64_tr_b16 a[54:55], v89 offset:2304
v_mfma_f32_16x16x32_bf16 v[212:215], a[104:107], v[124:127], v[212:215]
ds_read_b64_tr_b16 a[56:57], v90 offset:256
v_cmp_eq_u32 vcc, 7, v54
v_mfma_f32_16x16x32_bf16 v[220:223], a[108:111], v[124:127], v[220:223]
ds_read_b64_tr_b16 a[58:59], v90 offset:2304
ds_read_b64_tr_b16 a[60:61], v91 offset:256
v_mfma_f32_16x16x32_bf16 v[216:219], a[108:111], v[120:123], v[216:219]
ds_read_b64_tr_b16 a[62:63], v91 offset:2304
v_cndmask_b32 v49, 0, v55, vcc
v_mfma_f32_16x16x32_bf16 v[224:227], a[112:115], v[120:123], v[224:227]
buffer_load_dwordx4 v36, s[16:19], s41 offen offset:3072 lds
s_add_u32 s41, s41, 262144
v_mfma_f32_16x16x32_bf16 v[228:231], a[112:115], v[124:127], v[228:231]
v_accvgpr_write_b32 a251, v49
v_mfma_f32_16x16x32_bf16 v[236:239], a[116:119], v[124:127], v[236:239]
s_mov_b32 s48, 0x3db8aa3b
s_mov_b32 s49, 0x41317218
s_mov_b32 s51, 0
v_mfma_f32_16x16x32_bf16 v[232:235], a[116:119], v[120:123], v[232:235]
s_cmp_eq_u32 s34, 7
s_cselect_b32 s47, 0, s34
v_mfma_f32_16x16x32_bf16 v[240:243], a[120:123], v[120:123], v[240:243]
s_lshl_b32 s44, s47, 7
s_mov_b32 s45, 0
s_mov_b32 s46, 0
v_mfma_f32_16x16x32_bf16 v[244:247], a[120:123], v[124:127], v[244:247]
s_mul_i32 s39, s35, 229376
s_add_u32 s20, s80, s39
s_addc_u32 s21, s81, 0
v_mfma_f32_16x16x32_bf16 v[252:255], a[124:127], v[124:127], v[252:255]
s_mov_b32 s22, 229376
s_mov_b32 s23, 0x20000
v_mfma_f32_16x16x32_bf16 v[248:251], a[124:127], v[120:123], v[248:251]
s_waitcnt vmcnt(12) lgkmcnt(0)
s_barrier
v_mfma_f32_16x16x32_bf16 v[128:131], a[0:3], v[96:99], v[128:131]
ds_read_b64_tr_b16 a[64:65], v84 offset:16384
ds_read_b64_tr_b16 a[66:67], v84 offset:18432
v_mfma_f32_16x16x32_bf16 v[132:135], a[0:3], v[100:103], v[132:135]
ds_read_b64_tr_b16 a[68:69], v85 offset:16384
s_add_u32 m0, s33, 131072
v_mfma_f32_16x16x32_bf16 v[140:143], a[4:7], v[100:103], v[140:143]
ds_read_b64_tr_b16 a[70:71], v85 offset:18432
buffer_load_dwordx4 v33, s[16:19], s41 offen lds
v_mfma_f32_16x16x32_bf16 v[136:139], a[4:7], v[96:99], v[136:139]
ds_read_b64_tr_b16 a[72:73], v86 offset:16384
ds_read_b64_tr_b16 a[74:75], v86 offset:18432
v_mfma_f32_16x16x32_bf16 v[144:147], a[8:11], v[96:99], v[144:147]
ds_read_b64_tr_b16 a[76:77], v87 offset:16384
buffer_load_dwordx4 v34, s[16:19], s41 offen offset:1024 lds
v_mfma_f32_16x16x32_bf16 v[148:151], a[8:11], v[100:103], v[148:151]
ds_read_b64_tr_b16 a[78:79], v87 offset:18432
v_mfma_f32_16x16x32_bf16 v[156:159], a[12:15], v[100:103], v[156:159]
ds_read_b64_tr_b16 a[80:81], v88 offset:16384
ds_read_b64_tr_b16 a[82:83], v88 offset:18432
v_mfma_f32_16x16x32_bf16 v[152:155], a[12:15], v[96:99], v[152:155]
ds_read_b64_tr_b16 a[84:85], v89 offset:16384
buffer_load_dwordx4 v35, s[16:19], s41 offen offset:2048 lds
v_mfma_f32_16x16x32_bf16 v[160:163], a[16:19], v[96:99], v[160:163]
ds_read_b64_tr_b16 a[86:87], v89 offset:18432
v_mfma_f32_16x16x32_bf16 v[164:167], a[16:19], v[100:103], v[164:167]
ds_read_b64_tr_b16 a[88:89], v90 offset:16384
ds_read_b64_tr_b16 a[90:91], v90 offset:18432
v_mfma_f32_16x16x32_bf16 v[172:175], a[20:23], v[100:103], v[172:175]
ds_read_b64_tr_b16 a[92:93], v91 offset:16384
buffer_load_dwordx4 v36, s[16:19], s41 offen offset:3072 lds
v_mfma_f32_16x16x32_bf16 v[168:171], a[20:23], v[96:99], v[168:171]
ds_read_b64_tr_b16 a[94:95], v91 offset:18432
s_add_u32 s41, s41, 262144
v_mfma_f32_16x16x32_bf16 v[176:179], a[24:27], v[96:99], v[176:179]
ds_read_b64_tr_b16 a[96:97], v84 offset:16640
ds_read_b64_tr_b16 a[98:99], v84 offset:18688
s_cmp_eq_u32 s41, 3670016
s_cselect_b32 s41, 0, s41
v_mfma_f32_16x16x32_bf16 v[180:183], a[24:27], v[100:103], v[180:183]
ds_read_b64_tr_b16 a[100:101], v85 offset:16640
s_add_u32 m0, s33, 98304
v_mfma_f32_16x16x32_bf16 v[188:191], a[28:31], v[100:103], v[188:191]
ds_read_b64_tr_b16 a[102:103], v85 offset:18688
buffer_load_dwordx4 v37, s[4:7], s40 offen lds
v_mfma_f32_16x16x32_bf16 v[184:187], a[28:31], v[96:99], v[184:187]
ds_read_b64_tr_b16 a[104:105], v86 offset:16640
ds_read_b64_tr_b16 a[106:107], v86 offset:18688
v_mfma_f32_16x16x32_bf16 v[192:195], a[32:35], v[96:99], v[192:195]
ds_read_b64_tr_b16 a[108:109], v87 offset:16640
buffer_load_dwordx4 v38, s[4:7], s40 offen offset:1024 lds
v_mfma_f32_16x16x32_bf16 v[196:199], a[32:35], v[100:103], v[196:199]
ds_read_b64_tr_b16 a[110:111], v87 offset:18688
buffer_load_dwordx4 a[208:211], v25, s[8:11], s42 offen nt
v_mfma_f32_16x16x32_bf16 v[204:207], a[36:39], v[100:103], v[204:207]
ds_read_b64_tr_b16 a[112:113], v88 offset:16640
ds_read_b64_tr_b16 a[114:115], v88 offset:18688
v_mfma_f32_16x16x32_bf16 v[200:203], a[36:39], v[96:99], v[200:203]
ds_read_b64_tr_b16 a[116:117], v89 offset:16640
v_mfma_f32_16x16x32_bf16 v[208:211], a[40:43], v[96:99], v[208:211]
ds_read_b64_tr_b16 a[118:119], v89 offset:18688
buffer_load_dwordx4 a[212:215], v26, s[8:11], s42 offen offset:1024 nt
v_mfma_f32_16x16x32_bf16 v[212:215], a[40:43], v[100:103], v[212:215]
ds_read_b64_tr_b16 a[120:121], v90 offset:16640
ds_read_b64_tr_b16 a[122:123], v90 offset:18688
v_mfma_f32_16x16x32_bf16 v[220:223], a[44:47], v[100:103], v[220:223]
ds_read_b64_tr_b16 a[124:125], v91 offset:16640
v_mfma_f32_16x16x32_bf16 v[216:219], a[44:47], v[96:99], v[216:219]
ds_read_b64_tr_b16 a[126:127], v91 offset:18688
v_mfma_f32_16x16x32_bf16 v[224:227], a[48:51], v[96:99], v[224:227]
buffer_load_dwordx4 a[216:219], v27, s[8:11], s42 offen offset:2048 nt
v_mfma_f32_16x16x32_bf16 v[228:231], a[48:51], v[100:103], v[228:231]
s_lshl_b32 s39, s37, 22
s_add_u32 s24, s82, s39
s_addc_u32 s25, s83, 0
v_mfma_f32_16x16x32_bf16 v[236:239], a[52:55], v[100:103], v[236:239]
buffer_load_dwordx4 a[220:223], v28, s[8:11], s42 offen offset:3072 nt
s_add_u32 s42, s42, 16384
v_mfma_f32_16x16x32_bf16 v[232:235], a[52:55], v[96:99], v[232:235]
s_and_b32 s42, s42, 0x3ffff
s_mov_b32 s26, 4194304
s_mov_b32 s27, 0x20000
v_mfma_f32_16x16x32_bf16 v[240:243], a[56:59], v[96:99], v[240:243]
s_lshl_b32 s39, s37, 22
s_add_u32 s39, s39, 245760
s_add_u32 s56, s82, s39
s_addc_u32 s57, s83, 0
v_mfma_f32_16x16x32_bf16 v[244:247], a[56:59], v[100:103], v[244:247]
s_mov_b32 s58, 16384
s_mov_b32 s59, 0x20000
v_mfma_f32_16x16x32_bf16 v[252:255], a[60:63], v[100:103], v[252:255]
s_mov_b32 s60, s86
s_mov_b32 s61, s87
v_mfma_f32_16x16x32_bf16 v[248:251], a[60:63], v[96:99], v[248:251]
s_waitcnt vmcnt(10) lgkmcnt(0)
s_barrier
v_mfma_f32_16x16x32_bf16 v[128:131], a[64:67], v[104:107], v[128:131]
ds_read_b128 v[112:115], v82 offset:49152
ds_read_b128 v[116:119], v82 offset:51200
v_mfma_f32_16x16x32_bf16 v[132:135], a[64:67], v[108:111], v[132:135]
ds_read_b128 v[120:123], v83 offset:49152
buffer_load_dwordx4 v39, s[4:7], s40 offen offset:2048 lds
v_mfma_f32_16x16x32_bf16 v[140:143], a[68:71], v[108:111], v[140:143]
ds_read_b128 v[124:127], v83 offset:51200
ds_read_b64_tr_b16 a[0:1], v64 offset:49152
v_mfma_f32_16x16x32_bf16 v[136:139], a[68:71], v[104:107], v[136:139]
ds_read_b64_tr_b16 a[2:3], v64 offset:51200
v_mfma_f32_16x16x32_bf16 v[144:147], a[72:75], v[104:107], v[144:147]
L_pad2:
s_cbranch_execz L_hr0
ds_read_b64_tr_b16 a[4:5], v65 offset:49152
ds_read_b64_tr_b16 a[6:7], v65 offset:51200
v_mfma_f32_16x16x32_bf16 v[148:151], a[72:75], v[108:111], v[148:151]
ds_read_b64_tr_b16 a[8:9], v66 offset:49152
buffer_load_dwordx4 v40, s[4:7], s40 offen offset:3072 lds
v_mfma_f32_16x16x32_bf16 v[156:159], a[76:79], v[108:111], v[156:159]
ds_read_b64_tr_b16 a[10:11], v66 offset:51200
ds_read_b64_tr_b16 a[12:13], v67 offset:49152
v_mfma_f32_16x16x32_bf16 v[152:155], a[76:79], v[104:107], v[152:155]
ds_read_b64_tr_b16 a[14:15], v67 offset:51200
s_add_u32 s40, s40, 128
v_mfma_f32_16x16x32_bf16 v[160:163], a[80:83], v[104:107], v[160:163]
ds_read_b64_tr_b16 a[16:17], v68 offset:49152
ds_read_b64_tr_b16 a[18:19], v68 offset:51200
s_cmp_eq_u32 s40, 896
s_cselect_b32 s40, 0, s40
v_mfma_f32_16x16x32_bf16 v[164:167], a[80:83], v[108:111], v[164:167]
ds_read_b64_tr_b16 a[20:21], v69 offset:49152
s_add_u32 m0, s33, 147456
v_mfma_f32_16x16x32_bf16 v[172:175], a[84:87], v[108:111], v[172:175]
ds_read_b64_tr_b16 a[22:23], v69 offset:51200
ds_read_b64_tr_b16 a[24:25], v70 offset:49152
v_mfma_f32_16x16x32_bf16 v[168:171], a[84:87], v[104:107], v[168:171]
ds_read_b64_tr_b16 a[26:27], v70 offset:51200
buffer_load_dwordx4 v33, s[16:19], s41 offen lds
v_mfma_f32_16x16x32_bf16 v[176:179], a[88:91], v[104:107], v[176:179]
ds_read_b64_tr_b16 a[28:29], v71 offset:49152
ds_read_b64_tr_b16 a[30:31], v71 offset:51200
v_mfma_f32_16x16x32_bf16 v[180:183], a[88:91], v[108:111], v[180:183]
ds_read_b64_tr_b16 a[32:33], v64 offset:49408
v_mfma_f32_16x16x32_bf16 v[188:191], a[92:95], v[108:111], v[188:191]
ds_read_b64_tr_b16 a[34:35], v64 offset:51456
ds_read_b64_tr_b16 a[36:37], v65 offset:49408
v_mfma_f32_16x16x32_bf16 v[184:187], a[92:95], v[104:107], v[184:187]
ds_read_b64_tr_b16 a[38:39], v65 offset:51456
buffer_load_dwordx4 v34, s[16:19], s41 offen offset:1024 lds
v_mfma_f32_16x16x32_bf16 v[192:195], a[96:99], v[104:107], v[192:195]
ds_read_b64_tr_b16 a[40:41], v66 offset:49408
ds_read_b64_tr_b16 a[42:43], v66 offset:51456
v_mfma_f32_16x16x32_bf16 v[196:199], a[96:99], v[108:111], v[196:199]
ds_read_b64_tr_b16 a[44:45], v67 offset:49408
v_mfma_f32_16x16x32_bf16 v[204:207], a[100:103], v[108:111], v[204:207]
ds_read_b64_tr_b16 a[46:47], v67 offset:51456
ds_read_b64_tr_b16 a[48:49], v68 offset:49408
v_mfma_f32_16x16x32_bf16 v[200:203], a[100:103], v[104:107], v[200:203]
ds_read_b64_tr_b16 a[50:51], v68 offset:51456
buffer_load_dwordx4 v35, s[16:19], s41 offen offset:2048 lds
v_mfma_f32_16x16x32_bf16 v[208:211], a[104:107], v[104:107], v[208:211]
ds_read_b64_tr_b16 a[52:53], v69 offset:49408
ds_read_b64_tr_b16 a[54:55], v69 offset:51456
v_mfma_f32_16x16x32_bf16 v[212:215], a[104:107], v[108:111], v[212:215]
ds_read_b64_tr_b16 a[56:57], v70 offset:49408
v_mfma_f32_16x16x32_bf16 v[220:223], a[108:111], v[108:111], v[220:223]
ds_read_b64_tr_b16 a[58:59], v70 offset:51456
ds_read_b64_tr_b16 a[60:61], v71 offset:49408
v_mfma_f32_16x16x32_bf16 v[216:219], a[108:111], v[104:107], v[216:219]
ds_read_b64_tr_b16 a[62:63], v71 offset:51456
v_mfma_f32_16x16x32_bf16 v[224:227], a[112:115], v[104:107], v[224:227]
buffer_load_dwordx4 v36, s[16:19], s41 offen offset:3072 lds
s_add_u32 s41, s41, 262144
v_mfma_f32_16x16x32_bf16 v[228:231], a[112:115], v[108:111], v[228:231]
s_mov_b32 s62, 256
s_mov_b32 s63, 0x20000
v_mfma_f32_16x16x32_bf16 v[236:239], a[116:119], v[108:111], v[236:239]
s_mov_b32 s68, s84
s_mov_b32 s69, s85
v_mfma_f32_16x16x32_bf16 v[232:235], a[116:119], v[104:107], v[232:235]
s_mov_b32 s70, 1835008
s_mov_b32 s71, 0x20000
s_lshl4_add_u32 s94, s34, s35
v_mfma_f32_16x16x32_bf16 v[240:243], a[120:123], v[104:107], v[240:243]
s_mul_i32 s94, s94, 14336
s_mul_i32 s92, s36, 896
s_add_u32 s94, s94, s92
v_mfma_f32_16x16x32_bf16 v[244:247], a[120:123], v[108:111], v[244:247]
s_lshr_b32 s92, s32, 1
s_lshl_b32 s92, s92, 6
s_add_u32 s94, s94, s92
v_mfma_f32_16x16x32_bf16 v[252:255], a[124:127], v[108:111], v[252:255]
s_and_b32 s92, s32, 1
s_lshl4_add_u32 s94, s92, s94
s_mov_b32 s96, 0
v_mfma_f32_16x16x32_bf16 v[248:251], a[124:127], v[104:107], v[248:251]
s_mov_b32 s97, -1
s_waitcnt vmcnt(12) lgkmcnt(0)
s_barrier
s_lshl_b32 s93, s47, 7
s_mov_b32 s95, 0
s_mov_b32 s76, s64
s_mov_b32 s77, s65
s_mov_b32 s78, 0
s_mov_b32 s79, 0x20000
v_mov_b32 v55, 0x7fff0000
v_mov_b32 v58, 0
v_lshlrev_b32 v59, 2, v62
v_cmp_eq_u32 vcc, 0, v0
s_nop 1
v_cndmask_b32 v58, v55, v58, vcc
s_lshl_b32 s39, s35, 8
v_add_u32 v54, s39, v0
v_xor_b32 v54, 0x80, v54
s_lshl_b32 s39, s37, 4
v_mov_b32 v61, s39
v_cmp_eq_u32 vcc, 0x80, v0
s_nop 1
v_cndmask_b32 v60, v55, v61, vcc
v_cmp_gt_u32 vcc, 8, v54
s_nop 1
v_cndmask_b32 v59, v55, v59, vcc
s_cmp_ge_u32 s100, 56
s_cselect_b32 s39, 1, 0
v_mov_b32 v48, s39
v_xor_b32 v49, 1, v48
v_lshl_add_u32 v59, v49, 13, v59
v_lshlrev_b32 v48, s35, v48
v_or_b32 v48, 0x10000, v48
v_accvgpr_write_b32 a252, v48
v_mfma_f32_16x16x32_bf16 v[128:131], a[0:3], v[112:115], v[128:131]
ds_read_b64_tr_b16 a[64:65], v84 offset:0
ds_read_b64_tr_b16 a[66:67], v84 offset:2048
v_mfma_f32_16x16x32_bf16 v[132:135], a[0:3], v[116:119], v[132:135]
ds_read_b64_tr_b16 a[68:69], v85 offset:0
s_add_u32 m0, s33, 114688
v_mfma_f32_16x16x32_bf16 v[140:143], a[4:7], v[116:119], v[140:143]
ds_read_b64_tr_b16 a[70:71], v85 offset:2048
buffer_load_dwordx4 v33, s[16:19], s41 offen lds
v_mfma_f32_16x16x32_bf16 v[136:139], a[4:7], v[112:115], v[136:139]
ds_read_b64_tr_b16 a[72:73], v86 offset:0
ds_read_b64_tr_b16 a[74:75], v86 offset:2048
v_mfma_f32_16x16x32_bf16 v[144:147], a[8:11], v[112:115], v[144:147]
ds_read_b64_tr_b16 a[76:77], v87 offset:0
v_mfma_f32_16x16x32_bf16 v[148:151], a[8:11], v[116:119], v[148:151]
ds_read_b64_tr_b16 a[78:79], v87 offset:2048
buffer_load_dwordx4 v34, s[16:19], s41 offen offset:1024 lds
v_mfma_f32_16x16x32_bf16 v[156:159], a[12:15], v[116:119], v[156:159]
ds_read_b64_tr_b16 a[80:81], v88 offset:0
ds_read_b64_tr_b16 a[82:83], v88 offset:2048
v_mfma_f32_16x16x32_bf16 v[152:155], a[12:15], v[112:115], v[152:155]
ds_read_b64_tr_b16 a[84:85], v89 offset:0
v_mfma_f32_16x16x32_bf16 v[160:163], a[16:19], v[112:115], v[160:163]
ds_read_b64_tr_b16 a[86:87], v89 offset:2048
v_mfma_f32_16x16x32_bf16 v[164:167], a[16:19], v[116:119], v[164:167]
ds_read_b64_tr_b16 a[88:89], v90 offset:0
ds_read_b64_tr_b16 a[90:91], v90 offset:2048
v_mfma_f32_16x16x32_bf16 v[172:175], a[20:23], v[116:119], v[172:175]
ds_read_b64_tr_b16 a[92:93], v91 offset:0
buffer_load_dwordx4 v35, s[16:19], s41 offen offset:2048 lds
v_mfma_f32_16x16x32_bf16 v[168:171], a[20:23], v[112:115], v[168:171]
ds_read_b64_tr_b16 a[94:95], v91 offset:2048
v_mfma_f32_16x16x32_bf16 v[176:179], a[24:27], v[112:115], v[176:179]
ds_read_b64_tr_b16 a[96:97], v84 offset:256
ds_read_b64_tr_b16 a[98:99], v84 offset:2304
v_mfma_f32_16x16x32_bf16 v[180:183], a[24:27], v[116:119], v[180:183]
ds_read_b64_tr_b16 a[100:101], v85 offset:256
v_mfma_f32_16x16x32_bf16 v[188:191], a[28:31], v[116:119], v[188:191]
ds_read_b64_tr_b16 a[102:103], v85 offset:2304
v_mfma_f32_16x16x32_bf16 v[184:187], a[28:31], v[112:115], v[184:187]
ds_read_b64_tr_b16 a[104:105], v86 offset:256
ds_read_b64_tr_b16 a[106:107], v86 offset:2304
v_mfma_f32_16x16x32_bf16 v[192:195], a[32:35], v[112:115], v[192:195]
ds_read_b64_tr_b16 a[108:109], v87 offset:256
buffer_load_dwordx4 v36, s[16:19], s41 offen offset:3072 lds
v_mfma_f32_16x16x32_bf16 v[196:199], a[32:35], v[116:119], v[196:199]
ds_read_b64_tr_b16 a[110:111], v87 offset:2304
s_add_u32 s41, s41, 262144
v_mfma_f32_16x16x32_bf16 v[204:207], a[36:39], v[116:119], v[204:207]
ds_read_b64_tr_b16 a[112:113], v88 offset:256
ds_read_b64_tr_b16 a[114:115], v88 offset:2304
s_cmp_eq_u32 s41, 3670016
s_cselect_b32 s41, 0, s41
v_mfma_f32_16x16x32_bf16 v[200:203], a[36:39], v[112:115], v[200:203]
ds_read_b64_tr_b16 a[116:117], v89 offset:256
s_add_u32 m0, s33, 49152
v_mfma_f32_16x16x32_bf16 v[208:211], a[40:43], v[112:115], v[208:211]
ds_read_b64_tr_b16 a[118:119], v89 offset:2304
buffer_load_dwordx4 v37, s[4:7], s40 offen lds
v_mfma_f32_16x16x32_bf16 v[212:215], a[40:43], v[116:119], v[212:215]
ds_read_b64_tr_b16 a[120:121], v90 offset:256
ds_read_b64_tr_b16 a[122:123], v90 offset:2304
v_mfma_f32_16x16x32_bf16 v[220:223], a[44:47], v[116:119], v[220:223]
ds_read_b64_tr_b16 a[124:125], v91 offset:256
v_mfma_f32_16x16x32_bf16 v[216:219], a[44:47], v[112:115], v[216:219]
ds_read_b64_tr_b16 a[126:127], v91 offset:2304
v_mfma_f32_16x16x32_bf16 v[224:227], a[48:51], v[112:115], v[224:227]
buffer_load_dwordx4 v38, s[4:7], s40 offen offset:1024 lds
v_mfma_f32_16x16x32_bf16 v[228:231], a[48:51], v[116:119], v[228:231]
v_mfma_f32_16x16x32_bf16 v[236:239], a[52:55], v[116:119], v[236:239]
v_mfma_f32_16x16x32_bf16 v[232:235], a[52:55], v[112:115], v[232:235]
v_mfma_f32_16x16x32_bf16 v[240:243], a[56:59], v[112:115], v[240:243]
v_mfma_f32_16x16x32_bf16 v[244:247], a[56:59], v[116:119], v[244:247]
v_mfma_f32_16x16x32_bf16 v[252:255], a[60:63], v[116:119], v[252:255]
v_mfma_f32_16x16x32_bf16 v[248:251], a[60:63], v[112:115], v[248:251]
s_waitcnt vmcnt(4) lgkmcnt(0)
s_barrier
v_mfma_f32_16x16x32_bf16 v[128:131], a[64:67], v[120:123], v[128:131]
ds_read_b128 v[96:99], v82 offset:32768
ds_read_b128 v[100:103], v82 offset:34816
v_mfma_f32_16x16x32_bf16 v[132:135], a[64:67], v[124:127], v[132:135]
ds_read_b128 v[104:107], v83 offset:32768
buffer_load_dwordx4 v39, s[4:7], s40 offen offset:2048 lds
v_mfma_f32_16x16x32_bf16 v[140:143], a[68:71], v[124:127], v[140:143]
ds_read_b128 v[108:111], v83 offset:34816
ds_read_b64_tr_b16 a[0:1], v84 offset:16384
v_mfma_f32_16x16x32_bf16 v[136:139], a[68:71], v[120:123], v[136:139]
ds_read_b64_tr_b16 a[2:3], v84 offset:18432
buffer_load_dwordx4 v40, s[4:7], s40 offen offset:3072 lds
v_mfma_f32_16x16x32_bf16 v[144:147], a[72:75], v[120:123], v[144:147]
ds_read_b64_tr_b16 a[4:5], v85 offset:16384
ds_read_b64_tr_b16 a[6:7], v85 offset:18432
v_mfma_f32_16x16x32_bf16 v[148:151], a[72:75], v[124:127], v[148:151]
ds_read_b64_tr_b16 a[8:9], v86 offset:16384
s_add_u32 s40, s40, 128
v_mfma_f32_16x16x32_bf16 v[156:159], a[76:79], v[124:127], v[156:159]
ds_read_b64_tr_b16 a[10:11], v86 offset:18432
ds_read_b64_tr_b16 a[12:13], v87 offset:16384
s_cmp_eq_u32 s40, 896
s_cselect_b32 s40, 0, s40
v_mfma_f32_16x16x32_bf16 v[152:155], a[76:79], v[120:123], v[152:155]
ds_read_b64_tr_b16 a[14:15], v87 offset:18432
s_add_u32 m0, s33, 131072
v_mfma_f32_16x16x32_bf16 v[160:163], a[80:83], v[120:123], v[160:163]
ds_read_b64_tr_b16 a[16:17], v88 offset:16384
ds_read_b64_tr_b16 a[18:19], v88 offset:18432
v_mfma_f32_16x16x32_bf16 v[164:167], a[80:83], v[124:127], v[164:167]
ds_read_b64_tr_b16 a[20:21], v89 offset:16384
buffer_load_dwordx4 v33, s[16:19], s41 offen lds
v_mfma_f32_16x16x32_bf16 v[172:175], a[84:87], v[124:127], v[172:175]
ds_read_b64_tr_b16 a[22:23], v89 offset:18432
ds_read_b64_tr_b16 a[24:25], v90 offset:16384
v_mfma_f32_16x16x32_bf16 v[168:171], a[84:87], v[120:123], v[168:171]
ds_read_b64_tr_b16 a[26:27], v90 offset:18432
buffer_load_dwordx4 v34, s[16:19], s41 offen offset:1024 lds
v_mfma_f32_16x16x32_bf16 v[176:179], a[88:91], v[120:123], v[176:179]
ds_read_b64_tr_b16 a[28:29], v91 offset:16384
ds_read_b64_tr_b16 a[30:31], v91 offset:18432
v_mfma_f32_16x16x32_bf16 v[180:183], a[88:91], v[124:127], v[180:183]
ds_read_b64_tr_b16 a[32:33], v84 offset:16640
buffer_load_dwordx4 v35, s[16:19], s41 offen offset:2048 lds
v_mfma_f32_16x16x32_bf16 v[188:191], a[92:95], v[124:127], v[188:191]
ds_read_b64_tr_b16 a[34:35], v84 offset:18688
ds_read_b64_tr_b16 a[36:37], v85 offset:16640
v_mfma_f32_16x16x32_bf16 v[184:187], a[92:95], v[120:123], v[184:187]
ds_read_b64_tr_b16 a[38:39], v85 offset:18688
buffer_load_dwordx4 v36, s[16:19], s41 offen offset:3072 lds
v_mfma_f32_16x16x32_bf16 v[192:195], a[96:99], v[120:123], v[192:195]
ds_read_b64_tr_b16 a[40:41], v86 offset:16640
ds_read_b64_tr_b16 a[42:43], v86 offset:18688
v_mfma_f32_16x16x32_bf16 v[196:199], a[96:99], v[124:127], v[196:199]
ds_read_b64_tr_b16 a[44:45], v87 offset:16640
s_add_u32 s41, s41, 262144
v_mfma_f32_16x16x32_bf16 v[204:207], a[100:103], v[124:127], v[204:207]
ds_read_b64_tr_b16 a[46:47], v87 offset:18688
ds_read_b64_tr_b16 a[48:49], v88 offset:16640
v_mfma_f32_16x16x32_bf16 v[200:203], a[100:103], v[120:123], v[200:203]
ds_read_b64_tr_b16 a[50:51], v88 offset:18688
buffer_load_dwordx4 a[192:195], v29, s[12:15], s43 offen nt
v_mfma_f32_16x16x32_bf16 v[208:211], a[104:107], v[120:123], v[208:211]
ds_read_b64_tr_b16 a[52:53], v89 offset:16640
ds_read_b64_tr_b16 a[54:55], v89 offset:18688
v_mfma_f32_16x16x32_bf16 v[212:215], a[104:107], v[124:127], v[212:215]
ds_read_b64_tr_b16 a[56:57], v90 offset:16640
v_mfma_f32_16x16x32_bf16 v[220:223], a[108:111], v[124:127], v[220:223]
ds_read_b64_tr_b16 a[58:59], v90 offset:18688
ds_read_b64_tr_b16 a[60:61], v91 offset:16640
v_mfma_f32_16x16x32_bf16 v[216:219], a[108:111], v[120:123], v[216:219]
ds_read_b64_tr_b16 a[62:63], v91 offset:18688
buffer_load_dwordx4 a[196:199], v30, s[12:15], s43 offen offset:1024 nt
v_mfma_f32_16x16x32_bf16 v[224:227], a[112:115], v[120:123], v[224:227]
buffer_load_dwordx4 a[200:203], v31, s[12:15], s43 offen offset:2048 nt
v_mfma_f32_16x16x32_bf16 v[228:231], a[112:115], v[124:127], v[228:231]
v_mfma_f32_16x16x32_bf16 v[236:239], a[116:119], v[124:127], v[236:239]
buffer_load_dwordx4 a[204:207], v32, s[12:15], s43 offen offset:3072 nt
s_add_u32 s43, s43, 16384
v_mfma_f32_16x16x32_bf16 v[232:235], a[116:119], v[120:123], v[232:235]
s_and_b32 s43, s43, 0x3ffff
v_mfma_f32_16x16x32_bf16 v[240:243], a[120:123], v[120:123], v[240:243]
v_mfma_f32_16x16x32_bf16 v[244:247], a[120:123], v[124:127], v[244:247]
v_mfma_f32_16x16x32_bf16 v[252:255], a[124:127], v[124:127], v[252:255]
v_mfma_f32_16x16x32_bf16 v[248:251], a[124:127], v[120:123], v[248:251]
s_waitcnt vmcnt(4) lgkmcnt(0)
s_barrier
v_mfma_f32_16x16x32_bf16 v[128:131], a[0:3], v[96:99], v[128:131]
ds_read_b64_tr_b16 a[64:65], v74 offset:49152
ds_read_b64_tr_b16 a[66:67], v74 offset:51200
v_mfma_f32_16x16x32_bf16 v[132:135], a[0:3], v[100:103], v[132:135]
ds_read_b64_tr_b16 a[68:69], v75 offset:49152
s_add_u32 m0, s33, 147456
v_mfma_f32_16x16x32_bf16 v[140:143], a[4:7], v[100:103], v[140:143]
ds_read_b64_tr_b16 a[70:71], v75 offset:51200
buffer_load_dwordx4 v33, s[16:19], s41 offen lds
v_mfma_f32_16x16x32_bf16 v[136:139], a[4:7], v[96:99], v[136:139]
ds_read_b64_tr_b16 a[72:73], v76 offset:49152
ds_read_b64_tr_b16 a[74:75], v76 offset:51200
v_mfma_f32_16x16x32_bf16 v[144:147], a[8:11], v[96:99], v[144:147]
ds_read_b64_tr_b16 a[76:77], v77 offset:49152
v_mfma_f32_16x16x32_bf16 v[148:151], a[8:11], v[100:103], v[148:151]
ds_read_b64_tr_b16 a[78:79], v77 offset:51200
buffer_load_dwordx4 v34, s[16:19], s41 offen offset:1024 lds
v_mfma_f32_16x16x32_bf16 v[156:159], a[12:15], v[100:103], v[156:159]
ds_read_b64_tr_b16 a[80:81], v78 offset:49152
ds_read_b64_tr_b16 a[82:83], v78 offset:51200
v_mfma_f32_16x16x32_bf16 v[152:155], a[12:15], v[96:99], v[152:155]
ds_read_b64_tr_b16 a[84:85], v79 offset:49152
v_mfma_f32_16x16x32_bf16 v[160:163], a[16:19], v[96:99], v[160:163]
ds_read_b64_tr_b16 a[86:87], v79 offset:51200
v_mfma_f32_16x16x32_bf16 v[164:167], a[16:19], v[100:103], v[164:167]
ds_read_b64_tr_b16 a[88:89], v80 offset:49152
ds_read_b64_tr_b16 a[90:91], v80 offset:51200
v_mfma_f32_16x16x32_bf16 v[172:175], a[20:23], v[100:103], v[172:175]
ds_read_b64_tr_b16 a[92:93], v81 offset:49152
buffer_load_dwordx4 v35, s[16:19], s41 offen offset:2048 lds
v_mfma_f32_16x16x32_bf16 v[168:171], a[20:23], v[96:99], v[168:171]
ds_read_b64_tr_b16 a[94:95], v81 offset:51200
v_mfma_f32_16x16x32_bf16 v[176:179], a[24:27], v[96:99], v[176:179]
ds_read_b64_tr_b16 a[96:97], v74 offset:49408
ds_read_b64_tr_b16 a[98:99], v74 offset:51456
v_mfma_f32_16x16x32_bf16 v[180:183], a[24:27], v[100:103], v[180:183]
ds_read_b64_tr_b16 a[100:101], v75 offset:49408
v_mfma_f32_16x16x32_bf16 v[188:191], a[28:31], v[100:103], v[188:191]
ds_read_b64_tr_b16 a[102:103], v75 offset:51456
v_mfma_f32_16x16x32_bf16 v[184:187], a[28:31], v[96:99], v[184:187]
ds_read_b64_tr_b16 a[104:105], v76 offset:49408
ds_read_b64_tr_b16 a[106:107], v76 offset:51456
v_mfma_f32_16x16x32_bf16 v[192:195], a[32:35], v[96:99], v[192:195]
ds_read_b64_tr_b16 a[108:109], v77 offset:49408
buffer_load_dwordx4 v36, s[16:19], s41 offen offset:3072 lds
v_mfma_f32_16x16x32_bf16 v[196:199], a[32:35], v[100:103], v[196:199]
ds_read_b64_tr_b16 a[110:111], v77 offset:51456
s_add_u32 s41, s41, 262144
v_mfma_f32_16x16x32_bf16 v[204:207], a[36:39], v[100:103], v[204:207]
ds_read_b64_tr_b16 a[112:113], v78 offset:49408
ds_read_b64_tr_b16 a[114:115], v78 offset:51456
s_cmp_eq_u32 s41, 3670016
s_cselect_b32 s41, 0, s41
v_mfma_f32_16x16x32_bf16 v[200:203], a[36:39], v[96:99], v[200:203]
ds_read_b64_tr_b16 a[116:117], v79 offset:49408
s_add_u32 m0, s33, 98304
v_mfma_f32_16x16x32_bf16 v[208:211], a[40:43], v[96:99], v[208:211]
ds_read_b64_tr_b16 a[118:119], v79 offset:51456
buffer_load_dwordx4 v25, s[8:11], s42 offen nt lds
v_mfma_f32_16x16x32_bf16 v[212:215], a[40:43], v[100:103], v[212:215]
ds_read_b64_tr_b16 a[120:121], v80 offset:49408
ds_read_b64_tr_b16 a[122:123], v80 offset:51456
v_mfma_f32_16x16x32_bf16 v[220:223], a[44:47], v[100:103], v[220:223]
ds_read_b64_tr_b16 a[124:125], v81 offset:49408
v_mfma_f32_16x16x32_bf16 v[216:219], a[44:47], v[96:99], v[216:219]
ds_read_b64_tr_b16 a[126:127], v81 offset:51456
v_mfma_f32_16x16x32_bf16 v[224:227], a[48:51], v[96:99], v[224:227]
buffer_load_dwordx4 v26, s[8:11], s42 offen offset:1024 nt lds
v_mfma_f32_16x16x32_bf16 v[228:231], a[48:51], v[100:103], v[228:231]
v_mfma_f32_16x16x32_bf16 v[236:239], a[52:55], v[100:103], v[236:239]
v_mfma_f32_16x16x32_bf16 v[232:235], a[52:55], v[96:99], v[232:235]
v_mfma_f32_16x16x32_bf16 v[240:243], a[56:59], v[96:99], v[240:243]
v_mfma_f32_16x16x32_bf16 v[244:247], a[56:59], v[100:103], v[244:247]
v_mfma_f32_16x16x32_bf16 v[252:255], a[60:63], v[100:103], v[252:255]
v_mfma_f32_16x16x32_bf16 v[248:251], a[60:63], v[96:99], v[248:251]
s_waitcnt vmcnt(4) lgkmcnt(0)
s_barrier
v_mfma_f32_16x16x32_bf16 v[128:131], a[64:67], v[104:107], v[128:131]
ds_read_b128 v[112:115], v72 offset:49152
ds_read_b128 v[116:119], v72 offset:51200
v_mfma_f32_16x16x32_bf16 v[132:135], a[64:67], v[108:111], v[132:135]
ds_read_b128 v[120:123], v73 offset:49152
buffer_load_dwordx4 v27, s[8:11], s42 offen offset:2048 nt lds
v_mfma_f32_16x16x32_bf16 v[140:143], a[68:71], v[108:111], v[140:143]
ds_read_b128 v[124:127], v73 offset:51200
ds_read_b64_tr_b16 a[0:1], v84 offset:0
v_mfma_f32_16x16x32_bf16 v[136:139], a[68:71], v[104:107], v[136:139]
ds_read_b64_tr_b16 a[2:3], v84 offset:2048
v_mfma_f32_16x16x32_bf16 v[144:147], a[72:75], v[104:107], v[144:147]
ds_read_b64_tr_b16 a[4:5], v85 offset:0
ds_read_b64_tr_b16 a[6:7], v85 offset:2048
v_mfma_f32_16x16x32_bf16 v[148:151], a[72:75], v[108:111], v[148:151]
ds_read_b64_tr_b16 a[8:9], v86 offset:0
v_mfma_f32_16x16x32_bf16 v[156:159], a[76:79], v[108:111], v[156:159]
ds_read_b64_tr_b16 a[10:11], v86 offset:2048
ds_read_b64_tr_b16 a[12:13], v87 offset:0
v_mfma_f32_16x16x32_bf16 v[152:155], a[76:79], v[104:107], v[152:155]
ds_read_b64_tr_b16 a[14:15], v87 offset:2048
v_mfma_f32_16x16x32_bf16 v[160:163], a[80:83], v[104:107], v[160:163]
ds_read_b64_tr_b16 a[16:17], v88 offset:0
ds_read_b64_tr_b16 a[18:19], v88 offset:2048
v_mfma_f32_16x16x32_bf16 v[164:167], a[80:83], v[108:111], v[164:167]
ds_read_b64_tr_b16 a[20:21], v89 offset:0
v_mfma_f32_16x16x32_bf16 v[172:175], a[84:87], v[108:111], v[172:175]
ds_read_b64_tr_b16 a[22:23], v89 offset:2048
ds_read_b64_tr_b16 a[24:25], v90 offset:0
v_mfma_f32_16x16x32_bf16 v[168:171], a[84:87], v[104:107], v[168:171]
ds_read_b64_tr_b16 a[26:27], v90 offset:2048
buffer_load_dwordx4 v28, s[8:11], s42 offen offset:3072 nt lds
v_mfma_f32_16x16x32_bf16 v[176:179], a[88:91], v[104:107], v[176:179]
ds_read_b64_tr_b16 a[28:29], v91 offset:0
ds_read_b64_tr_b16 a[30:31], v91 offset:2048
v_mfma_f32_16x16x32_bf16 v[180:183], a[88:91], v[108:111], v[180:183]
ds_read_b64_tr_b16 a[32:33], v84 offset:256
s_add_u32 s42, s42, 16384
v_mfma_f32_16x16x32_bf16 v[188:191], a[92:95], v[108:111], v[188:191]
ds_read_b64_tr_b16 a[34:35], v84 offset:2304
ds_read_b64_tr_b16 a[36:37], v85 offset:256
s_and_b32 s42, s42, 0x3ffff
v_mfma_f32_16x16x32_bf16 v[184:187], a[92:95], v[104:107], v[184:187]
ds_read_b64_tr_b16 a[38:39], v85 offset:2304
v_mfma_f32_16x16x32_bf16 v[192:195], a[96:99], v[104:107], v[192:195]
ds_read_b64_tr_b16 a[40:41], v86 offset:256
ds_read_b64_tr_b16 a[42:43], v86 offset:2304
v_mfma_f32_16x16x32_bf16 v[196:199], a[96:99], v[108:111], v[196:199]
ds_read_b64_tr_b16 a[44:45], v87 offset:256
v_mfma_f32_16x16x32_bf16 v[204:207], a[100:103], v[108:111], v[204:207]
ds_read_b64_tr_b16 a[46:47], v87 offset:2304
ds_read_b64_tr_b16 a[48:49], v88 offset:256
v_mfma_f32_16x16x32_bf16 v[200:203], a[100:103], v[104:107], v[200:203]
ds_read_b64_tr_b16 a[50:51], v88 offset:2304
s_add_u32 m0, s33, 114688
v_mfma_f32_16x16x32_bf16 v[208:211], a[104:107], v[104:107], v[208:211]
ds_read_b64_tr_b16 a[52:53], v89 offset:256
ds_read_b64_tr_b16 a[54:55], v89 offset:2304
v_mfma_f32_16x16x32_bf16 v[212:215], a[104:107], v[108:111], v[212:215]
ds_read_b64_tr_b16 a[56:57], v90 offset:256
v_mfma_f32_16x16x32_bf16 v[220:223], a[108:111], v[108:111], v[220:223]
ds_read_b64_tr_b16 a[58:59], v90 offset:2304
ds_read_b64_tr_b16 a[60:61], v91 offset:256
buffer_load_dwordx4 v29, s[12:15], s43 offen nt lds
v_mfma_f32_16x16x32_bf16 v[216:219], a[108:111], v[104:107], v[216:219]
ds_read_b64_tr_b16 a[62:63], v91 offset:2304
v_mfma_f32_16x16x32_bf16 v[224:227], a[112:115], v[104:107], v[224:227]
v_mfma_f32_16x16x32_bf16 v[228:231], a[112:115], v[108:111], v[228:231]
v_mfma_f32_16x16x32_bf16 v[236:239], a[116:119], v[108:111], v[236:239]
v_mfma_f32_16x16x32_bf16 v[232:235], a[116:119], v[104:107], v[232:235]
v_mfma_f32_16x16x32_bf16 v[240:243], a[120:123], v[104:107], v[240:243]
v_mfma_f32_16x16x32_bf16 v[244:247], a[120:123], v[108:111], v[244:247]
v_mfma_f32_16x16x32_bf16 v[252:255], a[124:127], v[108:111], v[252:255]
v_mfma_f32_16x16x32_bf16 v[248:251], a[124:127], v[104:107], v[248:251]
s_waitcnt vmcnt(4) lgkmcnt(0)
s_barrier
v_mfma_f32_16x16x32_bf16 v[128:131], a[0:3], v[112:115], v[128:131]
ds_read_b64_tr_b16 a[64:65], v84 offset:16384
ds_read_b64_tr_b16 a[66:67], v84 offset:18432
v_mfma_f32_16x16x32_bf16 v[132:135], a[0:3], v[116:119], v[132:135]
ds_read_b64_tr_b16 a[68:69], v85 offset:16384
buffer_load_dwordx4 v30, s[12:15], s43 offen offset:1024 nt lds
v_mfma_f32_16x16x32_bf16 v[140:143], a[4:7], v[116:119], v[140:143]
ds_read_b64_tr_b16 a[70:71], v85 offset:18432
v_mfma_f32_16x16x32_bf16 v[136:139], a[4:7], v[112:115], v[136:139]
ds_read_b64_tr_b16 a[72:73], v86 offset:16384
ds_read_b64_tr_b16 a[74:75], v86 offset:18432
v_mfma_f32_16x16x32_bf16 v[144:147], a[8:11], v[112:115], v[144:147]
ds_read_b64_tr_b16 a[76:77], v87 offset:16384
v_mfma_f32_16x16x32_bf16 v[148:151], a[8:11], v[116:119], v[148:151]
ds_read_b64_tr_b16 a[78:79], v87 offset:18432
v_mfma_f32_16x16x32_bf16 v[156:159], a[12:15], v[116:119], v[156:159]
ds_read_b64_tr_b16 a[80:81], v88 offset:16384
ds_read_b64_tr_b16 a[82:83], v88 offset:18432
v_mfma_f32_16x16x32_bf16 v[152:155], a[12:15], v[112:115], v[152:155]
ds_read_b64_tr_b16 a[84:85], v89 offset:16384
v_mfma_f32_16x16x32_bf16 v[160:163], a[16:19], v[112:115], v[160:163]
ds_read_b64_tr_b16 a[86:87], v89 offset:18432
v_mfma_f32_16x16x32_bf16 v[164:167], a[16:19], v[116:119], v[164:167]
ds_read_b64_tr_b16 a[88:89], v90 offset:16384
ds_read_b64_tr_b16 a[90:91], v90 offset:18432
v_mfma_f32_16x16x32_bf16 v[172:175], a[20:23], v[116:119], v[172:175]
ds_read_b64_tr_b16 a[92:93], v91 offset:16384
buffer_load_dwordx4 v31, s[12:15], s43 offen offset:2048 nt lds
v_mfma_f32_16x16x32_bf16 v[168:171], a[20:23], v[112:115], v[168:171]
ds_read_b64_tr_b16 a[94:95], v91 offset:18432
v_mfma_f32_16x16x32_bf16 v[176:179], a[24:27], v[112:115], v[176:179]
ds_read_b64_tr_b16 a[96:97], v84 offset:16640
ds_read_b64_tr_b16 a[98:99], v84 offset:18688
v_mfma_f32_16x16x32_bf16 v[180:183], a[24:27], v[116:119], v[180:183]
ds_read_b64_tr_b16 a[100:101], v85 offset:16640
v_mfma_f32_16x16x32_bf16 v[188:191], a[28:31], v[116:119], v[188:191]
ds_read_b64_tr_b16 a[102:103], v85 offset:18688
v_mfma_f32_16x16x32_bf16 v[184:187], a[28:31], v[112:115], v[184:187]
ds_read_b64_tr_b16 a[104:105], v86 offset:16640
ds_read_b64_tr_b16 a[106:107], v86 offset:18688
v_mfma_f32_16x16x32_bf16 v[192:195], a[32:35], v[112:115], v[192:195]
ds_read_b64_tr_b16 a[108:109], v87 offset:16640
v_mfma_f32_16x16x32_bf16 v[196:199], a[32:35], v[116:119], v[196:199]
ds_read_b64_tr_b16 a[110:111], v87 offset:18688
v_mfma_f32_16x16x32_bf16 v[204:207], a[36:39], v[116:119], v[204:207]
ds_read_b64_tr_b16 a[112:113], v88 offset:16640
ds_read_b64_tr_b16 a[114:115], v88 offset:18688
v_mfma_f32_16x16x32_bf16 v[200:203], a[36:39], v[112:115], v[200:203]
ds_read_b64_tr_b16 a[116:117], v89 offset:16640
buffer_load_dwordx4 v32, s[12:15], s43 offen offset:3072 nt lds
v_mfma_f32_16x16x32_bf16 v[208:211], a[40:43], v[112:115], v[208:211]
ds_read_b64_tr_b16 a[118:119], v89 offset:18688
s_add_u32 s43, s43, 16384
v_mfma_f32_16x16x32_bf16 v[212:215], a[40:43], v[116:119], v[212:215]
ds_read_b64_tr_b16 a[120:121], v90 offset:16640
ds_read_b64_tr_b16 a[122:123], v90 offset:18688
v_mfma_f32_16x16x32_bf16 v[220:223], a[44:47], v[116:119], v[220:223]
ds_read_b64_tr_b16 a[124:125], v91 offset:16640
s_and_b32 s43, s43, 0x3ffff
v_mfma_f32_16x16x32_bf16 v[216:219], a[44:47], v[112:115], v[216:219]
ds_read_b64_tr_b16 a[126:127], v91 offset:18688
v_mfma_f32_16x16x32_bf16 v[224:227], a[48:51], v[112:115], v[224:227]
v_mfma_f32_16x16x32_bf16 v[228:231], a[48:51], v[116:119], v[228:231]
v_mfma_f32_16x16x32_bf16 v[236:239], a[52:55], v[116:119], v[236:239]
v_mfma_f32_16x16x32_bf16 v[232:235], a[52:55], v[112:115], v[232:235]
v_mfma_f32_16x16x32_bf16 v[240:243], a[56:59], v[112:115], v[240:243]
v_mfma_f32_16x16x32_bf16 v[244:247], a[56:59], v[116:119], v[244:247]
v_mfma_f32_16x16x32_bf16 v[252:255], a[60:63], v[116:119], v[252:255]
v_mfma_f32_16x16x32_bf16 v[248:251], a[60:63], v[112:115], v[248:251]
s_waitcnt vmcnt(4) lgkmcnt(0)
s_barrier
v_mfma_f32_16x16x32_bf16 v[128:131], a[64:67], v[120:123], v[128:131]
ds_read_b128 a[0:3], v1 offset:0
s_add_u32 m0, s33, 49152
v_mfma_f32_16x16x32_bf16 v[132:135], a[64:67], v[124:127], v[132:135]
ds_read_b128 a[32:35], v1 offset:8192
buffer_load_dwordx4 v25, s[8:11], s42 offen nt lds
v_mfma_f32_16x16x32_bf16 v[140:143], a[68:71], v[124:127], v[140:143]
ds_read_b128 a[4:7], v2 offset:0
v_mov_b32 v39, 0
v_mov_b32 v40, 1
v_mfma_f32_16x16x32_bf16 v[136:139], a[68:71], v[120:123], v[136:139]
ds_read_b128 a[36:39], v2 offset:8192
v_mfma_f32_16x16x32_bf16 v[144:147], a[72:75], v[120:123], v[144:147]
ds_read_b128 a[8:11], v3 offset:0
v_mfma_f32_16x16x32_bf16 v[148:151], a[72:75], v[124:127], v[148:151]
ds_read_b128 a[40:43], v3 offset:8192
v_mfma_f32_16x16x32_bf16 v[156:159], a[76:79], v[124:127], v[156:159]
ds_read_b128 a[12:15], v4 offset:0
v_mfma_f32_16x16x32_bf16 v[152:155], a[76:79], v[120:123], v[152:155]
ds_read_b128 a[44:47], v4 offset:8192
v_cvt_pk_bf16_f32 v104, v128, v129
v_cvt_pk_bf16_f32 v105, v130, v131
v_mfma_f32_16x16x32_bf16 v[160:163], a[80:83], v[120:123], v[160:163]
ds_read_b128 a[16:19], v1 offset:256
v_cvt_pk_bf16_f32 v106, v136, v137
v_cvt_pk_bf16_f32 v107, v138, v139
v_mfma_f32_16x16x32_bf16 v[164:167], a[80:83], v[124:127], v[164:167]
ds_read_b128 a[48:51], v1 offset:8448
v_cvt_pk_bf16_f32 v108, v132, v133
v_cvt_pk_bf16_f32 v109, v134, v135
v_mfma_f32_16x16x32_bf16 v[172:175], a[84:87], v[124:127], v[172:175]
ds_read_b128 a[20:23], v2 offset:256
buffer_load_dwordx4 v26, s[8:11], s42 offen offset:1024 nt lds
L_pad3:
s_cbranch_execz L_hr0
v_mfma_f32_16x16x32_bf16 v[168:171], a[84:87], v[120:123], v[168:171]
ds_read_b128 a[52:55], v2 offset:8448
v_cvt_pk_bf16_f32 v110, v140, v141
v_cvt_pk_bf16_f32 v111, v142, v143
v_mfma_f32_16x16x32_bf16 v[176:179], a[88:91], v[120:123], v[176:179]
ds_read_b128 a[24:27], v3 offset:256
v_permlane16_swap_b32 v104, v106
v_permlane16_swap_b32 v105, v107
v_mfma_f32_16x16x32_bf16 v[180:183], a[88:91], v[124:127], v[180:183]
ds_read_b128 a[56:59], v3 offset:8448
v_permlane16_swap_b32 v108, v110
v_permlane16_swap_b32 v109, v111
v_mfma_f32_16x16x32_bf16 v[188:191], a[92:95], v[124:127], v[188:191]
ds_read_b128 a[28:31], v4 offset:256
v_cvt_pk_bf16_f32 v136, v144, v145
v_cvt_pk_bf16_f32 v137, v146, v147
v_mfma_f32_16x16x32_bf16 v[184:187], a[92:95], v[120:123], v[184:187]
ds_read_b128 a[60:63], v4 offset:8448
v_cvt_pk_bf16_f32 v138, v152, v153
v_cvt_pk_bf16_f32 v139, v154, v155
v_mfma_f32_16x16x32_bf16 v[192:195], a[96:99], v[120:123], v[192:195]
v_cvt_pk_bf16_f32 v140, v148, v149
v_cvt_pk_bf16_f32 v141, v150, v151
v_cvt_pk_bf16_f32 v142, v156, v157
v_mfma_f32_16x16x32_bf16 v[196:199], a[96:99], v[124:127], v[196:199]
v_cvt_pk_bf16_f32 v143, v158, v159
v_permlane16_swap_b32 v136, v138
v_permlane16_swap_b32 v137, v139
v_mfma_f32_16x16x32_bf16 v[204:207], a[100:103], v[124:127], v[204:207]
v_permlane16_swap_b32 v140, v142
v_permlane16_swap_b32 v141, v143
v_cvt_pk_bf16_f32 v144, v160, v161
v_mfma_f32_16x16x32_bf16 v[200:203], a[100:103], v[120:123], v[200:203]
buffer_load_dwordx4 v27, s[8:11], s42 offen offset:2048 nt lds
v_cvt_pk_bf16_f32 v145, v162, v163
v_cvt_pk_bf16_f32 v146, v168, v169
v_mfma_f32_16x16x32_bf16 v[208:211], a[104:107], v[120:123], v[208:211]
v_cvt_pk_bf16_f32 v147, v170, v171
v_cvt_pk_bf16_f32 v148, v164, v165
v_cvt_pk_bf16_f32 v149, v166, v167
v_mfma_f32_16x16x32_bf16 v[212:215], a[104:107], v[124:127], v[212:215]
v_cvt_pk_bf16_f32 v150, v172, v173
v_cvt_pk_bf16_f32 v151, v174, v175
v_permlane16_swap_b32 v144, v146
v_mfma_f32_16x16x32_bf16 v[220:223], a[108:111], v[124:127], v[220:223]
v_permlane16_swap_b32 v145, v147
v_permlane16_swap_b32 v148, v150
v_permlane16_swap_b32 v149, v151
v_mfma_f32_16x16x32_bf16 v[216:219], a[108:111], v[120:123], v[216:219]
v_cvt_pk_bf16_f32 v152, v176, v177
v_cvt_pk_bf16_f32 v153, v178, v179
v_cvt_pk_bf16_f32 v154, v184, v185
v_mfma_f32_16x16x32_bf16 v[224:227], a[112:115], v[120:123], v[224:227]
v_cvt_pk_bf16_f32 v155, v186, v187
v_cvt_pk_bf16_f32 v156, v180, v181
v_cvt_pk_bf16_f32 v157, v182, v183
v_mfma_f32_16x16x32_bf16 v[228:231], a[112:115], v[124:127], v[228:231]
v_cvt_pk_bf16_f32 v158, v188, v189
v_cvt_pk_bf16_f32 v159, v190, v191
v_permlane16_swap_b32 v152, v154
v_mfma_f32_16x16x32_bf16 v[236:239], a[116:119], v[124:127], v[236:239]
v_permlane16_swap_b32 v153, v155
v_permlane16_swap_b32 v156, v158
v_permlane16_swap_b32 v157, v159
v_mfma_f32_16x16x32_bf16 v[232:235], a[116:119], v[120:123], v[232:235]
v_cvt_pk_bf16_f32 v160, v192, v193
v_cvt_pk_bf16_f32 v161, v194, v195
v_cvt_pk_bf16_f32 v162, v200, v201
v_mfma_f32_16x16x32_bf16 v[240:243], a[120:123], v[120:123], v[240:243]
v_cvt_pk_bf16_f32 v163, v202, v203
v_cvt_pk_bf16_f32 v164, v196, v197
v_cvt_pk_bf16_f32 v165, v198, v199
v_mfma_f32_16x16x32_bf16 v[244:247], a[120:123], v[124:127], v[244:247]
v_cvt_pk_bf16_f32 v166, v204, v205
v_cvt_pk_bf16_f32 v167, v206, v207
v_permlane16_swap_b32 v160, v162
v_mfma_f32_16x16x32_bf16 v[252:255], a[124:127], v[124:127], v[252:255]
v_permlane16_swap_b32 v161, v163
v_permlane16_swap_b32 v164, v166
v_permlane16_swap_b32 v165, v167
v_mfma_f32_16x16x32_bf16 v[248:251], a[124:127], v[120:123], v[248:251]
v_cvt_pk_bf16_f32 v168, v208, v209
v_cvt_pk_bf16_f32 v169, v210, v211
s_waitcnt vmcnt(4) lgkmcnt(0)
s_barrier
v_mfma_f32_16x16x32_bf16 v[64:67], a[0:3], v[104:107], 0
ds_read_b128 a[64:67], v1 offset:16384
v_cvt_pk_bf16_f32 v170, v216, v217
v_cvt_pk_bf16_f32 v171, v218, v219
v_mfma_f32_16x16x32_bf16 v[72:75], a[0:3], v[108:111], 0
ds_read_b128 a[68:71], v2 offset:16384
buffer_load_dwordx4 v28, s[8:11], s42 offen offset:3072 nt lds
v_mfma_f32_16x16x32_bf16 v[68:71], a[32:35], v[104:107], 0
ds_read_b128 a[72:75], v3 offset:16384
s_add_u32 s42, s42, 16384
v_cvt_pk_bf16_f32 v172, v212, v213
v_mfma_f32_16x16x32_bf16 v[76:79], a[32:35], v[108:111], 0
ds_read_b128 a[76:79], v4 offset:16384
s_and_b32 s42, s42, 0x3ffff
v_cvt_pk_bf16_f32 v173, v214, v215
v_mfma_f32_16x16x32_bf16 v[64:67], a[4:7], v[136:139], v[64:67]
ds_read_b128 a[80:83], v1 offset:16640
v_cvt_pk_bf16_f32 v174, v220, v221
v_cvt_pk_bf16_f32 v175, v222, v223
v_mfma_f32_16x16x32_bf16 v[72:75], a[4:7], v[140:143], v[72:75]
ds_read_b128 a[84:87], v2 offset:16640
v_permlane16_swap_b32 v168, v170
v_permlane16_swap_b32 v169, v171
v_mfma_f32_16x16x32_bf16 v[68:71], a[36:39], v[136:139], v[68:71]
ds_read_b128 a[88:91], v3 offset:16640
v_permlane16_swap_b32 v172, v174
v_permlane16_swap_b32 v173, v175
v_mfma_f32_16x16x32_bf16 v[76:79], a[36:39], v[140:143], v[76:79]
ds_read_b128 a[92:95], v4 offset:16640
v_cvt_pk_bf16_f32 v176, v224, v225
v_cvt_pk_bf16_f32 v177, v226, v227
v_mfma_f32_16x16x32_bf16 v[64:67], a[8:11], v[144:147], v[64:67]
ds_read_b128 a[96:99], v1 offset:24576
v_cvt_pk_bf16_f32 v178, v232, v233
v_cvt_pk_bf16_f32 v179, v234, v235
v_mfma_f32_16x16x32_bf16 v[72:75], a[8:11], v[148:151], v[72:75]
ds_read_b128 a[100:103], v2 offset:24576
v_cvt_pk_bf16_f32 v180, v228, v229
v_cvt_pk_bf16_f32 v181, v230, v231
v_mfma_f32_16x16x32_bf16 v[68:71], a[40:43], v[144:147], v[68:71]
ds_read_b128 a[104:107], v3 offset:24576
v_cvt_pk_bf16_f32 v182, v236, v237
v_cvt_pk_bf16_f32 v183, v238, v239
v_mfma_f32_16x16x32_bf16 v[76:79], a[40:43], v[148:151], v[76:79]
ds_read_b128 a[108:111], v4 offset:24576
v_permlane16_swap_b32 v176, v178
v_permlane16_swap_b32 v177, v179
v_mfma_f32_16x16x32_bf16 v[64:67], a[12:15], v[152:155], v[64:67]
ds_read_b128 a[112:115], v1 offset:24832
v_permlane16_swap_b32 v180, v182
v_permlane16_swap_b32 v181, v183
v_mfma_f32_16x16x32_bf16 v[72:75], a[12:15], v[156:159], v[72:75]
ds_read_b128 a[116:119], v2 offset:24832
v_cvt_pk_bf16_f32 v184, v240, v241
v_cvt_pk_bf16_f32 v185, v242, v243
v_mfma_f32_16x16x32_bf16 v[68:71], a[44:47], v[152:155], v[68:71]
ds_read_b128 a[120:123], v3 offset:24832
s_add_u32 m0, s33, 131072
v_cvt_pk_bf16_f32 v186, v248, v249
v_mfma_f32_16x16x32_bf16 v[76:79], a[44:47], v[156:159], v[76:79]
ds_read_b128 a[124:127], v4 offset:24832
v_cvt_pk_bf16_f32 v187, v250, v251
v_cvt_pk_bf16_f32 v188, v244, v245
v_mfma_f32_16x16x32_bf16 v[64:67], a[16:19], v[160:163], v[64:67]
buffer_load_dwordx4 v29, s[12:15], s43 offen nt lds
v_cvt_pk_bf16_f32 v189, v246, v247
v_cvt_pk_bf16_f32 v190, v252, v253
v_mfma_f32_16x16x32_bf16 v[72:75], a[16:19], v[164:167], v[72:75]
v_cvt_pk_bf16_f32 v191, v254, v255
v_permlane16_swap_b32 v184, v186
v_permlane16_swap_b32 v185, v187
v_mfma_f32_16x16x32_bf16 v[68:71], a[48:51], v[160:163], v[68:71]
v_permlane16_swap_b32 v188, v190
v_permlane16_swap_b32 v189, v191
v_accvgpr_write_b32 a128, v104
v_mfma_f32_16x16x32_bf16 v[76:79], a[48:51], v[164:167], v[76:79]
v_accvgpr_write_b32 a129, v105
v_accvgpr_write_b32 a130, v106
v_accvgpr_write_b32 a131, v107
v_mfma_f32_16x16x32_bf16 v[64:67], a[20:23], v[168:171], v[64:67]
v_accvgpr_write_b32 a132, v108
v_accvgpr_write_b32 a133, v109
v_accvgpr_write_b32 a134, v110
v_mfma_f32_16x16x32_bf16 v[72:75], a[20:23], v[172:175], v[72:75]
v_accvgpr_write_b32 a135, v111
v_accvgpr_write_b32 a136, v136
v_accvgpr_write_b32 a137, v137
v_mfma_f32_16x16x32_bf16 v[68:71], a[52:55], v[168:171], v[68:71]
v_accvgpr_write_b32 a138, v138
v_accvgpr_write_b32 a139, v139
v_accvgpr_write_b32 a140, v140
v_mfma_f32_16x16x32_bf16 v[76:79], a[52:55], v[172:175], v[76:79]
v_accvgpr_write_b32 a141, v141
v_accvgpr_write_b32 a142, v142
v_accvgpr_write_b32 a143, v143
v_mfma_f32_16x16x32_bf16 v[64:67], a[24:27], v[176:179], v[64:67]
v_accvgpr_write_b32 a144, v144
v_accvgpr_write_b32 a145, v145
v_accvgpr_write_b32 a146, v146
v_mfma_f32_16x16x32_bf16 v[72:75], a[24:27], v[180:183], v[72:75]
v_accvgpr_write_b32 a147, v147
v_accvgpr_write_b32 a148, v148
v_accvgpr_write_b32 a149, v149
v_mfma_f32_16x16x32_bf16 v[68:71], a[56:59], v[176:179], v[68:71]
v_accvgpr_write_b32 a150, v150
v_accvgpr_write_b32 a151, v151
v_accvgpr_write_b32 a152, v152
v_mfma_f32_16x16x32_bf16 v[76:79], a[56:59], v[180:183], v[76:79]
v_accvgpr_write_b32 a153, v153
v_accvgpr_write_b32 a154, v154
v_accvgpr_write_b32 a155, v155
v_mfma_f32_16x16x32_bf16 v[64:67], a[28:31], v[184:187], v[64:67]
v_accvgpr_write_b32 a156, v156
v_accvgpr_write_b32 a157, v157
v_accvgpr_write_b32 a158, v158
v_mfma_f32_16x16x32_bf16 v[72:75], a[28:31], v[188:191], v[72:75]
v_accvgpr_write_b32 a159, v159
v_accvgpr_write_b32 a160, v160
v_accvgpr_write_b32 a161, v161
v_mfma_f32_16x16x32_bf16 v[68:71], a[60:63], v[184:187], v[68:71]
v_accvgpr_write_b32 a162, v162
v_accvgpr_write_b32 a163, v163
v_accvgpr_write_b32 a164, v164
v_mfma_f32_16x16x32_bf16 v[76:79], a[60:63], v[188:191], v[76:79]
v_accvgpr_write_b32 a165, v165
v_accvgpr_write_b32 a166, v166
s_waitcnt vmcnt(4) lgkmcnt(0)
s_barrier
v_mfma_f32_16x16x32_bf16 v[80:83], a[64:67], v[104:107], 0
ds_read_b64_tr_b16 a[60:61], v12 offset:256
v_accvgpr_write_b32 a167, v167
v_accvgpr_write_b32 a168, v168
v_mfma_f32_16x16x32_bf16 v[88:91], a[64:67], v[108:111], 0
ds_read_b64_tr_b16 a[62:63], v12 offset:8448
buffer_load_dwordx4 v30, s[12:15], s43 offen offset:1024 nt lds
v_mfma_f32_16x16x32_bf16 v[80:83], a[68:71], v[136:139], v[80:83]
ds_read_b64_tr_b16 a[56:57], v11 offset:256
v_accvgpr_write_b32 a169, v169
v_accvgpr_write_b32 a170, v170
v_mfma_f32_16x16x32_bf16 v[88:91], a[68:71], v[140:143], v[88:91]
ds_read_b64_tr_b16 a[58:59], v11 offset:8448
v_max3_f32 v47, v64, v65, v66
v_max3_f32 v47, v47, v67, v68
v_mfma_f32_16x16x32_bf16 v[80:83], a[72:75], v[144:147], v[80:83]
ds_read_b64_tr_b16 a[52:53], v10 offset:256
v_max3_f32 v47, v47, v69, v70
v_max_f32 v47, v47, v71
v_mfma_f32_16x16x32_bf16 v[88:91], a[72:75], v[148:151], v[88:91]
ds_read_b64_tr_b16 a[54:55], v10 offset:8448
v_mov_b32 v34, v47
s_nop 1
v_permlane16_swap_b32 v47, v34
v_mfma_f32_16x16x32_bf16 v[80:83], a[76:79], v[152:155], v[80:83]
ds_read_b64_tr_b16 a[48:49], v9 offset:256
v_max_f32 v47, v47, v34
v_mov_b32 v34, v47
v_mfma_f32_16x16x32_bf16 v[88:91], a[76:79], v[156:159], v[88:91]
ds_read_b64_tr_b16 a[50:51], v9 offset:8448
v_permlane32_swap_b32 v47, v34
v_max_f32 v47, v47, v34
v_mfma_f32_16x16x32_bf16 v[80:83], a[80:83], v[160:163], v[80:83]
ds_read_b64_tr_b16 a[44:45], v8 offset:256
buffer_load_dwordx4 v31, s[12:15], s43 offen offset:2048 nt lds
v_mfma_f32_16x16x32_bf16 v[88:91], a[80:83], v[164:167], v[88:91]
ds_read_b64_tr_b16 a[46:47], v8 offset:8448
v_mul_f32 v35, s48, v47
v_sub_f32 v48, 0, v47
v_mfma_f32_16x16x32_bf16 v[80:83], a[84:87], v[168:171], v[80:83]
ds_read_b64_tr_b16 a[40:41], v7 offset:256
v_sub_f32 v49, 0, v47
v_sub_f32 v50, 0, v47
v_mfma_f32_16x16x32_bf16 v[88:91], a[84:87], v[172:175], v[88:91]
ds_read_b64_tr_b16 a[42:43], v7 offset:8448
v_sub_f32 v51, 0, v47
v_max3_f32 v33, v72, v73, v74
v_mfma_f32_16x16x32_bf16 v[80:83], a[88:91], v[176:179], v[80:83]
ds_read_b64_tr_b16 a[36:37], v6 offset:256
v_max3_f32 v33, v33, v75, v76
v_max3_f32 v33, v33, v77, v78
v_mfma_f32_16x16x32_bf16 v[88:91], a[88:91], v[180:183], v[88:91]
ds_read_b64_tr_b16 a[38:39], v6 offset:8448
v_max_f32 v33, v33, v79
v_mov_b32 v34, v33
v_mfma_f32_16x16x32_bf16 v[80:83], a[92:95], v[184:187], v[80:83]
ds_read_b64_tr_b16 a[32:33], v5 offset:256
v_permlane16_swap_b32 v33, v34
v_max_f32 v33, v33, v34
v_mfma_f32_16x16x32_bf16 v[88:91], a[92:95], v[188:191], v[88:91]
ds_read_b64_tr_b16 a[34:35], v5 offset:8448
buffer_load_dwordx4 v32, s[12:15], s43 offen offset:3072 nt lds
v_mfma_f32_16x16x32_bf16 v[84:87], a[96:99], v[104:107], 0
ds_read_b64_tr_b16 a[28:29], v12 offset:0
s_add_u32 s43, s43, 16384
v_mov_b32 v34, v33
v_mfma_f32_16x16x32_bf16 v[92:95], a[96:99], v[108:111], 0
ds_read_b64_tr_b16 a[30:31], v12 offset:8192
s_and_b32 s43, s43, 0x3ffff
v_permlane32_swap_b32 v33, v34
v_mfma_f32_16x16x32_bf16 v[84:87], a[100:103], v[136:139], v[84:87]
ds_read_b64_tr_b16 a[24:25], v11 offset:0
v_max_f32 v33, v33, v34
v_mul_f32 v36, s48, v33
v_mfma_f32_16x16x32_bf16 v[92:95], a[100:103], v[140:143], v[92:95]
ds_read_b64_tr_b16 a[26:27], v11 offset:8192
v_sub_f32 v52, 0, v33
v_sub_f32 v53, 0, v33
v_mfma_f32_16x16x32_bf16 v[84:87], a[104:107], v[144:147], v[84:87]
ds_read_b64_tr_b16 a[20:21], v10 offset:0
v_sub_f32 v54, 0, v33
v_sub_f32 v55, 0, v33
v_mfma_f32_16x16x32_bf16 v[92:95], a[104:107], v[148:151], v[92:95]
ds_read_b64_tr_b16 a[22:23], v10 offset:8192
v_fma_f32 v64, v64, s48, -v35
v_fma_f32 v65, v65, s48, -v35
v_mfma_f32_16x16x32_bf16 v[84:87], a[108:111], v[152:155], v[84:87]
ds_read_b64_tr_b16 a[16:17], v9 offset:0
buffer_store_dword v39, v59, s[56:59], 0 offen sc1
v_mfma_f32_16x16x32_bf16 v[92:95], a[108:111], v[156:159], v[92:95]
ds_read_b64_tr_b16 a[18:19], v9 offset:8192
v_fma_f32 v66, v66, s48, -v35
v_fma_f32 v67, v67, s48, -v35
v_mfma_f32_16x16x32_bf16 v[84:87], a[112:115], v[160:163], v[84:87]
ds_read_b64_tr_b16 a[12:13], v8 offset:0
v_fma_f32 v68, v68, s48, -v35
v_fma_f32 v69, v69, s48, -v35
v_mfma_f32_16x16x32_bf16 v[92:95], a[112:115], v[164:167], v[92:95]
ds_read_b64_tr_b16 a[14:15], v8 offset:8192
v_fma_f32 v70, v70, s48, -v35
v_fma_f32 v71, v71, s48, -v35
v_mfma_f32_16x16x32_bf16 v[84:87], a[116:119], v[168:171], v[84:87]
ds_read_b64_tr_b16 a[8:9], v7 offset:0
v_fma_f32 v72, v72, s48, -v36
v_fma_f32 v73, v73, s48, -v36
v_mfma_f32_16x16x32_bf16 v[92:95], a[116:119], v[172:175], v[92:95]
ds_read_b64_tr_b16 a[10:11], v7 offset:8192
v_fma_f32 v74, v74, s48, -v36
v_fma_f32 v75, v75, s48, -v36
v_mfma_f32_16x16x32_bf16 v[84:87], a[120:123], v[176:179], v[84:87]
ds_read_b64_tr_b16 a[4:5], v6 offset:0
v_fma_f32 v76, v76, s48, -v36
v_fma_f32 v77, v77, s48, -v36
v_mfma_f32_16x16x32_bf16 v[92:95], a[120:123], v[180:183], v[92:95]
ds_read_b64_tr_b16 a[6:7], v6 offset:8192
v_fma_f32 v78, v78, s48, -v36
v_fma_f32 v79, v79, s48, -v36
v_mfma_f32_16x16x32_bf16 v[84:87], a[124:127], v[184:187], v[84:87]
ds_read_b64_tr_b16 a[0:1], v5 offset:0
v_exp_f32 v64, v64
v_mfma_f32_16x16x32_bf16 v[92:95], a[124:127], v[188:191], v[92:95]
ds_read_b64_tr_b16 a[2:3], v5 offset:8192
s_waitcnt vmcnt(4) lgkmcnt(8)
s_barrier
v_exp_f32 v65, v65
v_exp_f32 v66, v66
v_exp_f32 v67, v67
v_exp_f32 v68, v68
v_exp_f32 v69, v69
v_exp_f32 v70, v70
v_exp_f32 v71, v71
v_exp_f32 v72, v72
v_exp_f32 v73, v73
v_exp_f32 v74, v74
v_exp_f32 v75, v75
v_exp_f32 v76, v76
v_exp_f32 v77, v77
v_exp_f32 v78, v78
v_exp_f32 v79, v79
v_cvt_pk_bf16_f32 v112, v64, v65
v_cvt_pk_bf16_f32 v113, v66, v67
v_cvt_pk_bf16_f32 v114, v68, v69
v_cvt_pk_bf16_f32 v115, v70, v71
v_cvt_pk_bf16_f32 v116, v72, v73
v_cvt_pk_bf16_f32 v117, v74, v75
v_cvt_pk_bf16_f32 v118, v76, v77
v_cvt_pk_bf16_f32 v119, v78, v79
v_mfma_f32_16x16x32_bf16 v[96:99], a[240:243], v[112:115], 0
ds_write_b128 v13, a[208:211] offset:0
s_add_u32 m0, s33, 16384
v_mfma_f32_16x16x32_bf16 v[100:103], a[240:243], v[116:119], 0
ds_write_b128 v13, a[212:215] offset:1024
buffer_load_dwordx4 v25, s[8:11], s42 offen nt lds
v_mfma_f32_16x16x32_bf16 v[248:251], a[60:63], v[112:115], 0
ds_write_b128 v13, a[216:219] offset:2048
v_accvgpr_write_b32 a171, v171
v_mfma_f32_16x16x32_bf16 v[252:255], a[60:63], v[116:119], 0
ds_write_b128 v13, a[220:223] offset:3072
v_fma_f32 v80, v80, s48, -v35
v_mfma_f32_16x16x32_bf16 v[244:247], a[56:59], v[116:119], 0
ds_read_b128 a[64:67], v1 offset:32768
v_fma_f32 v81, v81, s48, -v35
v_mfma_f32_16x16x32_bf16 v[240:243], a[56:59], v[112:115], 0
ds_read_b128 a[68:71], v2 offset:32768
v_fma_f32 v82, v82, s48, -v35
v_mfma_f32_16x16x32_bf16 v[232:235], a[52:55], v[112:115], 0
ds_read_b128 a[72:75], v3 offset:32768
v_fma_f32 v83, v83, s48, -v35
v_mfma_f32_16x16x32_bf16 v[236:239], a[52:55], v[116:119], 0
ds_read_b128 a[76:79], v4 offset:32768
s_waitcnt lgkmcnt(8)
v_mfma_f32_16x16x32_bf16 v[228:231], a[48:51], v[116:119], 0
ds_read_b128 a[80:83], v1 offset:33024
v_fma_f32 v88, v88, s48, -v36
v_mfma_f32_16x16x32_bf16 v[224:227], a[48:51], v[112:115], 0
ds_read_b128 a[84:87], v2 offset:33024
v_fma_f32 v89, v89, s48, -v36
v_mfma_f32_16x16x32_bf16 v[216:219], a[44:47], v[112:115], 0
ds_read_b128 a[88:91], v3 offset:33024
buffer_load_dwordx4 v26, s[8:11], s42 offen offset:1024 nt lds
v_mfma_f32_16x16x32_bf16 v[220:223], a[44:47], v[116:119], 0
ds_read_b128 a[92:95], v4 offset:33024
v_fma_f32 v90, v90, s48, -v36
v_mfma_f32_16x16x32_bf16 v[212:215], a[40:43], v[116:119], 0
ds_read_b128 a[96:99], v1 offset:40960
v_fma_f32 v91, v91, s48, -v36
v_mfma_f32_16x16x32_bf16 v[208:211], a[40:43], v[112:115], 0
ds_read_b128 a[100:103], v2 offset:40960
v_max3_f32 v47, v80, v81, v82
v_mfma_f32_16x16x32_bf16 v[200:203], a[36:39], v[112:115], 0
ds_read_b128 a[104:107], v3 offset:40960
v_max3_f32 v47, v47, v83, v88
v_mfma_f32_16x16x32_bf16 v[204:207], a[36:39], v[116:119], 0
ds_read_b128 a[108:111], v4 offset:40960
v_max3_f32 v47, v47, v89, v90
v_mfma_f32_16x16x32_bf16 v[196:199], a[32:35], v[116:119], 0
ds_read_b128 a[112:115], v1 offset:41216
v_fma_f32 v84, v84, s48, -v35
v_mfma_f32_16x16x32_bf16 v[192:195], a[32:35], v[112:115], 0
ds_read_b128 a[116:119], v2 offset:41216
v_fma_f32 v85, v85, s48, -v35
v_accvgpr_write_b32 a172, v172
v_accvgpr_write_b32 a173, v173
v_accvgpr_write_b32 a174, v174
v_accvgpr_write_b32 a175, v175
v_accvgpr_write_b32 a176, v176
v_accvgpr_write_b32 a177, v177
v_accvgpr_write_b32 a178, v178
v_accvgpr_write_b32 a179, v179
v_accvgpr_write_b32 a180, v180
v_accvgpr_write_b32 a181, v181
v_accvgpr_write_b32 a182, v182
v_accvgpr_write_b32 a183, v183
v_accvgpr_write_b32 a184, v184
v_accvgpr_write_b32 a185, v185
v_accvgpr_write_b32 a186, v186
v_accvgpr_write_b32 a187, v187
v_accvgpr_write_b32 a188, v188
v_accvgpr_write_b32 a189, v189
v_accvgpr_write_b32 a190, v190
v_accvgpr_write_b32 a191, v191
v_mfma_f32_16x16x32_bf16 v[184:187], a[28:31], v[112:115], 0
ds_read_b128 a[120:123], v3 offset:41216
v_fma_f32 v86, v86, s48, -v35
v_mfma_f32_16x16x32_bf16 v[188:191], a[28:31], v[116:119], 0
ds_read_b128 a[124:127], v4 offset:41216
v_fma_f32 v87, v87, s48, -v35
v_mfma_f32_16x16x32_bf16 v[180:183], a[24:27], v[116:119], 0
buffer_load_dwordx4 v27, s[8:11], s42 offen offset:2048 nt lds
v_fma_f32 v92, v92, s48, -v36
v_mfma_f32_16x16x32_bf16 v[176:179], a[24:27], v[112:115], 0
v_fma_f32 v93, v93, s48, -v36
v_fma_f32 v94, v94, s48, -v36
v_mfma_f32_16x16x32_bf16 v[168:171], a[20:23], v[112:115], 0
v_fma_f32 v95, v95, s48, -v36
v_max3_f32 v47, v47, v91, v84
v_mfma_f32_16x16x32_bf16 v[172:175], a[20:23], v[116:119], 0
v_max3_f32 v47, v47, v85, v86
v_max3_f32 v47, v47, v87, v92
v_mfma_f32_16x16x32_bf16 v[164:167], a[16:19], v[116:119], 0
v_max3_f32 v47, v47, v93, v94
v_max_f32 v47, v47, v95
v_mfma_f32_16x16x32_bf16 v[160:163], a[16:19], v[112:115], 0
v_cmp_lt_f32 vcc, 0x41000000, v47
s_cbranch_vccnz L_r1_1
L_b1_1:
v_mfma_f32_16x16x32_bf16 v[152:155], a[12:15], v[112:115], 0
v_exp_f32 v80, v80
v_mfma_f32_16x16x32_bf16 v[156:159], a[12:15], v[116:119], 0
v_exp_f32 v81, v81
v_mfma_f32_16x16x32_bf16 v[148:151], a[8:11], v[116:119], 0
v_exp_f32 v82, v82
v_mfma_f32_16x16x32_bf16 v[144:147], a[8:11], v[112:115], 0
v_exp_f32 v83, v83
v_mfma_f32_16x16x32_bf16 v[136:139], a[4:7], v[112:115], 0
v_exp_f32 v84, v84
v_mfma_f32_16x16x32_bf16 v[140:143], a[4:7], v[116:119], 0
v_exp_f32 v85, v85
v_mfma_f32_16x16x32_bf16 v[132:135], a[0:3], v[116:119], 0
v_exp_f32 v86, v86
v_mfma_f32_16x16x32_bf16 v[128:131], a[0:3], v[112:115], 0
s_cmp_lg_u32 s51, 0
s_cbranch_scc1 L_r2_1
L_b2_1:
s_waitcnt vmcnt(4) lgkmcnt(0)
s_barrier
v_mfma_f32_16x16x32_bf16 v[64:67], a[64:67], a[128:131], v[48:51]
ds_write_b128 v14, a[192:195] offset:0
ds_write_b128 v14, a[196:199] offset:1024
v_mfma_f32_16x16x32_bf16 v[72:75], a[64:67], a[132:135], v[52:55]
ds_write_b128 v14, a[200:203] offset:2048
buffer_load_dwordx4 v28, s[8:11], s42 offen offset:3072 nt lds
v_mfma_f32_16x16x32_bf16 v[64:67], a[68:71], a[136:139], v[64:67]
ds_write_b128 v14, a[204:207] offset:3072
s_add_u32 s42, s42, 16384
v_mfma_f32_16x16x32_bf16 v[72:75], a[68:71], a[140:143], v[72:75]
ds_read_b64_tr_b16 a[0:1], v5 offset:16384
s_and_b32 s42, s42, 0x3ffff
v_mfma_f32_16x16x32_bf16 v[64:67], a[72:75], a[144:147], v[64:67]
ds_read_b64_tr_b16 a[2:3], v5 offset:24576
v_exp_f32 v87, v87
v_mfma_f32_16x16x32_bf16 v[72:75], a[72:75], a[148:151], v[72:75]
ds_read_b64_tr_b16 a[4:5], v6 offset:16384
v_exp_f32 v88, v88
v_mfma_f32_16x16x32_bf16 v[64:67], a[76:79], a[152:155], v[64:67]
ds_read_b64_tr_b16 a[6:7], v6 offset:24576
v_exp_f32 v89, v89
v_mfma_f32_16x16x32_bf16 v[72:75], a[76:79], a[156:159], v[72:75]
ds_read_b64_tr_b16 a[8:9], v7 offset:16384
v_exp_f32 v90, v90
v_mfma_f32_16x16x32_bf16 v[64:67], a[80:83], a[160:163], v[64:67]
ds_read_b64_tr_b16 a[10:11], v7 offset:24576
ds_read_b64_tr_b16 a[12:13], v8 offset:16384
v_mfma_f32_16x16x32_bf16 v[72:75], a[80:83], a[164:167], v[72:75]
ds_read_b64_tr_b16 a[14:15], v8 offset:24576
s_add_u32 m0, s33, 147456
v_mfma_f32_16x16x32_bf16 v[64:67], a[84:87], a[168:171], v[64:67]
ds_read_b64_tr_b16 a[16:17], v9 offset:16384
buffer_load_dwordx4 v29, s[12:15], s43 offen nt lds
v_mfma_f32_16x16x32_bf16 v[72:75], a[84:87], a[172:175], v[72:75]
ds_read_b64_tr_b16 a[18:19], v9 offset:24576
v_exp_f32 v91, v91
v_mfma_f32_16x16x32_bf16 v[64:67], a[88:91], a[176:179], v[64:67]
ds_read_b64_tr_b16 a[20:21], v10 offset:16384
v_exp_f32 v92, v92
v_mfma_f32_16x16x32_bf16 v[72:75], a[88:91], a[180:183], v[72:75]
ds_read_b64_tr_b16 a[22:23], v10 offset:24576
v_exp_f32 v93, v93
v_mfma_f32_16x16x32_bf16 v[64:67], a[92:95], a[184:187], v[64:67]
ds_read_b64_tr_b16 a[24:25], v11 offset:16384
v_exp_f32 v94, v94
v_mfma_f32_16x16x32_bf16 v[72:75], a[92:95], a[188:191], v[72:75]
ds_read_b64_tr_b16 a[26:27], v11 offset:24576
v_exp_f32 v95, v95
v_mfma_f32_16x16x32_bf16 v[68:71], a[96:99], a[128:131], v[48:51]
ds_read_b64_tr_b16 a[28:29], v12 offset:16384
ds_read_b64_tr_b16 a[30:31], v12 offset:24576
v_mfma_f32_16x16x32_bf16 v[76:79], a[96:99], a[132:135], v[52:55]
ds_read_b64_tr_b16 a[32:33], v5 offset:16640
v_cvt_pk_bf16_f32 v120, v80, v81
v_mfma_f32_16x16x32_bf16 v[68:71], a[100:103], a[136:139], v[68:71]
ds_read_b64_tr_b16 a[34:35], v5 offset:24832
v_cvt_pk_bf16_f32 v121, v82, v83
v_mfma_f32_16x16x32_bf16 v[76:79], a[100:103], a[140:143], v[76:79]
ds_read_b64_tr_b16 a[36:37], v6 offset:16640
buffer_load_dwordx4 v30, s[12:15], s43 offen offset:1024 nt lds
v_mfma_f32_16x16x32_bf16 v[68:71], a[104:107], a[144:147], v[68:71]
ds_read_b64_tr_b16 a[38:39], v6 offset:24832
v_cvt_pk_bf16_f32 v122, v84, v85
v_mfma_f32_16x16x32_bf16 v[76:79], a[104:107], a[148:151], v[76:79]
ds_read_b64_tr_b16 a[40:41], v7 offset:16640
v_cvt_pk_bf16_f32 v123, v86, v87
v_mfma_f32_16x16x32_bf16 v[68:71], a[108:111], a[152:155], v[68:71]
ds_read_b64_tr_b16 a[42:43], v7 offset:24832
v_cvt_pk_bf16_f32 v124, v88, v89
v_mfma_f32_16x16x32_bf16 v[76:79], a[108:111], a[156:159], v[76:79]
ds_read_b64_tr_b16 a[44:45], v8 offset:16640
v_cvt_pk_bf16_f32 v125, v90, v91
v_mfma_f32_16x16x32_bf16 v[68:71], a[112:115], a[160:163], v[68:71]
ds_read_b64_tr_b16 a[46:47], v8 offset:24832
ds_read_b64_tr_b16 a[48:49], v9 offset:16640
v_mfma_f32_16x16x32_bf16 v[76:79], a[112:115], a[164:167], v[76:79]
ds_read_b64_tr_b16 a[50:51], v9 offset:24832
v_cvt_pk_bf16_f32 v126, v92, v93
v_mfma_f32_16x16x32_bf16 v[68:71], a[116:119], a[168:171], v[68:71]
ds_read_b64_tr_b16 a[52:53], v10 offset:16640
v_cvt_pk_bf16_f32 v127, v94, v95
v_mfma_f32_16x16x32_bf16 v[76:79], a[116:119], a[172:175], v[76:79]
ds_read_b64_tr_b16 a[54:55], v10 offset:24832
v_mul_f32 v64, s48, v64
v_mfma_f32_16x16x32_bf16 v[68:71], a[120:123], a[176:179], v[68:71]
ds_read_b64_tr_b16 a[56:57], v11 offset:16640
L_pad4:
s_cbranch_execz L_hr0
v_mul_f32 v65, s48, v65
v_mfma_f32_16x16x32_bf16 v[76:79], a[120:123], a[180:183], v[76:79]
ds_read_b64_tr_b16 a[58:59], v11 offset:24832
v_mul_f32 v66, s48, v66
v_mfma_f32_16x16x32_bf16 v[68:71], a[124:127], a[184:187], v[68:71]
ds_read_b64_tr_b16 a[60:61], v12 offset:16640
v_mul_f32 v67, s48, v67
v_mfma_f32_16x16x32_bf16 v[76:79], a[124:127], a[188:191], v[76:79]
ds_read_b64_tr_b16 a[62:63], v12 offset:24832
s_waitcnt vmcnt(4) lgkmcnt(8)
s_barrier
v_mfma_f32_16x16x32_bf16 v[96:99], a[240:243], v[120:123], v[96:99]
ds_read_b128 a[64:67], v1 offset:0
v_mul_f32 v72, s48, v72
v_mfma_f32_16x16x32_bf16 v[100:103], a[240:243], v[124:127], v[100:103]
ds_read_b128 a[68:71], v2 offset:0
buffer_load_dwordx4 v31, s[12:15], s43 offen offset:2048 nt lds
v_mfma_f32_16x16x32_bf16 v[132:135], a[0:3], v[124:127], v[132:135]
ds_read_b128 a[72:75], v3 offset:0
v_mul_f32 v73, s48, v73
v_mfma_f32_16x16x32_bf16 v[128:131], a[0:3], v[120:123], v[128:131]
ds_read_b128 a[76:79], v4 offset:0
v_mul_f32 v74, s48, v74
v_mfma_f32_16x16x32_bf16 v[136:139], a[4:7], v[120:123], v[136:139]
ds_read_b128 a[80:83], v1 offset:256
v_mul_f32 v75, s48, v75
v_mfma_f32_16x16x32_bf16 v[140:143], a[4:7], v[124:127], v[140:143]
ds_read_b128 a[84:87], v2 offset:256
v_max3_f32 v47, v64, v65, v66
v_mfma_f32_16x16x32_bf16 v[148:151], a[8:11], v[124:127], v[148:151]
ds_read_b128 a[88:91], v3 offset:256
v_max3_f32 v47, v47, v67, v72
v_mfma_f32_16x16x32_bf16 v[144:147], a[8:11], v[120:123], v[144:147]
ds_read_b128 a[92:95], v4 offset:256
s_waitcnt lgkmcnt(8)
v_mfma_f32_16x16x32_bf16 v[152:155], a[12:15], v[120:123], v[152:155]
ds_read_b128 a[96:99], v1 offset:8192
buffer_load_dwordx4 v32, s[12:15], s43 offen offset:3072 nt lds
v_mfma_f32_16x16x32_bf16 v[156:159], a[12:15], v[124:127], v[156:159]
ds_read_b128 a[100:103], v2 offset:8192
s_add_u32 s43, s43, 16384
v_mfma_f32_16x16x32_bf16 v[164:167], a[16:19], v[124:127], v[164:167]
ds_read_b128 a[104:107], v3 offset:8192
s_and_b32 s43, s43, 0x3ffff
v_mfma_f32_16x16x32_bf16 v[160:163], a[16:19], v[120:123], v[160:163]
ds_read_b128 a[108:111], v4 offset:8192
v_max3_f32 v47, v47, v73, v74
v_mfma_f32_16x16x32_bf16 v[168:171], a[20:23], v[120:123], v[168:171]
ds_read_b128 a[112:115], v1 offset:8448
v_mul_f32 v68, s48, v68
v_mfma_f32_16x16x32_bf16 v[172:175], a[20:23], v[124:127], v[172:175]
ds_read_b128 a[116:119], v2 offset:8448
v_mul_f32 v69, s48, v69
v_mfma_f32_16x16x32_bf16 v[180:183], a[24:27], v[124:127], v[180:183]
ds_read_b128 a[120:123], v3 offset:8448
s_add_u32 m0, s33, 32768
v_mfma_f32_16x16x32_bf16 v[176:179], a[24:27], v[120:123], v[176:179]
ds_read_b128 a[124:127], v4 offset:8448
v_mul_f32 v70, s48, v70
v_mfma_f32_16x16x32_bf16 v[184:187], a[28:31], v[120:123], v[184:187]
buffer_load_dwordx4 v25, s[8:11], s42 offen nt lds
v_mul_f32 v71, s48, v71
v_mfma_f32_16x16x32_bf16 v[188:191], a[28:31], v[124:127], v[188:191]
v_mul_f32 v76, s48, v76
v_mul_f32 v77, s48, v77
v_mfma_f32_16x16x32_bf16 v[196:199], a[32:35], v[124:127], v[196:199]
v_mul_f32 v78, s48, v78
v_mul_f32 v79, s48, v79
v_mfma_f32_16x16x32_bf16 v[192:195], a[32:35], v[120:123], v[192:195]
v_max3_f32 v47, v47, v75, v68
v_max3_f32 v47, v47, v69, v70
v_mfma_f32_16x16x32_bf16 v[200:203], a[36:39], v[120:123], v[200:203]
v_max3_f32 v47, v47, v71, v76
v_max3_f32 v47, v47, v77, v78
v_mfma_f32_16x16x32_bf16 v[204:207], a[36:39], v[124:127], v[204:207]
v_max_f32 v47, v47, v79
v_cmp_lt_f32 vcc, 0x41000000, v47
v_mfma_f32_16x16x32_bf16 v[212:215], a[40:43], v[124:127], v[212:215]
buffer_atomic_add a252, v60, s[60:63], 0 offen sc1
s_cbranch_vccnz L_r1_2
L_b1_2:
v_mfma_f32_16x16x32_bf16 v[208:211], a[40:43], v[120:123], v[208:211]
v_exp_f32 v64, v64
v_mfma_f32_16x16x32_bf16 v[216:219], a[44:47], v[120:123], v[216:219]
v_exp_f32 v65, v65
v_mfma_f32_16x16x32_bf16 v[220:223], a[44:47], v[124:127], v[220:223]
v_exp_f32 v66, v66
v_mfma_f32_16x16x32_bf16 v[228:231], a[48:51], v[124:127], v[228:231]
v_exp_f32 v67, v67
v_mfma_f32_16x16x32_bf16 v[224:227], a[48:51], v[120:123], v[224:227]
v_exp_f32 v68, v68
v_mfma_f32_16x16x32_bf16 v[232:235], a[52:55], v[120:123], v[232:235]
v_exp_f32 v69, v69
v_mfma_f32_16x16x32_bf16 v[236:239], a[52:55], v[124:127], v[236:239]
v_exp_f32 v70, v70
v_mfma_f32_16x16x32_bf16 v[244:247], a[56:59], v[124:127], v[244:247]
v_exp_f32 v71, v71
v_mfma_f32_16x16x32_bf16 v[240:243], a[56:59], v[120:123], v[240:243]
v_exp_f32 v72, v72
v_mfma_f32_16x16x32_bf16 v[248:251], a[60:63], v[120:123], v[248:251]
v_exp_f32 v73, v73
v_mfma_f32_16x16x32_bf16 v[252:255], a[60:63], v[124:127], v[252:255]
s_cmp_lg_u32 s51, 0
s_cbranch_scc1 L_r2_2
L_b2_2:
s_waitcnt vmcnt(4) lgkmcnt(0)
s_barrier
v_mfma_f32_16x16x32_bf16 v[80:83], a[64:67], a[128:131], v[48:51]
ds_read_b64_tr_b16 a[0:1], v5 offset:0
v_add_u32 v1, 49152, v1
v_mfma_f32_16x16x32_bf16 v[88:91], a[64:67], a[132:135], v[52:55]
ds_read_b64_tr_b16 a[2:3], v5 offset:8192
buffer_load_dwordx4 v26, s[8:11], s42 offen offset:1024 nt lds
v_mfma_f32_16x16x32_bf16 v[80:83], a[68:71], a[136:139], v[80:83]
ds_read_b64_tr_b16 a[4:5], v6 offset:0
v_add_u32 v2, 49152, v2
v_mfma_f32_16x16x32_bf16 v[88:91], a[68:71], a[140:143], v[88:91]
ds_read_b64_tr_b16 a[6:7], v6 offset:8192
v_add_u32 v3, 49152, v3
v_mfma_f32_16x16x32_bf16 v[80:83], a[72:75], a[144:147], v[80:83]
ds_read_b64_tr_b16 a[8:9], v7 offset:0
v_add_u32 v4, 49152, v4
v_mfma_f32_16x16x32_bf16 v[88:91], a[72:75], a[148:151], v[88:91]
ds_read_b64_tr_b16 a[10:11], v7 offset:8192
v_exp_f32 v74, v74
v_mfma_f32_16x16x32_bf16 v[80:83], a[76:79], a[152:155], v[80:83]
ds_read_b64_tr_b16 a[12:13], v8 offset:0
v_exp_f32 v75, v75
v_mfma_f32_16x16x32_bf16 v[88:91], a[76:79], a[156:159], v[88:91]
ds_read_b64_tr_b16 a[14:15], v8 offset:8192
v_exp_f32 v76, v76
v_mfma_f32_16x16x32_bf16 v[80:83], a[80:83], a[160:163], v[80:83]
ds_read_b64_tr_b16 a[16:17], v9 offset:0
v_exp_f32 v77, v77
v_mfma_f32_16x16x32_bf16 v[88:91], a[80:83], a[164:167], v[88:91]
ds_read_b64_tr_b16 a[18:19], v9 offset:8192
v_exp_f32 v78, v78
v_mfma_f32_16x16x32_bf16 v[80:83], a[84:87], a[168:171], v[80:83]
ds_read_b64_tr_b16 a[20:21], v10 offset:0
buffer_load_dwordx4 v27, s[8:11], s42 offen offset:2048 nt lds
v_mfma_f32_16x16x32_bf16 v[88:91], a[84:87], a[172:175], v[88:91]
ds_read_b64_tr_b16 a[22:23], v10 offset:8192
v_exp_f32 v79, v79
v_mfma_f32_16x16x32_bf16 v[80:83], a[88:91], a[176:179], v[80:83]
ds_read_b64_tr_b16 a[24:25], v11 offset:0
v_cvt_pk_bf16_f32 v112, v64, v65
v_mfma_f32_16x16x32_bf16 v[88:91], a[88:91], a[180:183], v[88:91]
ds_read_b64_tr_b16 a[26:27], v11 offset:8192
v_cvt_pk_bf16_f32 v113, v66, v67
v_mfma_f32_16x16x32_bf16 v[80:83], a[92:95], a[184:187], v[80:83]
ds_read_b64_tr_b16 a[28:29], v12 offset:0
v_cvt_pk_bf16_f32 v114, v68, v69
v_mfma_f32_16x16x32_bf16 v[88:91], a[92:95], a[188:191], v[88:91]
ds_read_b64_tr_b16 a[30:31], v12 offset:8192
v_cvt_pk_bf16_f32 v115, v70, v71
v_mfma_f32_16x16x32_bf16 v[84:87], a[96:99], a[128:131], v[48:51]
ds_read_b64_tr_b16 a[32:33], v5 offset:256
v_cvt_pk_bf16_f32 v116, v72, v73
v_mfma_f32_16x16x32_bf16 v[92:95], a[96:99], a[132:135], v[52:55]
ds_read_b64_tr_b16 a[34:35], v5 offset:8448
v_cvt_pk_bf16_f32 v117, v74, v75
v_mfma_f32_16x16x32_bf16 v[84:87], a[100:103], a[136:139], v[84:87]
ds_read_b64_tr_b16 a[36:37], v6 offset:256
v_cvt_pk_bf16_f32 v118, v76, v77
v_mfma_f32_16x16x32_bf16 v[92:95], a[100:103], a[140:143], v[92:95]
ds_read_b64_tr_b16 a[38:39], v6 offset:8448
buffer_load_dwordx4 v28, s[8:11], s42 offen offset:3072 nt lds
v_mfma_f32_16x16x32_bf16 v[84:87], a[104:107], a[144:147], v[84:87]
ds_read_b64_tr_b16 a[40:41], v7 offset:256
s_add_u32 s42, s42, 16384
v_mfma_f32_16x16x32_bf16 v[92:95], a[104:107], a[148:151], v[92:95]
ds_read_b64_tr_b16 a[42:43], v7 offset:8448
s_and_b32 s42, s42, 0x3ffff
v_mfma_f32_16x16x32_bf16 v[84:87], a[108:111], a[152:155], v[84:87]
ds_read_b64_tr_b16 a[44:45], v8 offset:256
v_cvt_pk_bf16_f32 v119, v78, v79
v_mfma_f32_16x16x32_bf16 v[92:95], a[108:111], a[156:159], v[92:95]
ds_read_b64_tr_b16 a[46:47], v8 offset:8448
v_mul_f32 v80, s48, v80
v_mfma_f32_16x16x32_bf16 v[84:87], a[112:115], a[160:163], v[84:87]
ds_read_b64_tr_b16 a[48:49], v9 offset:256
v_mul_f32 v81, s48, v81
v_mfma_f32_16x16x32_bf16 v[92:95], a[112:115], a[164:167], v[92:95]
ds_read_b64_tr_b16 a[50:51], v9 offset:8448
v_mul_f32 v82, s48, v82
v_mfma_f32_16x16x32_bf16 v[84:87], a[116:119], a[168:171], v[84:87]
ds_read_b64_tr_b16 a[52:53], v10 offset:256
v_mul_f32 v83, s48, v83
v_mfma_f32_16x16x32_bf16 v[92:95], a[116:119], a[172:175], v[92:95]
ds_read_b64_tr_b16 a[54:55], v10 offset:8448
v_mul_f32 v88, s48, v88
v_mfma_f32_16x16x32_bf16 v[84:87], a[120:123], a[176:179], v[84:87]
ds_read_b64_tr_b16 a[56:57], v11 offset:256
v_mul_f32 v89, s48, v89
v_mfma_f32_16x16x32_bf16 v[92:95], a[120:123], a[180:183], v[92:95]
ds_read_b64_tr_b16 a[58:59], v11 offset:8448
v_mul_f32 v90, s48, v90
v_mfma_f32_16x16x32_bf16 v[84:87], a[124:127], a[184:187], v[84:87]
ds_read_b64_tr_b16 a[60:61], v12 offset:256
v_mul_f32 v91, s48, v91
v_mfma_f32_16x16x32_bf16 v[92:95], a[124:127], a[188:191], v[92:95]
ds_read_b64_tr_b16 a[62:63], v12 offset:8448
s_waitcnt vmcnt(4) lgkmcnt(8)
s_barrier
v_mfma_f32_16x16x32_bf16 v[96:99], a[240:243], v[112:115], v[96:99]
ds_read_b128 a[64:67], v1 offset:49152
s_add_u32 m0, s33, 81920
v_mfma_f32_16x16x32_bf16 v[100:103], a[240:243], v[116:119], v[100:103]
ds_read_b128 a[68:71], v2 offset:49152
buffer_load_dwordx4 v29, s[12:15], s43 offen nt lds
v_mfma_f32_16x16x32_bf16 v[132:135], a[0:3], v[116:119], v[132:135]
ds_read_b128 a[72:75], v3 offset:49152
v_max3_f32 v47, v80, v81, v82
v_mfma_f32_16x16x32_bf16 v[128:131], a[0:3], v[112:115], v[128:131]
ds_read_b128 a[76:79], v4 offset:49152
v_max3_f32 v47, v47, v83, v88
v_mfma_f32_16x16x32_bf16 v[136:139], a[4:7], v[112:115], v[136:139]
ds_read_b128 a[80:83], v1 offset:49408
v_max3_f32 v47, v47, v89, v90
v_mfma_f32_16x16x32_bf16 v[140:143], a[4:7], v[116:119], v[140:143]
ds_read_b128 a[84:87], v2 offset:49408
v_mul_f32 v84, s48, v84
v_mfma_f32_16x16x32_bf16 v[148:151], a[8:11], v[116:119], v[148:151]
ds_read_b128 a[88:91], v3 offset:49408
v_mul_f32 v85, s48, v85
v_mfma_f32_16x16x32_bf16 v[144:147], a[8:11], v[112:115], v[144:147]
ds_read_b128 a[92:95], v4 offset:49408
s_waitcnt lgkmcnt(8)
v_mfma_f32_16x16x32_bf16 v[152:155], a[12:15], v[112:115], v[152:155]
ds_read_b128 a[96:99], v1 offset:57344
v_mul_f32 v86, s48, v86
v_mfma_f32_16x16x32_bf16 v[156:159], a[12:15], v[116:119], v[156:159]
ds_read_b128 a[100:103], v2 offset:57344
v_mul_f32 v87, s48, v87
v_mfma_f32_16x16x32_bf16 v[164:167], a[16:19], v[116:119], v[164:167]
ds_read_b128 a[104:107], v3 offset:57344
buffer_load_dwordx4 v30, s[12:15], s43 offen offset:1024 nt lds
v_mfma_f32_16x16x32_bf16 v[160:163], a[16:19], v[112:115], v[160:163]
ds_read_b128 a[108:111], v4 offset:57344
v_mul_f32 v92, s48, v92
v_mfma_f32_16x16x32_bf16 v[168:171], a[20:23], v[112:115], v[168:171]
ds_read_b128 a[112:115], v1 offset:57600
v_mul_f32 v93, s48, v93
v_mfma_f32_16x16x32_bf16 v[172:175], a[20:23], v[116:119], v[172:175]
ds_read_b128 a[116:119], v2 offset:57600
v_mul_f32 v94, s48, v94
v_mfma_f32_16x16x32_bf16 v[180:183], a[24:27], v[116:119], v[180:183]
ds_read_b128 a[120:123], v3 offset:57600
v_mul_f32 v95, s48, v95
v_mfma_f32_16x16x32_bf16 v[176:179], a[24:27], v[112:115], v[176:179]
ds_read_b128 a[124:127], v4 offset:57600
v_max3_f32 v47, v47, v91, v84
v_mfma_f32_16x16x32_bf16 v[184:187], a[28:31], v[112:115], v[184:187]
v_max3_f32 v47, v47, v85, v86
v_max3_f32 v47, v47, v87, v92
v_mfma_f32_16x16x32_bf16 v[188:191], a[28:31], v[116:119], v[188:191]
v_max3_f32 v47, v47, v93, v94
v_max_f32 v47, v47, v95
v_mfma_f32_16x16x32_bf16 v[196:199], a[32:35], v[116:119], v[196:199]
v_cmp_lt_f32 vcc, 0x41000000, v47
s_cbranch_vccnz L_r1_3
L_b1_3:
v_mfma_f32_16x16x32_bf16 v[192:195], a[32:35], v[112:115], v[192:195]
buffer_load_dwordx4 v31, s[12:15], s43 offen offset:2048 nt lds
v_mfma_f32_16x16x32_bf16 v[200:203], a[36:39], v[112:115], v[200:203]
v_exp_f32 v80, v80
v_mfma_f32_16x16x32_bf16 v[204:207], a[36:39], v[116:119], v[204:207]
v_exp_f32 v81, v81
v_mfma_f32_16x16x32_bf16 v[212:215], a[40:43], v[116:119], v[212:215]
v_exp_f32 v82, v82
v_mfma_f32_16x16x32_bf16 v[208:211], a[40:43], v[112:115], v[208:211]
v_exp_f32 v83, v83
v_mfma_f32_16x16x32_bf16 v[216:219], a[44:47], v[112:115], v[216:219]
v_exp_f32 v84, v84
v_mfma_f32_16x16x32_bf16 v[220:223], a[44:47], v[116:119], v[220:223]
v_exp_f32 v85, v85
v_mfma_f32_16x16x32_bf16 v[228:231], a[48:51], v[116:119], v[228:231]
v_exp_f32 v86, v86
v_mfma_f32_16x16x32_bf16 v[224:227], a[48:51], v[112:115], v[224:227]
v_exp_f32 v87, v87
v_mfma_f32_16x16x32_bf16 v[232:235], a[52:55], v[112:115], v[232:235]
v_exp_f32 v88, v88
v_mfma_f32_16x16x32_bf16 v[236:239], a[52:55], v[116:119], v[236:239]
v_exp_f32 v89, v89
v_mfma_f32_16x16x32_bf16 v[244:247], a[56:59], v[116:119], v[244:247]
v_exp_f32 v90, v90
v_mfma_f32_16x16x32_bf16 v[240:243], a[56:59], v[112:115], v[240:243]
v_exp_f32 v91, v91
v_mfma_f32_16x16x32_bf16 v[248:251], a[60:63], v[112:115], v[248:251]
v_exp_f32 v92, v92
v_mfma_f32_16x16x32_bf16 v[252:255], a[60:63], v[116:119], v[252:255]
s_cmp_lg_u32 s51, 0
s_cbranch_scc1 L_r2_3
L_b2_3:
s_waitcnt vmcnt(4) lgkmcnt(0)
s_barrier
v_mfma_f32_16x16x32_bf16 v[64:67], a[64:67], a[128:131], v[48:51]
ds_read_b64_tr_b16 a[0:1], v5 offset:49152
v_exp_f32 v93, v93
v_mfma_f32_16x16x32_bf16 v[72:75], a[64:67], a[132:135], v[52:55]
ds_read_b64_tr_b16 a[2:3], v5 offset:57344
buffer_load_dwordx4 v32, s[12:15], s43 offen offset:3072 nt lds
v_mfma_f32_16x16x32_bf16 v[64:67], a[68:71], a[136:139], v[64:67]
ds_read_b64_tr_b16 a[4:5], v6 offset:49152
s_add_u32 s43, s43, 16384
v_mfma_f32_16x16x32_bf16 v[72:75], a[68:71], a[140:143], v[72:75]
ds_read_b64_tr_b16 a[6:7], v6 offset:57344
s_and_b32 s43, s43, 0x3ffff
v_mfma_f32_16x16x32_bf16 v[64:67], a[72:75], a[144:147], v[64:67]
ds_read_b64_tr_b16 a[8:9], v7 offset:49152
v_exp_f32 v94, v94
v_mfma_f32_16x16x32_bf16 v[72:75], a[72:75], a[148:151], v[72:75]
ds_read_b64_tr_b16 a[10:11], v7 offset:57344
v_exp_f32 v95, v95
v_mfma_f32_16x16x32_bf16 v[64:67], a[76:79], a[152:155], v[64:67]
ds_read_b64_tr_b16 a[12:13], v8 offset:49152
v_cvt_pk_bf16_f32 v120, v80, v81
v_mfma_f32_16x16x32_bf16 v[72:75], a[76:79], a[156:159], v[72:75]
ds_read_b64_tr_b16 a[14:15], v8 offset:57344
v_cvt_pk_bf16_f32 v121, v82, v83
v_mfma_f32_16x16x32_bf16 v[64:67], a[80:83], a[160:163], v[64:67]
ds_read_b64_tr_b16 a[16:17], v9 offset:49152
v_cvt_pk_bf16_f32 v122, v84, v85
v_mfma_f32_16x16x32_bf16 v[72:75], a[80:83], a[164:167], v[72:75]
ds_read_b64_tr_b16 a[18:19], v9 offset:57344
s_add_u32 m0, s33, 0
v_mfma_f32_16x16x32_bf16 v[64:67], a[84:87], a[168:171], v[64:67]
ds_read_b64_tr_b16 a[20:21], v10 offset:49152
buffer_load_dwordx4 v25, s[8:11], s42 offen nt lds
v_mfma_f32_16x16x32_bf16 v[72:75], a[84:87], a[172:175], v[72:75]
ds_read_b64_tr_b16 a[22:23], v10 offset:57344
v_cvt_pk_bf16_f32 v123, v86, v87
v_mfma_f32_16x16x32_bf16 v[64:67], a[88:91], a[176:179], v[64:67]
ds_read_b64_tr_b16 a[24:25], v11 offset:49152
v_cvt_pk_bf16_f32 v124, v88, v89
v_mfma_f32_16x16x32_bf16 v[72:75], a[88:91], a[180:183], v[72:75]
ds_read_b64_tr_b16 a[26:27], v11 offset:57344
v_cvt_pk_bf16_f32 v125, v90, v91
v_mfma_f32_16x16x32_bf16 v[64:67], a[92:95], a[184:187], v[64:67]
ds_read_b64_tr_b16 a[28:29], v12 offset:49152
v_cvt_pk_bf16_f32 v126, v92, v93
v_mfma_f32_16x16x32_bf16 v[72:75], a[92:95], a[188:191], v[72:75]
ds_read_b64_tr_b16 a[30:31], v12 offset:57344
v_cvt_pk_bf16_f32 v127, v94, v95
v_mfma_f32_16x16x32_bf16 v[68:71], a[96:99], a[128:131], v[48:51]
ds_read_b64_tr_b16 a[32:33], v5 offset:49408
v_mfma_f32_16x16x32_bf16 v[76:79], a[96:99], a[132:135], v[52:55]
ds_read_b64_tr_b16 a[34:35], v5 offset:57600
v_mfma_f32_16x16x32_bf16 v[68:71], a[100:103], a[136:139], v[68:71]
ds_read_b64_tr_b16 a[36:37], v6 offset:49408
v_mfma_f32_16x16x32_bf16 v[76:79], a[100:103], a[140:143], v[76:79]
ds_read_b64_tr_b16 a[38:39], v6 offset:57600
buffer_load_dwordx4 v26, s[8:11], s42 offen offset:1024 nt lds
v_mfma_f32_16x16x32_bf16 v[68:71], a[104:107], a[144:147], v[68:71]
ds_read_b64_tr_b16 a[40:41], v7 offset:49408
v_mul_f32 v64, s48, v64
v_mfma_f32_16x16x32_bf16 v[76:79], a[104:107], a[148:151], v[76:79]
ds_read_b64_tr_b16 a[42:43], v7 offset:57600
v_mul_f32 v65, s48, v65
v_mfma_f32_16x16x32_bf16 v[68:71], a[108:111], a[152:155], v[68:71]
ds_read_b64_tr_b16 a[44:45], v8 offset:49408
v_mul_f32 v66, s48, v66
v_mfma_f32_16x16x32_bf16 v[76:79], a[108:111], a[156:159], v[76:79]
ds_read_b64_tr_b16 a[46:47], v8 offset:57600
v_mul_f32 v67, s48, v67
v_mfma_f32_16x16x32_bf16 v[68:71], a[112:115], a[160:163], v[68:71]
ds_read_b64_tr_b16 a[48:49], v9 offset:49408
v_mul_f32 v72, s48, v72
v_mfma_f32_16x16x32_bf16 v[76:79], a[112:115], a[164:167], v[76:79]
ds_read_b64_tr_b16 a[50:51], v9 offset:57600
v_mul_f32 v73, s48, v73
v_mfma_f32_16x16x32_bf16 v[68:71], a[116:119], a[168:171], v[68:71]
ds_read_b64_tr_b16 a[52:53], v10 offset:49408
v_mul_f32 v74, s48, v74
v_mfma_f32_16x16x32_bf16 v[76:79], a[116:119], a[172:175], v[76:79]
ds_read_b64_tr_b16 a[54:55], v10 offset:57600
v_mul_f32 v75, s48, v75
v_mfma_f32_16x16x32_bf16 v[68:71], a[120:123], a[176:179], v[68:71]
ds_read_b64_tr_b16 a[56:57], v11 offset:49408
v_max3_f32 v47, v64, v65, v66
v_mfma_f32_16x16x32_bf16 v[76:79], a[120:123], a[180:183], v[76:79]
ds_read_b64_tr_b16 a[58:59], v11 offset:57600
v_max3_f32 v47, v47, v67, v72
v_mfma_f32_16x16x32_bf16 v[68:71], a[124:127], a[184:187], v[68:71]
ds_read_b64_tr_b16 a[60:61], v12 offset:49408
v_max3_f32 v47, v47, v73, v74
v_mfma_f32_16x16x32_bf16 v[76:79], a[124:127], a[188:191], v[76:79]
ds_read_b64_tr_b16 a[62:63], v12 offset:57600
s_waitcnt vmcnt(4) lgkmcnt(8)
s_barrier
v_mfma_f32_16x16x32_bf16 v[96:99], a[240:243], v[120:123], v[96:99]
ds_read_b128 a[64:67], v1 offset:0
v_add_u32 v5, 32768, v5
v_mfma_f32_16x16x32_bf16 v[100:103], a[240:243], v[124:127], v[100:103]
ds_read_b128 a[68:71], v2 offset:0
buffer_load_dwordx4 v27, s[8:11], s42 offen offset:2048 nt lds
v_mfma_f32_16x16x32_bf16 v[132:135], a[0:3], v[124:127], v[132:135]
ds_read_b128 a[72:75], v3 offset:0
v_add_u32 v6, 32768, v6
v_mfma_f32_16x16x32_bf16 v[128:131], a[0:3], v[120:123], v[128:131]
ds_read_b128 a[76:79], v4 offset:0
v_add_u32 v7, 32768, v7
v_mfma_f32_16x16x32_bf16 v[136:139], a[4:7], v[120:123], v[136:139]
ds_read_b128 a[80:83], v1 offset:256
v_add_u32 v8, 32768, v8
v_mfma_f32_16x16x32_bf16 v[140:143], a[4:7], v[124:127], v[140:143]
ds_read_b128 a[84:87], v2 offset:256
v_add_u32 v9, 32768, v9
v_mfma_f32_16x16x32_bf16 v[148:151], a[8:11], v[124:127], v[148:151]
ds_read_b128 a[88:91], v3 offset:256
v_add_u32 v10, 32768, v10
v_mfma_f32_16x16x32_bf16 v[144:147], a[8:11], v[120:123], v[144:147]
ds_read_b128 a[92:95], v4 offset:256
s_waitcnt lgkmcnt(8)
v_mfma_f32_16x16x32_bf16 v[152:155], a[12:15], v[120:123], v[152:155]
ds_read_b128 a[96:99], v1 offset:8192
v_add_u32 v11, 32768, v11
v_mfma_f32_16x16x32_bf16 v[156:159], a[12:15], v[124:127], v[156:159]
ds_read_b128 a[100:103], v2 offset:8192
v_add_u32 v12, 32768, v12
v_mfma_f32_16x16x32_bf16 v[164:167], a[16:19], v[124:127], v[164:167]
ds_read_b128 a[104:107], v3 offset:8192
buffer_load_dwordx4 v28, s[8:11], s42 offen offset:3072 nt lds
v_mfma_f32_16x16x32_bf16 v[160:163], a[16:19], v[120:123], v[160:163]
ds_read_b128 a[108:111], v4 offset:8192
s_add_u32 s42, s42, 16384
v_mfma_f32_16x16x32_bf16 v[168:171], a[20:23], v[120:123], v[168:171]
ds_read_b128 a[112:115], v1 offset:8448
s_and_b32 s42, s42, 0x3ffff
v_mfma_f32_16x16x32_bf16 v[172:175], a[20:23], v[124:127], v[172:175]
ds_read_b128 a[116:119], v2 offset:8448
v_mul_f32 v68, s48, v68
v_mfma_f32_16x16x32_bf16 v[180:183], a[24:27], v[124:127], v[180:183]
ds_read_b128 a[120:123], v3 offset:8448
v_mul_f32 v69, s48, v69
v_mfma_f32_16x16x32_bf16 v[176:179], a[24:27], v[120:123], v[176:179]
ds_read_b128 a[124:127], v4 offset:8448
v_mul_f32 v70, s48, v70
v_mfma_f32_16x16x32_bf16 v[184:187], a[28:31], v[120:123], v[184:187]
v_mul_f32 v71, s48, v71
v_mul_f32 v76, s48, v76
v_mfma_f32_16x16x32_bf16 v[188:191], a[28:31], v[124:127], v[188:191]
v_mul_f32 v77, s48, v77
v_mul_f32 v78, s48, v78
v_mfma_f32_16x16x32_bf16 v[196:199], a[32:35], v[124:127], v[196:199]
s_add_u32 m0, s33, 65536
v_mul_f32 v79, s48, v79
v_max3_f32 v47, v47, v75, v68
v_mfma_f32_16x16x32_bf16 v[192:195], a[32:35], v[120:123], v[192:195]
buffer_load_dwordx4 v29, s[12:15], s43 offen nt lds
v_max3_f32 v47, v47, v69, v70
v_mfma_f32_16x16x32_bf16 v[200:203], a[36:39], v[120:123], v[200:203]
v_max3_f32 v47, v47, v71, v76
v_max3_f32 v47, v47, v77, v78
v_mfma_f32_16x16x32_bf16 v[204:207], a[36:39], v[124:127], v[204:207]
v_max_f32 v47, v47, v79
v_cmp_lt_f32 vcc, 0x41000000, v47
v_mfma_f32_16x16x32_bf16 v[212:215], a[40:43], v[124:127], v[212:215]
s_cbranch_vccnz L_r1_4
L_b1_4:
v_exp_f32 v64, v64
v_mfma_f32_16x16x32_bf16 v[208:211], a[40:43], v[120:123], v[208:211]
v_exp_f32 v65, v65
v_mfma_f32_16x16x32_bf16 v[216:219], a[44:47], v[120:123], v[216:219]
v_exp_f32 v66, v66
v_mfma_f32_16x16x32_bf16 v[220:223], a[44:47], v[124:127], v[220:223]
v_exp_f32 v67, v67
v_mfma_f32_16x16x32_bf16 v[228:231], a[48:51], v[124:127], v[228:231]
v_exp_f32 v68, v68
v_mfma_f32_16x16x32_bf16 v[224:227], a[48:51], v[120:123], v[224:227]
v_exp_f32 v69, v69
v_mfma_f32_16x16x32_bf16 v[232:235], a[52:55], v[120:123], v[232:235]
v_exp_f32 v70, v70
v_mfma_f32_16x16x32_bf16 v[236:239], a[52:55], v[124:127], v[236:239]
v_exp_f32 v71, v71
v_mfma_f32_16x16x32_bf16 v[244:247], a[56:59], v[124:127], v[244:247]
v_exp_f32 v72, v72
v_mfma_f32_16x16x32_bf16 v[240:243], a[56:59], v[120:123], v[240:243]
v_exp_f32 v73, v73
v_mfma_f32_16x16x32_bf16 v[248:251], a[60:63], v[120:123], v[248:251]
v_exp_f32 v74, v74
v_mfma_f32_16x16x32_bf16 v[252:255], a[60:63], v[124:127], v[252:255]
s_cmp_lg_u32 s51, 0
s_cbranch_scc1 L_r2_4
L_b2_4:
s_waitcnt vmcnt(4) lgkmcnt(0)
s_barrier
v_mfma_f32_16x16x32_bf16 v[80:83], a[64:67], a[128:131], v[48:51]
ds_read_b64_tr_b16 a[0:1], v5 offset:32768
v_subrev_u32 v1, 49152, v1
v_mfma_f32_16x16x32_bf16 v[88:91], a[64:67], a[132:135], v[52:55]
ds_read_b64_tr_b16 a[2:3], v5 offset:40960
buffer_load_dwordx4 v30, s[12:15], s43 offen offset:1024 nt lds
v_mfma_f32_16x16x32_bf16 v[80:83], a[68:71], a[136:139], v[80:83]
ds_read_b64_tr_b16 a[4:5], v6 offset:32768
v_subrev_u32 v2, 49152, v2
v_mfma_f32_16x16x32_bf16 v[88:91], a[68:71], a[140:143], v[88:91]
ds_read_b64_tr_b16 a[6:7], v6 offset:40960
v_subrev_u32 v3, 49152, v3
v_mfma_f32_16x16x32_bf16 v[80:83], a[72:75], a[144:147], v[80:83]
ds_read_b64_tr_b16 a[8:9], v7 offset:32768
v_subrev_u32 v4, 49152, v4
v_mfma_f32_16x16x32_bf16 v[88:91], a[72:75], a[148:151], v[88:91]
ds_read_b64_tr_b16 a[10:11], v7 offset:40960
v_exp_f32 v75, v75
v_mfma_f32_16x16x32_bf16 v[80:83], a[76:79], a[152:155], v[80:83]
ds_read_b64_tr_b16 a[12:13], v8 offset:32768
v_exp_f32 v76, v76
v_mfma_f32_16x16x32_bf16 v[88:91], a[76:79], a[156:159], v[88:91]
ds_read_b64_tr_b16 a[14:15], v8 offset:40960
v_exp_f32 v77, v77
v_mfma_f32_16x16x32_bf16 v[80:83], a[80:83], a[160:163], v[80:83]
ds_read_b64_tr_b16 a[16:17], v9 offset:32768
v_exp_f32 v78, v78
v_mfma_f32_16x16x32_bf16 v[88:91], a[80:83], a[164:167], v[88:91]
ds_read_b64_tr_b16 a[18:19], v9 offset:40960
v_exp_f32 v79, v79
v_mfma_f32_16x16x32_bf16 v[80:83], a[84:87], a[168:171], v[80:83]
ds_read_b64_tr_b16 a[20:21], v10 offset:32768
buffer_load_dwordx4 v31, s[12:15], s43 offen offset:2048 nt lds
v_mfma_f32_16x16x32_bf16 v[88:91], a[84:87], a[172:175], v[88:91]
ds_read_b64_tr_b16 a[22:23], v10 offset:40960
v_cvt_pk_bf16_f32 v112, v64, v65
v_mfma_f32_16x16x32_bf16 v[80:83], a[88:91], a[176:179], v[80:83]
ds_read_b64_tr_b16 a[24:25], v11 offset:32768
v_cvt_pk_bf16_f32 v113, v66, v67
v_mfma_f32_16x16x32_bf16 v[88:91], a[88:91], a[180:183], v[88:91]
ds_read_b64_tr_b16 a[26:27], v11 offset:40960
v_cvt_pk_bf16_f32 v114, v68, v69
v_mfma_f32_16x16x32_bf16 v[80:83], a[92:95], a[184:187], v[80:83]
ds_read_b64_tr_b16 a[28:29], v12 offset:32768
v_cvt_pk_bf16_f32 v115, v70, v71
v_mfma_f32_16x16x32_bf16 v[88:91], a[92:95], a[188:191], v[88:91]
ds_read_b64_tr_b16 a[30:31], v12 offset:40960
v_cvt_pk_bf16_f32 v116, v72, v73
v_mfma_f32_16x16x32_bf16 v[84:87], a[96:99], a[128:131], v[48:51]
ds_read_b64_tr_b16 a[32:33], v5 offset:33024
v_cvt_pk_bf16_f32 v117, v74, v75
v_mfma_f32_16x16x32_bf16 v[92:95], a[96:99], a[132:135], v[52:55]
ds_read_b64_tr_b16 a[34:35], v5 offset:41216
v_cvt_pk_bf16_f32 v118, v76, v77
v_mfma_f32_16x16x32_bf16 v[84:87], a[100:103], a[136:139], v[84:87]
ds_read_b64_tr_b16 a[36:37], v6 offset:33024
v_cvt_pk_bf16_f32 v119, v78, v79
v_mfma_f32_16x16x32_bf16 v[92:95], a[100:103], a[140:143], v[92:95]
ds_read_b64_tr_b16 a[38:39], v6 offset:41216
buffer_load_dwordx4 v32, s[12:15], s43 offen offset:3072 nt lds
v_mfma_f32_16x16x32_bf16 v[84:87], a[104:107], a[144:147], v[84:87]
ds_read_b64_tr_b16 a[40:41], v7 offset:33024
s_add_u32 s43, s43, 16384
v_mfma_f32_16x16x32_bf16 v[92:95], a[104:107], a[148:151], v[92:95]
ds_read_b64_tr_b16 a[42:43], v7 offset:41216
s_and_b32 s43, s43, 0x3ffff
v_mfma_f32_16x16x32_bf16 v[84:87], a[108:111], a[152:155], v[84:87]
ds_read_b64_tr_b16 a[44:45], v8 offset:33024
v_mul_f32 v80, s48, v80
v_mfma_f32_16x16x32_bf16 v[92:95], a[108:111], a[156:159], v[92:95]
ds_read_b64_tr_b16 a[46:47], v8 offset:41216
v_mul_f32 v81, s48, v81
v_mfma_f32_16x16x32_bf16 v[84:87], a[112:115], a[160:163], v[84:87]
ds_read_b64_tr_b16 a[48:49], v9 offset:33024
v_mul_f32 v82, s48, v82
v_mfma_f32_16x16x32_bf16 v[92:95], a[112:115], a[164:167], v[92:95]
ds_read_b64_tr_b16 a[50:51], v9 offset:41216
v_mul_f32 v83, s48, v83
v_mfma_f32_16x16x32_bf16 v[84:87], a[116:119], a[168:171], v[84:87]
ds_read_b64_tr_b16 a[52:53], v10 offset:33024
v_mul_f32 v88, s48, v88
v_mfma_f32_16x16x32_bf16 v[92:95], a[116:119], a[172:175], v[92:95]
ds_read_b64_tr_b16 a[54:55], v10 offset:41216
v_mul_f32 v89, s48, v89
v_mfma_f32_16x16x32_bf16 v[84:87], a[120:123], a[176:179], v[84:87]
ds_read_b64_tr_b16 a[56:57], v11 offset:33024
v_mul_f32 v90, s48, v90
v_mfma_f32_16x16x32_bf16 v[92:95], a[120:123], a[180:183], v[92:95]
ds_read_b64_tr_b16 a[58:59], v11 offset:41216
v_mul_f32 v91, s48, v91
v_mfma_f32_16x16x32_bf16 v[84:87], a[124:127], a[184:187], v[84:87]
ds_read_b64_tr_b16 a[60:61], v12 offset:33024
v_max3_f32 v47, v80, v81, v82
v_mfma_f32_16x16x32_bf16 v[92:95], a[124:127], a[188:191], v[92:95]
ds_read_b64_tr_b16 a[62:63], v12 offset:41216
s_waitcnt vmcnt(4) lgkmcnt(8)
L_pad5:
s_cbranch_execz L_hr1
s_barrier
v_mfma_f32_16x16x32_bf16 v[96:99], a[240:243], v[112:115], v[96:99]
ds_read_b128 a[64:67], v1 offset:16384
s_add_u32 m0, s33, 49152
v_mfma_f32_16x16x32_bf16 v[100:103], a[240:243], v[116:119], v[100:103]
ds_read_b128 a[68:71], v2 offset:16384
buffer_load_dwordx4 v25, s[8:11], s42 offen nt lds
v_mfma_f32_16x16x32_bf16 v[132:135], a[0:3], v[116:119], v[132:135]
ds_read_b128 a[72:75], v3 offset:16384
v_max3_f32 v47, v47, v83, v88
v_mfma_f32_16x16x32_bf16 v[128:131], a[0:3], v[112:115], v[128:131]
ds_read_b128 a[76:79], v4 offset:16384
v_max3_f32 v47, v47, v89, v90
v_mfma_f32_16x16x32_bf16 v[136:139], a[4:7], v[112:115], v[136:139]
ds_read_b128 a[80:83], v1 offset:16640
v_mul_f32 v84, s48, v84
v_mfma_f32_16x16x32_bf16 v[140:143], a[4:7], v[116:119], v[140:143]
ds_read_b128 a[84:87], v2 offset:16640
v_mul_f32 v85, s48, v85
v_mfma_f32_16x16x32_bf16 v[148:151], a[8:11], v[116:119], v[148:151]
ds_read_b128 a[88:91], v3 offset:16640
v_mul_f32 v86, s48, v86
v_mfma_f32_16x16x32_bf16 v[144:147], a[8:11], v[112:115], v[144:147]
ds_read_b128 a[92:95], v4 offset:16640
s_waitcnt lgkmcnt(8)
v_mfma_f32_16x16x32_bf16 v[152:155], a[12:15], v[112:115], v[152:155]
ds_read_b128 a[96:99], v1 offset:24576
v_mul_f32 v87, s48, v87
v_mfma_f32_16x16x32_bf16 v[156:159], a[12:15], v[116:119], v[156:159]
ds_read_b128 a[100:103], v2 offset:24576
v_mul_f32 v92, s48, v92
v_mfma_f32_16x16x32_bf16 v[164:167], a[16:19], v[116:119], v[164:167]
ds_read_b128 a[104:107], v3 offset:24576
buffer_load_dwordx4 v26, s[8:11], s42 offen offset:1024 nt lds
v_mfma_f32_16x16x32_bf16 v[160:163], a[16:19], v[112:115], v[160:163]
ds_read_b128 a[108:111], v4 offset:24576
v_mul_f32 v93, s48, v93
v_mfma_f32_16x16x32_bf16 v[168:171], a[20:23], v[112:115], v[168:171]
ds_read_b128 a[112:115], v1 offset:24832
v_mul_f32 v94, s48, v94
v_mfma_f32_16x16x32_bf16 v[172:175], a[20:23], v[116:119], v[172:175]
ds_read_b128 a[116:119], v2 offset:24832
v_mul_f32 v95, s48, v95
v_mfma_f32_16x16x32_bf16 v[180:183], a[24:27], v[116:119], v[180:183]
ds_read_b128 a[120:123], v3 offset:24832
v_max3_f32 v47, v47, v91, v84
v_mfma_f32_16x16x32_bf16 v[176:179], a[24:27], v[112:115], v[176:179]
ds_read_b128 a[124:127], v4 offset:24832
v_max3_f32 v47, v47, v85, v86
v_mfma_f32_16x16x32_bf16 v[184:187], a[28:31], v[112:115], v[184:187]
v_max3_f32 v47, v47, v87, v92
v_max3_f32 v47, v47, v93, v94
v_mfma_f32_16x16x32_bf16 v[188:191], a[28:31], v[116:119], v[188:191]
v_max_f32 v47, v47, v95
v_cmp_lt_f32 vcc, 0x41000000, v47
v_mfma_f32_16x16x32_bf16 v[196:199], a[32:35], v[116:119], v[196:199]
s_cbranch_vccnz L_r1_5
L_b1_5:
v_exp_f32 v80, v80
v_mfma_f32_16x16x32_bf16 v[192:195], a[32:35], v[112:115], v[192:195]
buffer_load_dwordx4 v27, s[8:11], s42 offen offset:2048 nt lds
v_mfma_f32_16x16x32_bf16 v[200:203], a[36:39], v[112:115], v[200:203]
v_exp_f32 v81, v81
v_mfma_f32_16x16x32_bf16 v[204:207], a[36:39], v[116:119], v[204:207]
v_exp_f32 v82, v82
v_mfma_f32_16x16x32_bf16 v[212:215], a[40:43], v[116:119], v[212:215]
v_exp_f32 v83, v83
v_mfma_f32_16x16x32_bf16 v[208:211], a[40:43], v[112:115], v[208:211]
v_exp_f32 v84, v84
v_mfma_f32_16x16x32_bf16 v[216:219], a[44:47], v[112:115], v[216:219]
v_exp_f32 v85, v85
v_mfma_f32_16x16x32_bf16 v[220:223], a[44:47], v[116:119], v[220:223]
v_exp_f32 v86, v86
v_mfma_f32_16x16x32_bf16 v[228:231], a[48:51], v[116:119], v[228:231]
v_exp_f32 v87, v87
v_mfma_f32_16x16x32_bf16 v[224:227], a[48:51], v[112:115], v[224:227]
v_exp_f32 v88, v88
v_mfma_f32_16x16x32_bf16 v[232:235], a[52:55], v[112:115], v[232:235]
v_exp_f32 v89, v89
v_mfma_f32_16x16x32_bf16 v[236:239], a[52:55], v[116:119], v[236:239]
v_exp_f32 v90, v90
v_mfma_f32_16x16x32_bf16 v[244:247], a[56:59], v[116:119], v[244:247]
v_exp_f32 v91, v91
v_mfma_f32_16x16x32_bf16 v[240:243], a[56:59], v[112:115], v[240:243]
v_exp_f32 v92, v92
v_mfma_f32_16x16x32_bf16 v[248:251], a[60:63], v[112:115], v[248:251]
v_exp_f32 v93, v93
v_mfma_f32_16x16x32_bf16 v[252:255], a[60:63], v[116:119], v[252:255]
s_cmp_lg_u32 s51, 0
s_cbranch_scc1 L_r2_5
L_b2_5:
s_waitcnt vmcnt(4) lgkmcnt(0)
s_barrier
v_mfma_f32_16x16x32_bf16 v[64:67], a[64:67], a[128:131], v[48:51]
ds_read_b64_tr_b16 a[0:1], v5 offset:49152
v_exp_f32 v94, v94
v_mfma_f32_16x16x32_bf16 v[72:75], a[64:67], a[132:135], v[52:55]
ds_read_b64_tr_b16 a[2:3], v5 offset:57344
buffer_load_dwordx4 v28, s[8:11], s42 offen offset:3072 nt lds
v_mfma_f32_16x16x32_bf16 v[64:67], a[68:71], a[136:139], v[64:67]
ds_read_b64_tr_b16 a[4:5], v6 offset:49152
s_add_u32 s42, s42, 16384
v_mfma_f32_16x16x32_bf16 v[72:75], a[68:71], a[140:143], v[72:75]
ds_read_b64_tr_b16 a[6:7], v6 offset:57344
s_and_b32 s42, s42, 0x3ffff
v_mfma_f32_16x16x32_bf16 v[64:67], a[72:75], a[144:147], v[64:67]
ds_read_b64_tr_b16 a[8:9], v7 offset:49152
v_exp_f32 v95, v95
v_mfma_f32_16x16x32_bf16 v[72:75], a[72:75], a[148:151], v[72:75]
ds_read_b64_tr_b16 a[10:11], v7 offset:57344
v_cvt_pk_bf16_f32 v120, v80, v81
v_mfma_f32_16x16x32_bf16 v[64:67], a[76:79], a[152:155], v[64:67]
ds_read_b64_tr_b16 a[12:13], v8 offset:49152
v_cvt_pk_bf16_f32 v121, v82, v83
v_mfma_f32_16x16x32_bf16 v[72:75], a[76:79], a[156:159], v[72:75]
ds_read_b64_tr_b16 a[14:15], v8 offset:57344
v_cvt_pk_bf16_f32 v122, v84, v85
v_mfma_f32_16x16x32_bf16 v[64:67], a[80:83], a[160:163], v[64:67]
ds_read_b64_tr_b16 a[16:17], v9 offset:49152
v_cvt_pk_bf16_f32 v123, v86, v87
v_mfma_f32_16x16x32_bf16 v[72:75], a[80:83], a[164:167], v[72:75]
ds_read_b64_tr_b16 a[18:19], v9 offset:57344
s_add_u32 m0, s33, 98304
v_mfma_f32_16x16x32_bf16 v[64:67], a[84:87], a[168:171], v[64:67]
ds_read_b64_tr_b16 a[20:21], v10 offset:49152
buffer_load_dwordx4 v29, s[12:15], s43 offen nt lds
v_mfma_f32_16x16x32_bf16 v[72:75], a[84:87], a[172:175], v[72:75]
ds_read_b64_tr_b16 a[22:23], v10 offset:57344
v_cvt_pk_bf16_f32 v124, v88, v89
v_mfma_f32_16x16x32_bf16 v[64:67], a[88:91], a[176:179], v[64:67]
ds_read_b64_tr_b16 a[24:25], v11 offset:49152
v_cvt_pk_bf16_f32 v125, v90, v91
v_mfma_f32_16x16x32_bf16 v[72:75], a[88:91], a[180:183], v[72:75]
ds_read_b64_tr_b16 a[26:27], v11 offset:57344
v_cvt_pk_bf16_f32 v126, v92, v93
v_mfma_f32_16x16x32_bf16 v[64:67], a[92:95], a[184:187], v[64:67]
ds_read_b64_tr_b16 a[28:29], v12 offset:49152
v_cvt_pk_bf16_f32 v127, v94, v95
v_mfma_f32_16x16x32_bf16 v[72:75], a[92:95], a[188:191], v[72:75]
ds_read_b64_tr_b16 a[30:31], v12 offset:57344
v_mfma_f32_16x16x32_bf16 v[68:71], a[96:99], a[128:131], v[48:51]
ds_read_b64_tr_b16 a[32:33], v5 offset:49408
v_mfma_f32_16x16x32_bf16 v[76:79], a[96:99], a[132:135], v[52:55]
ds_read_b64_tr_b16 a[34:35], v5 offset:57600
v_mfma_f32_16x16x32_bf16 v[68:71], a[100:103], a[136:139], v[68:71]
ds_read_b64_tr_b16 a[36:37], v6 offset:49408
v_mfma_f32_16x16x32_bf16 v[76:79], a[100:103], a[140:143], v[76:79]
ds_read_b64_tr_b16 a[38:39], v6 offset:57600
buffer_load_dwordx4 v30, s[12:15], s43 offen offset:1024 nt lds
v_mfma_f32_16x16x32_bf16 v[68:71], a[104:107], a[144:147], v[68:71]
ds_read_b64_tr_b16 a[40:41], v7 offset:49408
v_mul_f32 v64, s48, v64
v_mfma_f32_16x16x32_bf16 v[76:79], a[104:107], a[148:151], v[76:79]
ds_read_b64_tr_b16 a[42:43], v7 offset:57600
v_mul_f32 v65, s48, v65
v_mfma_f32_16x16x32_bf16 v[68:71], a[108:111], a[152:155], v[68:71]
ds_read_b64_tr_b16 a[44:45], v8 offset:49408
v_mul_f32 v66, s48, v66
v_mfma_f32_16x16x32_bf16 v[76:79], a[108:111], a[156:159], v[76:79]
ds_read_b64_tr_b16 a[46:47], v8 offset:57600
v_mul_f32 v67, s48, v67
v_mfma_f32_16x16x32_bf16 v[68:71], a[112:115], a[160:163], v[68:71]
ds_read_b64_tr_b16 a[48:49], v9 offset:49408
v_mul_f32 v72, s48, v72
v_mfma_f32_16x16x32_bf16 v[76:79], a[112:115], a[164:167], v[76:79]
ds_read_b64_tr_b16 a[50:51], v9 offset:57600
v_mul_f32 v73, s48, v73
v_mfma_f32_16x16x32_bf16 v[68:71], a[116:119], a[168:171], v[68:71]
ds_read_b64_tr_b16 a[52:53], v10 offset:49408
v_mul_f32 v74, s48, v74
v_mfma_f32_16x16x32_bf16 v[76:79], a[116:119], a[172:175], v[76:79]
ds_read_b64_tr_b16 a[54:55], v10 offset:57600
v_mul_f32 v75, s48, v75
v_mfma_f32_16x16x32_bf16 v[68:71], a[120:123], a[176:179], v[68:71]
ds_read_b64_tr_b16 a[56:57], v11 offset:49408
v_max3_f32 v47, v64, v65, v66
v_mfma_f32_16x16x32_bf16 v[76:79], a[120:123], a[180:183], v[76:79]
ds_read_b64_tr_b16 a[58:59], v11 offset:57600
v_max3_f32 v47, v47, v67, v72
v_mfma_f32_16x16x32_bf16 v[68:71], a[124:127], a[184:187], v[68:71]
ds_read_b64_tr_b16 a[60:61], v12 offset:49408
v_max3_f32 v47, v47, v73, v74
v_mfma_f32_16x16x32_bf16 v[76:79], a[124:127], a[188:191], v[76:79]
ds_read_b64_tr_b16 a[62:63], v12 offset:57600
s_waitcnt vmcnt(4) lgkmcnt(8)
s_barrier
v_mfma_f32_16x16x32_bf16 v[96:99], a[240:243], v[120:123], v[96:99]
ds_read_b128 a[64:67], v1 offset:32768
v_subrev_u32 v5, 32768, v5
v_mfma_f32_16x16x32_bf16 v[100:103], a[240:243], v[124:127], v[100:103]
ds_read_b128 a[68:71], v2 offset:32768
buffer_load_dwordx4 v31, s[12:15], s43 offen offset:2048 nt lds
v_mfma_f32_16x16x32_bf16 v[132:135], a[0:3], v[124:127], v[132:135]
ds_read_b128 a[72:75], v3 offset:32768
v_subrev_u32 v6, 32768, v6
v_mfma_f32_16x16x32_bf16 v[128:131], a[0:3], v[120:123], v[128:131]
ds_read_b128 a[76:79], v4 offset:32768
v_subrev_u32 v7, 32768, v7
v_mfma_f32_16x16x32_bf16 v[136:139], a[4:7], v[120:123], v[136:139]
ds_read_b128 a[80:83], v1 offset:33024
v_subrev_u32 v8, 32768, v8
v_mfma_f32_16x16x32_bf16 v[140:143], a[4:7], v[124:127], v[140:143]
ds_read_b128 a[84:87], v2 offset:33024
v_subrev_u32 v9, 32768, v9
v_mfma_f32_16x16x32_bf16 v[148:151], a[8:11], v[124:127], v[148:151]
ds_read_b128 a[88:91], v3 offset:33024
v_subrev_u32 v10, 32768, v10
v_mfma_f32_16x16x32_bf16 v[144:147], a[8:11], v[120:123], v[144:147]
ds_read_b128 a[92:95], v4 offset:33024
s_waitcnt lgkmcnt(8)
v_mfma_f32_16x16x32_bf16 v[152:155], a[12:15], v[120:123], v[152:155]
ds_read_b128 a[96:99], v1 offset:40960
v_subrev_u32 v11, 32768, v11
v_mfma_f32_16x16x32_bf16 v[156:159], a[12:15], v[124:127], v[156:159]
ds_read_b128 a[100:103], v2 offset:40960
v_subrev_u32 v12, 32768, v12
v_mfma_f32_16x16x32_bf16 v[164:167], a[16:19], v[124:127], v[164:167]
ds_read_b128 a[104:107], v3 offset:40960
buffer_load_dwordx4 v32, s[12:15], s43 offen offset:3072 nt lds
v_mfma_f32_16x16x32_bf16 v[160:163], a[16:19], v[120:123], v[160:163]
ds_read_b128 a[108:111], v4 offset:40960
s_add_u32 s43, s43, 16384
v_mfma_f32_16x16x32_bf16 v[168:171], a[20:23], v[120:123], v[168:171]
ds_read_b128 a[112:115], v1 offset:41216
s_and_b32 s43, s43, 0x3ffff
v_mfma_f32_16x16x32_bf16 v[172:175], a[20:23], v[124:127], v[172:175]
ds_read_b128 a[116:119], v2 offset:41216
v_mul_f32 v68, s48, v68
v_mfma_f32_16x16x32_bf16 v[180:183], a[24:27], v[124:127], v[180:183]
ds_read_b128 a[120:123], v3 offset:41216
v_mul_f32 v69, s48, v69
v_mfma_f32_16x16x32_bf16 v[176:179], a[24:27], v[120:123], v[176:179]
ds_read_b128 a[124:127], v4 offset:41216
v_mul_f32 v70, s48, v70
v_mfma_f32_16x16x32_bf16 v[184:187], a[28:31], v[120:123], v[184:187]
v_mul_f32 v71, s48, v71
v_mul_f32 v76, s48, v76
v_mfma_f32_16x16x32_bf16 v[188:191], a[28:31], v[124:127], v[188:191]
v_mul_f32 v77, s48, v77
v_mul_f32 v78, s48, v78
v_mfma_f32_16x16x32_bf16 v[196:199], a[32:35], v[124:127], v[196:199]
s_add_u32 m0, s33, 16384
v_mul_f32 v79, s48, v79
v_max3_f32 v47, v47, v75, v68
v_mfma_f32_16x16x32_bf16 v[192:195], a[32:35], v[120:123], v[192:195]
buffer_load_dwordx4 v25, s[8:11], s42 offen nt lds
v_max3_f32 v47, v47, v69, v70
v_mfma_f32_16x16x32_bf16 v[200:203], a[36:39], v[120:123], v[200:203]
v_max3_f32 v47, v47, v71, v76
v_max3_f32 v47, v47, v77, v78
v_mfma_f32_16x16x32_bf16 v[204:207], a[36:39], v[124:127], v[204:207]
v_max_f32 v47, v47, v79
v_cmp_lt_f32 vcc, 0x41000000, v47
v_mfma_f32_16x16x32_bf16 v[212:215], a[40:43], v[124:127], v[212:215]
s_cbranch_vccnz L_r1_6
L_b1_6:
v_exp_f32 v64, v64
v_mfma_f32_16x16x32_bf16 v[208:211], a[40:43], v[120:123], v[208:211]
v_exp_f32 v65, v65
v_mfma_f32_16x16x32_bf16 v[216:219], a[44:47], v[120:123], v[216:219]
v_exp_f32 v66, v66
v_mfma_f32_16x16x32_bf16 v[220:223], a[44:47], v[124:127], v[220:223]
v_exp_f32 v67, v67
v_mfma_f32_16x16x32_bf16 v[228:231], a[48:51], v[124:127], v[228:231]
v_exp_f32 v68, v68
v_mfma_f32_16x16x32_bf16 v[224:227], a[48:51], v[120:123], v[224:227]
v_exp_f32 v69, v69
v_mfma_f32_16x16x32_bf16 v[232:235], a[52:55], v[120:123], v[232:235]
v_exp_f32 v70, v70
v_mfma_f32_16x16x32_bf16 v[236:239], a[52:55], v[124:127], v[236:239]
v_exp_f32 v71, v71
v_mfma_f32_16x16x32_bf16 v[244:247], a[56:59], v[124:127], v[244:247]
v_exp_f32 v72, v72
v_mfma_f32_16x16x32_bf16 v[240:243], a[56:59], v[120:123], v[240:243]
v_exp_f32 v73, v73
v_mfma_f32_16x16x32_bf16 v[248:251], a[60:63], v[120:123], v[248:251]
v_exp_f32 v74, v74
v_mfma_f32_16x16x32_bf16 v[252:255], a[60:63], v[124:127], v[252:255]
s_cmp_lg_u32 s51, 0
s_cbranch_scc1 L_r2_6
L_b2_6:
s_waitcnt vmcnt(4) lgkmcnt(0)
s_barrier
v_mfma_f32_16x16x32_bf16 v[80:83], a[64:67], a[128:131], v[48:51]
ds_read_b64_tr_b16 a[0:1], v5 offset:16384
v_exp_f32 v75, v75
v_mfma_f32_16x16x32_bf16 v[88:91], a[64:67], a[132:135], v[52:55]
ds_read_b64_tr_b16 a[2:3], v5 offset:24576
buffer_load_dwordx4 v26, s[8:11], s42 offen offset:1024 nt lds
v_mfma_f32_16x16x32_bf16 v[80:83], a[68:71], a[136:139], v[80:83]
ds_read_b64_tr_b16 a[4:5], v6 offset:16384
v_exp_f32 v76, v76
v_mfma_f32_16x16x32_bf16 v[88:91], a[68:71], a[140:143], v[88:91]
ds_read_b64_tr_b16 a[6:7], v6 offset:24576
v_exp_f32 v77, v77
v_mfma_f32_16x16x32_bf16 v[80:83], a[72:75], a[144:147], v[80:83]
ds_read_b64_tr_b16 a[8:9], v7 offset:16384
v_exp_f32 v78, v78
v_mfma_f32_16x16x32_bf16 v[88:91], a[72:75], a[148:151], v[88:91]
ds_read_b64_tr_b16 a[10:11], v7 offset:24576
v_exp_f32 v79, v79
v_mfma_f32_16x16x32_bf16 v[80:83], a[76:79], a[152:155], v[80:83]
ds_read_b64_tr_b16 a[12:13], v8 offset:16384
v_cvt_pk_bf16_f32 v112, v64, v65
v_mfma_f32_16x16x32_bf16 v[88:91], a[76:79], a[156:159], v[88:91]
ds_read_b64_tr_b16 a[14:15], v8 offset:24576
v_cvt_pk_bf16_f32 v113, v66, v67
v_mfma_f32_16x16x32_bf16 v[80:83], a[80:83], a[160:163], v[80:83]
ds_read_b64_tr_b16 a[16:17], v9 offset:16384
v_cvt_pk_bf16_f32 v114, v68, v69
v_mfma_f32_16x16x32_bf16 v[88:91], a[80:83], a[164:167], v[88:91]
ds_read_b64_tr_b16 a[18:19], v9 offset:24576
v_cvt_pk_bf16_f32 v115, v70, v71
v_mfma_f32_16x16x32_bf16 v[80:83], a[84:87], a[168:171], v[80:83]
ds_read_b64_tr_b16 a[20:21], v10 offset:16384
buffer_load_dwordx4 v27, s[8:11], s42 offen offset:2048 nt lds
v_mfma_f32_16x16x32_bf16 v[88:91], a[84:87], a[172:175], v[88:91]
ds_read_b64_tr_b16 a[22:23], v10 offset:24576
v_cvt_pk_bf16_f32 v116, v72, v73
v_mfma_f32_16x16x32_bf16 v[80:83], a[88:91], a[176:179], v[80:83]
ds_read_b64_tr_b16 a[24:25], v11 offset:16384
v_cvt_pk_bf16_f32 v117, v74, v75
v_mfma_f32_16x16x32_bf16 v[88:91], a[88:91], a[180:183], v[88:91]
ds_read_b64_tr_b16 a[26:27], v11 offset:24576
v_cvt_pk_bf16_f32 v118, v76, v77
v_mfma_f32_16x16x32_bf16 v[80:83], a[92:95], a[184:187], v[80:83]
ds_read_b64_tr_b16 a[28:29], v12 offset:16384
v_cvt_pk_bf16_f32 v119, v78, v79
v_mfma_f32_16x16x32_bf16 v[88:91], a[92:95], a[188:191], v[88:91]
ds_read_b64_tr_b16 a[30:31], v12 offset:24576
v_mfma_f32_16x16x32_bf16 v[84:87], a[96:99], a[128:131], v[48:51]
ds_read_b64_tr_b16 a[32:33], v5 offset:16640
v_mfma_f32_16x16x32_bf16 v[92:95], a[96:99], a[132:135], v[52:55]
ds_read_b64_tr_b16 a[34:35], v5 offset:24832
v_mfma_f32_16x16x32_bf16 v[84:87], a[100:103], a[136:139], v[84:87]
ds_read_b64_tr_b16 a[36:37], v6 offset:16640
v_mfma_f32_16x16x32_bf16 v[92:95], a[100:103], a[140:143], v[92:95]
ds_read_b64_tr_b16 a[38:39], v6 offset:24832
buffer_load_dwordx4 v28, s[8:11], s42 offen offset:3072 nt lds
v_mfma_f32_16x16x32_bf16 v[84:87], a[104:107], a[144:147], v[84:87]
ds_read_b64_tr_b16 a[40:41], v7 offset:16640
s_add_u32 s42, s42, 16384
v_mfma_f32_16x16x32_bf16 v[92:95], a[104:107], a[148:151], v[92:95]
ds_read_b64_tr_b16 a[42:43], v7 offset:24832
s_and_b32 s42, s42, 0x3ffff
v_mfma_f32_16x16x32_bf16 v[84:87], a[108:111], a[152:155], v[84:87]
ds_read_b64_tr_b16 a[44:45], v8 offset:16640
v_mul_f32 v80, s48, v80
v_mfma_f32_16x16x32_bf16 v[92:95], a[108:111], a[156:159], v[92:95]
ds_read_b64_tr_b16 a[46:47], v8 offset:24832
v_mul_f32 v81, s48, v81
v_mfma_f32_16x16x32_bf16 v[84:87], a[112:115], a[160:163], v[84:87]
ds_read_b64_tr_b16 a[48:49], v9 offset:16640
v_mul_f32 v82, s48, v82
v_mfma_f32_16x16x32_bf16 v[92:95], a[112:115], a[164:167], v[92:95]
ds_read_b64_tr_b16 a[50:51], v9 offset:24832
v_mul_f32 v83, s48, v83
v_mfma_f32_16x16x32_bf16 v[84:87], a[116:119], a[168:171], v[84:87]
ds_read_b64_tr_b16 a[52:53], v10 offset:16640
v_mul_f32 v88, s48, v88
v_mfma_f32_16x16x32_bf16 v[92:95], a[116:119], a[172:175], v[92:95]
ds_read_b64_tr_b16 a[54:55], v10 offset:24832
v_mul_f32 v89, s48, v89
v_mfma_f32_16x16x32_bf16 v[84:87], a[120:123], a[176:179], v[84:87]
ds_read_b64_tr_b16 a[56:57], v11 offset:16640
v_mul_f32 v90, s48, v90
v_mfma_f32_16x16x32_bf16 v[92:95], a[120:123], a[180:183], v[92:95]
ds_read_b64_tr_b16 a[58:59], v11 offset:24832
v_mul_f32 v91, s48, v91
v_mfma_f32_16x16x32_bf16 v[84:87], a[124:127], a[184:187], v[84:87]
ds_read_b64_tr_b16 a[60:61], v12 offset:16640
v_max3_f32 v47, v80, v81, v82
v_mfma_f32_16x16x32_bf16 v[92:95], a[124:127], a[188:191], v[92:95]
ds_read_b64_tr_b16 a[62:63], v12 offset:24832
s_waitcnt vmcnt(4) lgkmcnt(8)
s_barrier
v_mfma_f32_16x16x32_bf16 v[96:99], a[240:243], v[112:115], v[96:99]
ds_read_b128 a[64:67], v1 offset:0
s_add_u32 m0, s33, 114688
v_mfma_f32_16x16x32_bf16 v[100:103], a[240:243], v[116:119], v[100:103]
ds_read_b128 a[68:71], v2 offset:0
buffer_load_dwordx4 v29, s[12:15], s43 offen nt lds
v_mfma_f32_16x16x32_bf16 v[132:135], a[0:3], v[116:119], v[132:135]
ds_read_b128 a[72:75], v3 offset:0
v_max3_f32 v47, v47, v83, v88
v_mfma_f32_16x16x32_bf16 v[128:131], a[0:3], v[112:115], v[128:131]
ds_read_b128 a[76:79], v4 offset:0
v_max3_f32 v47, v47, v89, v90
v_mfma_f32_16x16x32_bf16 v[136:139], a[4:7], v[112:115], v[136:139]
ds_read_b128 a[80:83], v1 offset:256
v_mul_f32 v84, s48, v84
v_mfma_f32_16x16x32_bf16 v[140:143], a[4:7], v[116:119], v[140:143]
ds_read_b128 a[84:87], v2 offset:256
v_mul_f32 v85, s48, v85
v_mfma_f32_16x16x32_bf16 v[148:151], a[8:11], v[116:119], v[148:151]
ds_read_b128 a[88:91], v3 offset:256
v_mul_f32 v86, s48, v86
v_mfma_f32_16x16x32_bf16 v[144:147], a[8:11], v[112:115], v[144:147]
ds_read_b128 a[92:95], v4 offset:256
s_waitcnt lgkmcnt(8)
v_mfma_f32_16x16x32_bf16 v[152:155], a[12:15], v[112:115], v[152:155]
ds_read_b128 a[96:99], v1 offset:8192
buffer_load_dwordx4 v30, s[12:15], s43 offen offset:1024 nt lds
v_mfma_f32_16x16x32_bf16 v[156:159], a[12:15], v[116:119], v[156:159]
ds_read_b128 a[100:103], v2 offset:8192
v_mul_f32 v87, s48, v87
v_mfma_f32_16x16x32_bf16 v[164:167], a[16:19], v[116:119], v[164:167]
ds_read_b128 a[104:107], v3 offset:8192
v_mul_f32 v92, s48, v92
v_mfma_f32_16x16x32_bf16 v[160:163], a[16:19], v[112:115], v[160:163]
ds_read_b128 a[108:111], v4 offset:8192
v_mul_f32 v93, s48, v93
v_mfma_f32_16x16x32_bf16 v[168:171], a[20:23], v[112:115], v[168:171]
ds_read_b128 a[112:115], v1 offset:8448
v_mul_f32 v94, s48, v94
v_mfma_f32_16x16x32_bf16 v[172:175], a[20:23], v[116:119], v[172:175]
ds_read_b128 a[116:119], v2 offset:8448
v_mul_f32 v95, s48, v95
v_mfma_f32_16x16x32_bf16 v[180:183], a[24:27], v[116:119], v[180:183]
ds_read_b128 a[120:123], v3 offset:8448
v_max3_f32 v47, v47, v91, v84
v_mfma_f32_16x16x32_bf16 v[176:179], a[24:27], v[112:115], v[176:179]
ds_read_b128 a[124:127], v4 offset:8448
v_max3_f32 v47, v47, v85, v86
v_mfma_f32_16x16x32_bf16 v[184:187], a[28:31], v[112:115], v[184:187]
buffer_load_dwordx4 v31, s[12:15], s43 offen offset:2048 nt lds
v_max3_f32 v47, v47, v87, v92
v_mfma_f32_16x16x32_bf16 v[188:191], a[28:31], v[116:119], v[188:191]
v_max3_f32 v47, v47, v93, v94
v_max_f32 v47, v47, v95
v_mfma_f32_16x16x32_bf16 v[196:199], a[32:35], v[116:119], v[196:199]
v_cmp_lt_f32 vcc, 0x41000000, v47
s_cbranch_vccnz L_r1_7
L_b1_7:
v_mfma_f32_16x16x32_bf16 v[192:195], a[32:35], v[112:115], v[192:195]
v_exp_f32 v80, v80
v_mfma_f32_16x16x32_bf16 v[200:203], a[36:39], v[112:115], v[200:203]
v_exp_f32 v81, v81
v_mfma_f32_16x16x32_bf16 v[204:207], a[36:39], v[116:119], v[204:207]
v_exp_f32 v82, v82
v_mfma_f32_16x16x32_bf16 v[212:215], a[40:43], v[116:119], v[212:215]
buffer_load_dwordx4 v32, s[12:15], s43 offen offset:3072 nt lds
s_add_u32 s43, s43, 16384
v_mfma_f32_16x16x32_bf16 v[208:211], a[40:43], v[112:115], v[208:211]
s_and_b32 s43, s43, 0x3ffff
v_exp_f32 v83, v83
v_mfma_f32_16x16x32_bf16 v[216:219], a[44:47], v[112:115], v[216:219]
v_exp_f32 v84, v84
v_mfma_f32_16x16x32_bf16 v[220:223], a[44:47], v[116:119], v[220:223]
v_exp_f32 v85, v85
v_mfma_f32_16x16x32_bf16 v[228:231], a[48:51], v[116:119], v[228:231]
v_exp_f32 v86, v86
v_mfma_f32_16x16x32_bf16 v[224:227], a[48:51], v[112:115], v[224:227]
v_exp_f32 v87, v87
v_mfma_f32_16x16x32_bf16 v[232:235], a[52:55], v[112:115], v[232:235]
v_exp_f32 v88, v88
v_mfma_f32_16x16x32_bf16 v[236:239], a[52:55], v[116:119], v[236:239]
v_exp_f32 v89, v89
v_mfma_f32_16x16x32_bf16 v[244:247], a[56:59], v[116:119], v[244:247]
v_exp_f32 v90, v90
v_mfma_f32_16x16x32_bf16 v[240:243], a[56:59], v[112:115], v[240:243]
v_exp_f32 v91, v91
v_mfma_f32_16x16x32_bf16 v[248:251], a[60:63], v[112:115], v[248:251]
v_exp_f32 v92, v92
v_mfma_f32_16x16x32_bf16 v[252:255], a[60:63], v[116:119], v[252:255]
s_cmp_lg_u32 s51, 0
s_cbranch_scc1 L_r2_7
L_b2_7:
s_waitcnt vmcnt(4) lgkmcnt(0)
s_barrier
v_mfma_f32_16x16x32_bf16 v[64:67], a[64:67], a[128:131], v[48:51]
ds_read_b64_tr_b16 a[0:1], v5 offset:0
s_add_u32 m0, s33, 0
v_mfma_f32_16x16x32_bf16 v[72:75], a[64:67], a[132:135], v[52:55]
ds_read_b64_tr_b16 a[2:3], v5 offset:8192
buffer_load_dwordx4 v25, s[8:11], s42 offen nt lds
v_mfma_f32_16x16x32_bf16 v[64:67], a[68:71], a[136:139], v[64:67]
ds_read_b64_tr_b16 a[4:5], v6 offset:0
v_exp_f32 v93, v93
v_mfma_f32_16x16x32_bf16 v[72:75], a[68:71], a[140:143], v[72:75]
ds_read_b64_tr_b16 a[6:7], v6 offset:8192
v_exp_f32 v94, v94
v_mfma_f32_16x16x32_bf16 v[64:67], a[72:75], a[144:147], v[64:67]
ds_read_b64_tr_b16 a[8:9], v7 offset:0
v_exp_f32 v95, v95
v_mfma_f32_16x16x32_bf16 v[72:75], a[72:75], a[148:151], v[72:75]
ds_read_b64_tr_b16 a[10:11], v7 offset:8192
v_cvt_pk_bf16_f32 v120, v80, v81
v_mfma_f32_16x16x32_bf16 v[64:67], a[76:79], a[152:155], v[64:67]
ds_read_b64_tr_b16 a[12:13], v8 offset:0
v_cvt_pk_bf16_f32 v121, v82, v83
v_mfma_f32_16x16x32_bf16 v[72:75], a[76:79], a[156:159], v[72:75]
ds_read_b64_tr_b16 a[14:15], v8 offset:8192
v_cvt_pk_bf16_f32 v122, v84, v85
v_mfma_f32_16x16x32_bf16 v[64:67], a[80:83], a[160:163], v[64:67]
ds_read_b64_tr_b16 a[16:17], v9 offset:0
v_cvt_pk_bf16_f32 v123, v86, v87
v_mfma_f32_16x16x32_bf16 v[72:75], a[80:83], a[164:167], v[72:75]
ds_read_b64_tr_b16 a[18:19], v9 offset:8192
v_cvt_pk_bf16_f32 v124, v88, v89
v_mfma_f32_16x16x32_bf16 v[64:67], a[84:87], a[168:171], v[64:67]
ds_read_b64_tr_b16 a[20:21], v10 offset:0
buffer_load_dwordx4 v26, s[8:11], s42 offen offset:1024 nt lds
v_mfma_f32_16x16x32_bf16 v[72:75], a[84:87], a[172:175], v[72:75]
ds_read_b64_tr_b16 a[22:23], v10 offset:8192
v_cvt_pk_bf16_f32 v125, v90, v91
v_mfma_f32_16x16x32_bf16 v[64:67], a[88:91], a[176:179], v[64:67]
ds_read_b64_tr_b16 a[24:25], v11 offset:0
v_cvt_pk_bf16_f32 v126, v92, v93
v_mfma_f32_16x16x32_bf16 v[72:75], a[88:91], a[180:183], v[72:75]
ds_read_b64_tr_b16 a[26:27], v11 offset:8192
v_cvt_pk_bf16_f32 v127, v94, v95
v_mfma_f32_16x16x32_bf16 v[64:67], a[92:95], a[184:187], v[64:67]
ds_read_b64_tr_b16 a[28:29], v12 offset:0
v_mfma_f32_16x16x32_bf16 v[72:75], a[92:95], a[188:191], v[72:75]
ds_read_b64_tr_b16 a[30:31], v12 offset:8192
v_mfma_f32_16x16x32_bf16 v[68:71], a[96:99], a[128:131], v[48:51]
ds_read_b64_tr_b16 a[32:33], v5 offset:256
v_mfma_f32_16x16x32_bf16 v[76:79], a[96:99], a[132:135], v[52:55]
ds_read_b64_tr_b16 a[34:35], v5 offset:8448
v_mfma_f32_16x16x32_bf16 v[68:71], a[100:103], a[136:139], v[68:71]
ds_read_b64_tr_b16 a[36:37], v6 offset:256
v_mfma_f32_16x16x32_bf16 v[76:79], a[100:103], a[140:143], v[76:79]
ds_read_b64_tr_b16 a[38:39], v6 offset:8448
buffer_load_dwordx4 v27, s[8:11], s42 offen offset:2048 nt lds
v_mfma_f32_16x16x32_bf16 v[68:71], a[104:107], a[144:147], v[68:71]
ds_read_b64_tr_b16 a[40:41], v7 offset:256
v_mul_f32 v64, s48, v64
v_mfma_f32_16x16x32_bf16 v[76:79], a[104:107], a[148:151], v[76:79]
ds_read_b64_tr_b16 a[42:43], v7 offset:8448
v_mul_f32 v65, s48, v65
v_mfma_f32_16x16x32_bf16 v[68:71], a[108:111], a[152:155], v[68:71]
ds_read_b64_tr_b16 a[44:45], v8 offset:256
v_mul_f32 v66, s48, v66
v_mfma_f32_16x16x32_bf16 v[76:79], a[108:111], a[156:159], v[76:79]
ds_read_b64_tr_b16 a[46:47], v8 offset:8448
v_mul_f32 v67, s48, v67
v_mfma_f32_16x16x32_bf16 v[68:71], a[112:115], a[160:163], v[68:71]
ds_read_b64_tr_b16 a[48:49], v9 offset:256
v_mul_f32 v72, s48, v72
v_mfma_f32_16x16x32_bf16 v[76:79], a[112:115], a[164:167], v[76:79]
ds_read_b64_tr_b16 a[50:51], v9 offset:8448
v_mul_f32 v73, s48, v73
v_mfma_f32_16x16x32_bf16 v[68:71], a[116:119], a[168:171], v[68:71]
ds_read_b64_tr_b16 a[52:53], v10 offset:256
v_mul_f32 v74, s48, v74
v_mfma_f32_16x16x32_bf16 v[76:79], a[116:119], a[172:175], v[76:79]
ds_read_b64_tr_b16 a[54:55], v10 offset:8448
v_mul_f32 v75, s48, v75
v_mfma_f32_16x16x32_bf16 v[68:71], a[120:123], a[176:179], v[68:71]
ds_read_b64_tr_b16 a[56:57], v11 offset:256
v_max3_f32 v47, v64, v65, v66
v_mfma_f32_16x16x32_bf16 v[76:79], a[120:123], a[180:183], v[76:79]
ds_read_b64_tr_b16 a[58:59], v11 offset:8448
v_max3_f32 v47, v47, v67, v72
v_mfma_f32_16x16x32_bf16 v[68:71], a[124:127], a[184:187], v[68:71]
ds_read_b64_tr_b16 a[60:61], v12 offset:256
v_max3_f32 v47, v47, v73, v74
v_mfma_f32_16x16x32_bf16 v[76:79], a[124:127], a[188:191], v[76:79]
ds_read_b64_tr_b16 a[62:63], v12 offset:8448
s_waitcnt vmcnt(4) lgkmcnt(8)
s_barrier
v_mfma_f32_16x16x32_bf16 v[96:99], a[240:243], v[120:123], v[96:99]
ds_read_b128 a[64:67], v1 offset:49152
v_mfma_f32_16x16x32_bf16 v[100:103], a[240:243], v[124:127], v[100:103]
ds_read_b128 a[68:71], v2 offset:49152
buffer_load_dwordx4 v28, s[8:11], s42 offen offset:3072 nt lds
v_mfma_f32_16x16x32_bf16 v[132:135], a[0:3], v[124:127], v[132:135]
ds_read_b128 a[72:75], v3 offset:49152
s_add_u32 s42, s42, 16384
v_mfma_f32_16x16x32_bf16 v[128:131], a[0:3], v[120:123], v[128:131]
ds_read_b128 a[76:79], v4 offset:49152
s_and_b32 s42, s42, 0x3ffff
v_mfma_f32_16x16x32_bf16 v[136:139], a[4:7], v[120:123], v[136:139]
ds_read_b128 a[80:83], v1 offset:49408
v_mul_f32 v68, s48, v68
v_mfma_f32_16x16x32_bf16 v[140:143], a[4:7], v[124:127], v[140:143]
ds_read_b128 a[84:87], v2 offset:49408
v_mul_f32 v69, s48, v69
v_mfma_f32_16x16x32_bf16 v[148:151], a[8:11], v[124:127], v[148:151]
ds_read_b128 a[88:91], v3 offset:49408
L_pad6:
s_cbranch_execz L_hr1
v_mul_f32 v70, s48, v70
v_mfma_f32_16x16x32_bf16 v[144:147], a[8:11], v[120:123], v[144:147]
ds_read_b128 a[92:95], v4 offset:49408
s_waitcnt lgkmcnt(8)
v_mfma_f32_16x16x32_bf16 v[152:155], a[12:15], v[120:123], v[152:155]
ds_read_b128 a[96:99], v1 offset:57344
v_mul_f32 v71, s48, v71
v_mfma_f32_16x16x32_bf16 v[156:159], a[12:15], v[124:127], v[156:159]
ds_read_b128 a[100:103], v2 offset:57344
s_add_u32 m0, s33, 81920
v_mfma_f32_16x16x32_bf16 v[164:167], a[16:19], v[124:127], v[164:167]
ds_read_b128 a[104:107], v3 offset:57344
buffer_load_dwordx4 v29, s[12:15], s43 offen nt lds
v_mfma_f32_16x16x32_bf16 v[160:163], a[16:19], v[120:123], v[160:163]
ds_read_b128 a[108:111], v4 offset:57344
v_mul_f32 v76, s48, v76
v_mfma_f32_16x16x32_bf16 v[168:171], a[20:23], v[120:123], v[168:171]
ds_read_b128 a[112:115], v1 offset:57600
v_mul_f32 v77, s48, v77
v_mfma_f32_16x16x32_bf16 v[172:175], a[20:23], v[124:127], v[172:175]
ds_read_b128 a[116:119], v2 offset:57600
v_mul_f32 v78, s48, v78
v_mfma_f32_16x16x32_bf16 v[180:183], a[24:27], v[124:127], v[180:183]
ds_read_b128 a[120:123], v3 offset:57600
v_mul_f32 v79, s48, v79
v_mfma_f32_16x16x32_bf16 v[176:179], a[24:27], v[120:123], v[176:179]
ds_read_b128 a[124:127], v4 offset:57600
v_max3_f32 v47, v47, v75, v68
v_mfma_f32_16x16x32_bf16 v[184:187], a[28:31], v[120:123], v[184:187]
v_max3_f32 v47, v47, v69, v70
v_max3_f32 v47, v47, v71, v76
v_mfma_f32_16x16x32_bf16 v[188:191], a[28:31], v[124:127], v[188:191]
v_max3_f32 v47, v47, v77, v78
v_max_f32 v47, v47, v79
v_mfma_f32_16x16x32_bf16 v[196:199], a[32:35], v[124:127], v[196:199]
v_cmp_lt_f32 vcc, 0x41000000, v47
s_cbranch_vccnz L_r1_8
L_b1_8:
v_mfma_f32_16x16x32_bf16 v[192:195], a[32:35], v[120:123], v[192:195]
buffer_load_dwordx4 v30, s[12:15], s43 offen offset:1024 nt lds
v_mfma_f32_16x16x32_bf16 v[200:203], a[36:39], v[120:123], v[200:203]
v_exp_f32 v64, v64
v_mfma_f32_16x16x32_bf16 v[204:207], a[36:39], v[124:127], v[204:207]
v_exp_f32 v65, v65
v_mfma_f32_16x16x32_bf16 v[212:215], a[40:43], v[124:127], v[212:215]
v_exp_f32 v66, v66
v_mfma_f32_16x16x32_bf16 v[208:211], a[40:43], v[120:123], v[208:211]
v_exp_f32 v67, v67
v_mfma_f32_16x16x32_bf16 v[216:219], a[44:47], v[120:123], v[216:219]
v_exp_f32 v68, v68
v_mfma_f32_16x16x32_bf16 v[220:223], a[44:47], v[124:127], v[220:223]
v_exp_f32 v69, v69
v_mfma_f32_16x16x32_bf16 v[228:231], a[48:51], v[124:127], v[228:231]
v_exp_f32 v70, v70
v_mfma_f32_16x16x32_bf16 v[224:227], a[48:51], v[120:123], v[224:227]
v_exp_f32 v71, v71
v_mfma_f32_16x16x32_bf16 v[232:235], a[52:55], v[120:123], v[232:235]
v_exp_f32 v72, v72
v_mfma_f32_16x16x32_bf16 v[236:239], a[52:55], v[124:127], v[236:239]
v_exp_f32 v73, v73
v_mfma_f32_16x16x32_bf16 v[244:247], a[56:59], v[124:127], v[244:247]
v_exp_f32 v74, v74
v_mfma_f32_16x16x32_bf16 v[240:243], a[56:59], v[120:123], v[240:243]
v_exp_f32 v75, v75
v_mfma_f32_16x16x32_bf16 v[248:251], a[60:63], v[120:123], v[248:251]
v_exp_f32 v76, v76
v_mfma_f32_16x16x32_bf16 v[252:255], a[60:63], v[124:127], v[252:255]
s_cmp_lg_u32 s51, 0
s_cbranch_scc1 L_r2_8
L_b2_8:
s_waitcnt vmcnt(4) lgkmcnt(0)
s_barrier
v_mfma_f32_16x16x32_bf16 v[80:83], a[64:67], a[128:131], v[48:51]
ds_read_b64_tr_b16 a[0:1], v5 offset:32768
v_exp_f32 v77, v77
v_mfma_f32_16x16x32_bf16 v[88:91], a[64:67], a[132:135], v[52:55]
ds_read_b64_tr_b16 a[2:3], v5 offset:40960
buffer_load_dwordx4 v31, s[12:15], s43 offen offset:2048 nt lds
v_mfma_f32_16x16x32_bf16 v[80:83], a[68:71], a[136:139], v[80:83]
ds_read_b64_tr_b16 a[4:5], v6 offset:32768
v_exp_f32 v78, v78
v_mfma_f32_16x16x32_bf16 v[88:91], a[68:71], a[140:143], v[88:91]
ds_read_b64_tr_b16 a[6:7], v6 offset:40960
v_exp_f32 v79, v79
v_mfma_f32_16x16x32_bf16 v[80:83], a[72:75], a[144:147], v[80:83]
ds_read_b64_tr_b16 a[8:9], v7 offset:32768
v_cvt_pk_bf16_f32 v112, v64, v65
v_mfma_f32_16x16x32_bf16 v[88:91], a[72:75], a[148:151], v[88:91]
ds_read_b64_tr_b16 a[10:11], v7 offset:40960
v_cvt_pk_bf16_f32 v113, v66, v67
v_mfma_f32_16x16x32_bf16 v[80:83], a[76:79], a[152:155], v[80:83]
ds_read_b64_tr_b16 a[12:13], v8 offset:32768
v_cvt_pk_bf16_f32 v114, v68, v69
v_mfma_f32_16x16x32_bf16 v[88:91], a[76:79], a[156:159], v[88:91]
ds_read_b64_tr_b16 a[14:15], v8 offset:40960
v_cvt_pk_bf16_f32 v115, v70, v71
v_mfma_f32_16x16x32_bf16 v[80:83], a[80:83], a[160:163], v[80:83]
ds_read_b64_tr_b16 a[16:17], v9 offset:32768
v_cvt_pk_bf16_f32 v116, v72, v73
v_mfma_f32_16x16x32_bf16 v[88:91], a[80:83], a[164:167], v[88:91]
ds_read_b64_tr_b16 a[18:19], v9 offset:40960
v_cvt_pk_bf16_f32 v117, v74, v75
v_mfma_f32_16x16x32_bf16 v[80:83], a[84:87], a[168:171], v[80:83]
ds_read_b64_tr_b16 a[20:21], v10 offset:32768
buffer_load_dwordx4 v32, s[12:15], s43 offen offset:3072 nt lds
v_mfma_f32_16x16x32_bf16 v[88:91], a[84:87], a[172:175], v[88:91]
ds_read_b64_tr_b16 a[22:23], v10 offset:40960
s_add_u32 s43, s43, 16384
v_mfma_f32_16x16x32_bf16 v[80:83], a[88:91], a[176:179], v[80:83]
ds_read_b64_tr_b16 a[24:25], v11 offset:32768
s_and_b32 s43, s43, 0x3ffff
v_mfma_f32_16x16x32_bf16 v[88:91], a[88:91], a[180:183], v[88:91]
ds_read_b64_tr_b16 a[26:27], v11 offset:40960
v_cvt_pk_bf16_f32 v118, v76, v77
v_mfma_f32_16x16x32_bf16 v[80:83], a[92:95], a[184:187], v[80:83]
ds_read_b64_tr_b16 a[28:29], v12 offset:32768
v_cvt_pk_bf16_f32 v119, v78, v79
v_mfma_f32_16x16x32_bf16 v[88:91], a[92:95], a[188:191], v[88:91]
ds_read_b64_tr_b16 a[30:31], v12 offset:40960
v_mfma_f32_16x16x32_bf16 v[84:87], a[96:99], a[128:131], v[48:51]
ds_read_b64_tr_b16 a[32:33], v5 offset:33024
v_mfma_f32_16x16x32_bf16 v[92:95], a[96:99], a[132:135], v[52:55]
ds_read_b64_tr_b16 a[34:35], v5 offset:41216
v_mfma_f32_16x16x32_bf16 v[84:87], a[100:103], a[136:139], v[84:87]
ds_read_b64_tr_b16 a[36:37], v6 offset:33024
s_add_u32 m0, s33, 32768
v_mfma_f32_16x16x32_bf16 v[92:95], a[100:103], a[140:143], v[92:95]
ds_read_b64_tr_b16 a[38:39], v6 offset:41216
buffer_load_dwordx4 v25, s[8:11], s42 offen nt lds
v_mfma_f32_16x16x32_bf16 v[84:87], a[104:107], a[144:147], v[84:87]
ds_read_b64_tr_b16 a[40:41], v7 offset:33024
v_mul_f32 v80, s48, v80
v_mfma_f32_16x16x32_bf16 v[92:95], a[104:107], a[148:151], v[92:95]
ds_read_b64_tr_b16 a[42:43], v7 offset:41216
v_mul_f32 v81, s48, v81
v_mfma_f32_16x16x32_bf16 v[84:87], a[108:111], a[152:155], v[84:87]
ds_read_b64_tr_b16 a[44:45], v8 offset:33024
v_mul_f32 v82, s48, v82
v_mfma_f32_16x16x32_bf16 v[92:95], a[108:111], a[156:159], v[92:95]
ds_read_b64_tr_b16 a[46:47], v8 offset:41216
v_mul_f32 v83, s48, v83
v_mfma_f32_16x16x32_bf16 v[84:87], a[112:115], a[160:163], v[84:87]
ds_read_b64_tr_b16 a[48:49], v9 offset:33024
v_mul_f32 v88, s48, v88
v_mfma_f32_16x16x32_bf16 v[92:95], a[112:115], a[164:167], v[92:95]
ds_read_b64_tr_b16 a[50:51], v9 offset:41216
v_mul_f32 v89, s48, v89
v_mfma_f32_16x16x32_bf16 v[84:87], a[116:119], a[168:171], v[84:87]
ds_read_b64_tr_b16 a[52:53], v10 offset:33024
v_mul_f32 v90, s48, v90
v_mfma_f32_16x16x32_bf16 v[92:95], a[116:119], a[172:175], v[92:95]
ds_read_b64_tr_b16 a[54:55], v10 offset:41216
v_mul_f32 v91, s48, v91
v_mfma_f32_16x16x32_bf16 v[84:87], a[120:123], a[176:179], v[84:87]
ds_read_b64_tr_b16 a[56:57], v11 offset:33024
v_max3_f32 v47, v80, v81, v82
v_mfma_f32_16x16x32_bf16 v[92:95], a[120:123], a[180:183], v[92:95]
ds_read_b64_tr_b16 a[58:59], v11 offset:41216
v_max3_f32 v47, v47, v83, v88
v_mfma_f32_16x16x32_bf16 v[84:87], a[124:127], a[184:187], v[84:87]
ds_read_b64_tr_b16 a[60:61], v12 offset:33024
v_max3_f32 v47, v47, v89, v90
v_mfma_f32_16x16x32_bf16 v[92:95], a[124:127], a[188:191], v[92:95]
ds_read_b64_tr_b16 a[62:63], v12 offset:41216
s_waitcnt vmcnt(4) lgkmcnt(8)
s_barrier
v_mfma_f32_16x16x32_bf16 v[96:99], a[240:243], v[112:115], v[96:99]
ds_read_b128 a[64:67], v1 offset:16384
v_mfma_f32_16x16x32_bf16 v[100:103], a[240:243], v[116:119], v[100:103]
ds_read_b128 a[68:71], v2 offset:16384
buffer_load_dwordx4 v26, s[8:11], s42 offen offset:1024 nt lds
v_mfma_f32_16x16x32_bf16 v[132:135], a[0:3], v[116:119], v[132:135]
ds_read_b128 a[72:75], v3 offset:16384
v_mfma_f32_16x16x32_bf16 v[128:131], a[0:3], v[112:115], v[128:131]
ds_read_b128 a[76:79], v4 offset:16384
v_mul_f32 v84, s48, v84
v_mfma_f32_16x16x32_bf16 v[136:139], a[4:7], v[112:115], v[136:139]
ds_read_b128 a[80:83], v1 offset:16640
v_mul_f32 v85, s48, v85
v_mfma_f32_16x16x32_bf16 v[140:143], a[4:7], v[116:119], v[140:143]
ds_read_b128 a[84:87], v2 offset:16640
v_mul_f32 v86, s48, v86
v_mfma_f32_16x16x32_bf16 v[148:151], a[8:11], v[116:119], v[148:151]
ds_read_b128 a[88:91], v3 offset:16640
v_mul_f32 v87, s48, v87
v_mfma_f32_16x16x32_bf16 v[144:147], a[8:11], v[112:115], v[144:147]
ds_read_b128 a[92:95], v4 offset:16640
s_waitcnt lgkmcnt(8)
v_mfma_f32_16x16x32_bf16 v[152:155], a[12:15], v[112:115], v[152:155]
ds_read_b128 a[96:99], v1 offset:24576
v_mul_f32 v92, s48, v92
v_mfma_f32_16x16x32_bf16 v[156:159], a[12:15], v[116:119], v[156:159]
ds_read_b128 a[100:103], v2 offset:24576
v_mul_f32 v93, s48, v93
v_mfma_f32_16x16x32_bf16 v[164:167], a[16:19], v[116:119], v[164:167]
ds_read_b128 a[104:107], v3 offset:24576
buffer_load_dwordx4 v27, s[8:11], s42 offen offset:2048 nt lds
v_mfma_f32_16x16x32_bf16 v[160:163], a[16:19], v[112:115], v[160:163]
ds_read_b128 a[108:111], v4 offset:24576
v_mul_f32 v94, s48, v94
v_mfma_f32_16x16x32_bf16 v[168:171], a[20:23], v[112:115], v[168:171]
ds_read_b128 a[112:115], v1 offset:24832
v_mul_f32 v95, s48, v95
v_mfma_f32_16x16x32_bf16 v[172:175], a[20:23], v[116:119], v[172:175]
ds_read_b128 a[116:119], v2 offset:24832
v_max3_f32 v47, v47, v91, v84
v_mfma_f32_16x16x32_bf16 v[180:183], a[24:27], v[116:119], v[180:183]
ds_read_b128 a[120:123], v3 offset:24832
v_max3_f32 v47, v47, v85, v86
v_mfma_f32_16x16x32_bf16 v[176:179], a[24:27], v[112:115], v[176:179]
ds_read_b128 a[124:127], v4 offset:24832
v_max3_f32 v47, v47, v87, v92
v_mfma_f32_16x16x32_bf16 v[184:187], a[28:31], v[112:115], v[184:187]
v_max3_f32 v47, v47, v93, v94
v_max_f32 v47, v47, v95
v_mfma_f32_16x16x32_bf16 v[188:191], a[28:31], v[116:119], v[188:191]
v_cmp_lt_f32 vcc, 0x41000000, v47
s_cbranch_vccnz L_r1_9
L_b1_9:
v_mfma_f32_16x16x32_bf16 v[196:199], a[32:35], v[116:119], v[196:199]
v_exp_f32 v80, v80
v_mfma_f32_16x16x32_bf16 v[192:195], a[32:35], v[112:115], v[192:195]
buffer_load_dwordx4 v28, s[8:11], s42 offen offset:3072 nt lds
s_add_u32 s42, s42, 16384
v_mfma_f32_16x16x32_bf16 v[200:203], a[36:39], v[112:115], v[200:203]
s_and_b32 s42, s42, 0x3ffff
v_exp_f32 v81, v81
v_mfma_f32_16x16x32_bf16 v[204:207], a[36:39], v[116:119], v[204:207]
v_exp_f32 v82, v82
v_mfma_f32_16x16x32_bf16 v[212:215], a[40:43], v[116:119], v[212:215]
v_exp_f32 v83, v83
v_mfma_f32_16x16x32_bf16 v[208:211], a[40:43], v[112:115], v[208:211]
v_exp_f32 v84, v84
v_mfma_f32_16x16x32_bf16 v[216:219], a[44:47], v[112:115], v[216:219]
v_exp_f32 v85, v85
v_mfma_f32_16x16x32_bf16 v[220:223], a[44:47], v[116:119], v[220:223]
v_exp_f32 v86, v86
v_mfma_f32_16x16x32_bf16 v[228:231], a[48:51], v[116:119], v[228:231]
v_exp_f32 v87, v87
v_mfma_f32_16x16x32_bf16 v[224:227], a[48:51], v[112:115], v[224:227]
v_exp_f32 v88, v88
v_mfma_f32_16x16x32_bf16 v[232:235], a[52:55], v[112:115], v[232:235]
v_exp_f32 v89, v89
v_mfma_f32_16x16x32_bf16 v[236:239], a[52:55], v[116:119], v[236:239]
v_exp_f32 v90, v90
v_mfma_f32_16x16x32_bf16 v[244:247], a[56:59], v[116:119], v[244:247]
v_exp_f32 v91, v91
v_mfma_f32_16x16x32_bf16 v[240:243], a[56:59], v[112:115], v[240:243]
v_exp_f32 v92, v92
v_mfma_f32_16x16x32_bf16 v[248:251], a[60:63], v[112:115], v[248:251]
v_exp_f32 v93, v93
v_mfma_f32_16x16x32_bf16 v[252:255], a[60:63], v[116:119], v[252:255]
s_cmp_lg_u32 s51, 0
s_cbranch_scc1 L_r2_9
L_b2_9:
s_waitcnt vmcnt(4) lgkmcnt(0)
s_barrier
v_mfma_f32_16x16x32_bf16 v[64:67], a[64:67], a[128:131], v[48:51]
ds_read_b64_tr_b16 a[0:1], v5 offset:49152
s_add_u32 m0, s33, 65536
v_mfma_f32_16x16x32_bf16 v[72:75], a[64:67], a[132:135], v[52:55]
ds_read_b64_tr_b16 a[2:3], v5 offset:57344
buffer_load_dwordx4 v29, s[12:15], s43 offen nt lds
v_mfma_f32_16x16x32_bf16 v[64:67], a[68:71], a[136:139], v[64:67]
ds_read_b64_tr_b16 a[4:5], v6 offset:49152
v_exp_f32 v94, v94
v_mfma_f32_16x16x32_bf16 v[72:75], a[68:71], a[140:143], v[72:75]
ds_read_b64_tr_b16 a[6:7], v6 offset:57344
v_exp_f32 v95, v95
v_mfma_f32_16x16x32_bf16 v[64:67], a[72:75], a[144:147], v[64:67]
ds_read_b64_tr_b16 a[8:9], v7 offset:49152
v_cvt_pk_bf16_f32 v120, v80, v81
v_mfma_f32_16x16x32_bf16 v[72:75], a[72:75], a[148:151], v[72:75]
ds_read_b64_tr_b16 a[10:11], v7 offset:57344
v_cvt_pk_bf16_f32 v121, v82, v83
v_mfma_f32_16x16x32_bf16 v[64:67], a[76:79], a[152:155], v[64:67]
ds_read_b64_tr_b16 a[12:13], v8 offset:49152
v_cvt_pk_bf16_f32 v122, v84, v85
v_mfma_f32_16x16x32_bf16 v[72:75], a[76:79], a[156:159], v[72:75]
ds_read_b64_tr_b16 a[14:15], v8 offset:57344
v_cvt_pk_bf16_f32 v123, v86, v87
v_mfma_f32_16x16x32_bf16 v[64:67], a[80:83], a[160:163], v[64:67]
ds_read_b64_tr_b16 a[16:17], v9 offset:49152
buffer_load_dwordx4 v30, s[12:15], s43 offen offset:1024 nt lds
v_mfma_f32_16x16x32_bf16 v[72:75], a[80:83], a[164:167], v[72:75]
ds_read_b64_tr_b16 a[18:19], v9 offset:57344
v_cvt_pk_bf16_f32 v124, v88, v89
v_mfma_f32_16x16x32_bf16 v[64:67], a[84:87], a[168:171], v[64:67]
ds_read_b64_tr_b16 a[20:21], v10 offset:49152
v_cvt_pk_bf16_f32 v125, v90, v91
v_mfma_f32_16x16x32_bf16 v[72:75], a[84:87], a[172:175], v[72:75]
ds_read_b64_tr_b16 a[22:23], v10 offset:57344
v_cvt_pk_bf16_f32 v126, v92, v93
v_mfma_f32_16x16x32_bf16 v[64:67], a[88:91], a[176:179], v[64:67]
ds_read_b64_tr_b16 a[24:25], v11 offset:49152
v_cvt_pk_bf16_f32 v127, v94, v95
v_mfma_f32_16x16x32_bf16 v[72:75], a[88:91], a[180:183], v[72:75]
ds_read_b64_tr_b16 a[26:27], v11 offset:57344
v_mfma_f32_16x16x32_bf16 v[64:67], a[92:95], a[184:187], v[64:67]
ds_read_b64_tr_b16 a[28:29], v12 offset:49152
v_mfma_f32_16x16x32_bf16 v[72:75], a[92:95], a[188:191], v[72:75]
ds_read_b64_tr_b16 a[30:31], v12 offset:57344
buffer_load_dwordx4 v31, s[12:15], s43 offen offset:2048 nt lds
v_mfma_f32_16x16x32_bf16 v[68:71], a[96:99], a[128:131], v[48:51]
ds_read_b64_tr_b16 a[32:33], v5 offset:49408
v_mfma_f32_16x16x32_bf16 v[76:79], a[96:99], a[132:135], v[52:55]
ds_read_b64_tr_b16 a[34:35], v5 offset:57600
v_mfma_f32_16x16x32_bf16 v[68:71], a[100:103], a[136:139], v[68:71]
ds_read_b64_tr_b16 a[36:37], v6 offset:49408
v_mfma_f32_16x16x32_bf16 v[76:79], a[100:103], a[140:143], v[76:79]
ds_read_b64_tr_b16 a[38:39], v6 offset:57600
v_mul_f32 v64, s48, v64
v_mfma_f32_16x16x32_bf16 v[68:71], a[104:107], a[144:147], v[68:71]
ds_read_b64_tr_b16 a[40:41], v7 offset:49408
v_mul_f32 v65, s48, v65
v_mfma_f32_16x16x32_bf16 v[76:79], a[104:107], a[148:151], v[76:79]
ds_read_b64_tr_b16 a[42:43], v7 offset:57600
v_mul_f32 v66, s48, v66
v_mfma_f32_16x16x32_bf16 v[68:71], a[108:111], a[152:155], v[68:71]
ds_read_b64_tr_b16 a[44:45], v8 offset:49408
buffer_load_dword v57, v56, s[28:31], 0 offen sc1
v_mfma_f32_16x16x32_bf16 v[76:79], a[108:111], a[156:159], v[76:79]
ds_read_b64_tr_b16 a[46:47], v8 offset:57600
v_mul_f32 v67, s48, v67
v_mfma_f32_16x16x32_bf16 v[68:71], a[112:115], a[160:163], v[68:71]
ds_read_b64_tr_b16 a[48:49], v9 offset:49408
v_mul_f32 v72, s48, v72
v_mfma_f32_16x16x32_bf16 v[76:79], a[112:115], a[164:167], v[76:79]
ds_read_b64_tr_b16 a[50:51], v9 offset:57600
v_mul_f32 v73, s48, v73
v_mfma_f32_16x16x32_bf16 v[68:71], a[116:119], a[168:171], v[68:71]
ds_read_b64_tr_b16 a[52:53], v10 offset:49408
v_mul_f32 v74, s48, v74
v_mfma_f32_16x16x32_bf16 v[76:79], a[116:119], a[172:175], v[76:79]
ds_read_b64_tr_b16 a[54:55], v10 offset:57600
v_mul_f32 v75, s48, v75
v_mfma_f32_16x16x32_bf16 v[68:71], a[120:123], a[176:179], v[68:71]
ds_read_b64_tr_b16 a[56:57], v11 offset:49408
v_max3_f32 v47, v64, v65, v66
v_mfma_f32_16x16x32_bf16 v[76:79], a[120:123], a[180:183], v[76:79]
ds_read_b64_tr_b16 a[58:59], v11 offset:57600
v_max3_f32 v47, v47, v67, v72
v_mfma_f32_16x16x32_bf16 v[68:71], a[124:127], a[184:187], v[68:71]
ds_read_b64_tr_b16 a[60:61], v12 offset:49408
v_max3_f32 v47, v47, v73, v74
v_mfma_f32_16x16x32_bf16 v[76:79], a[124:127], a[188:191], v[76:79]
ds_read_b64_tr_b16 a[62:63], v12 offset:57600
s_waitcnt vmcnt(4) lgkmcnt(8)
s_barrier
v_mfma_f32_16x16x32_bf16 v[96:99], a[240:243], v[120:123], v[96:99]
ds_read_b128 a[64:67], v1 offset:0
v_mfma_f32_16x16x32_bf16 v[100:103], a[240:243], v[124:127], v[100:103]
ds_read_b128 a[68:71], v2 offset:0
buffer_load_dwordx4 v32, s[12:15], s43 offen offset:3072 nt lds
v_mfma_f32_16x16x32_bf16 v[132:135], a[0:3], v[124:127], v[132:135]
ds_read_b128 a[72:75], v3 offset:0
s_add_u32 s43, s43, 16384
v_mfma_f32_16x16x32_bf16 v[128:131], a[0:3], v[120:123], v[128:131]
ds_read_b128 a[76:79], v4 offset:0
s_and_b32 s43, s43, 0x3ffff
v_mfma_f32_16x16x32_bf16 v[136:139], a[4:7], v[120:123], v[136:139]
ds_read_b128 a[80:83], v1 offset:256
v_mul_f32 v68, s48, v68
v_mfma_f32_16x16x32_bf16 v[140:143], a[4:7], v[124:127], v[140:143]
ds_read_b128 a[84:87], v2 offset:256
v_mul_f32 v69, s48, v69
v_mfma_f32_16x16x32_bf16 v[148:151], a[8:11], v[124:127], v[148:151]
ds_read_b128 a[88:91], v3 offset:256
v_mul_f32 v70, s48, v70
v_mfma_f32_16x16x32_bf16 v[144:147], a[8:11], v[120:123], v[144:147]
ds_read_b128 a[92:95], v4 offset:256
s_waitcnt lgkmcnt(8)
v_mfma_f32_16x16x32_bf16 v[152:155], a[12:15], v[120:123], v[152:155]
ds_read_b128 a[96:99], v1 offset:8192
v_mul_f32 v71, s48, v71
v_mfma_f32_16x16x32_bf16 v[156:159], a[12:15], v[124:127], v[156:159]
ds_read_b128 a[100:103], v2 offset:8192
s_add_u32 m0, s33, 16384
v_mfma_f32_16x16x32_bf16 v[164:167], a[16:19], v[124:127], v[164:167]
ds_read_b128 a[104:107], v3 offset:8192
buffer_load_dwordx4 v25, s[8:11], s42 offen nt lds
v_mfma_f32_16x16x32_bf16 v[160:163], a[16:19], v[120:123], v[160:163]
ds_read_b128 a[108:111], v4 offset:8192
v_mul_f32 v76, s48, v76
v_mfma_f32_16x16x32_bf16 v[168:171], a[20:23], v[120:123], v[168:171]
ds_read_b128 a[112:115], v1 offset:8448
v_mul_f32 v77, s48, v77
v_mfma_f32_16x16x32_bf16 v[172:175], a[20:23], v[124:127], v[172:175]
ds_read_b128 a[116:119], v2 offset:8448
v_mul_f32 v78, s48, v78
v_mfma_f32_16x16x32_bf16 v[180:183], a[24:27], v[124:127], v[180:183]
ds_read_b128 a[120:123], v3 offset:8448
v_mul_f32 v79, s48, v79
v_mfma_f32_16x16x32_bf16 v[176:179], a[24:27], v[120:123], v[176:179]
ds_read_b128 a[124:127], v4 offset:8448
v_max3_f32 v47, v47, v75, v68
v_mfma_f32_16x16x32_bf16 v[184:187], a[28:31], v[120:123], v[184:187]
v_max3_f32 v47, v47, v69, v70
v_max3_f32 v47, v47, v71, v76
v_mfma_f32_16x16x32_bf16 v[188:191], a[28:31], v[124:127], v[188:191]
v_max3_f32 v47, v47, v77, v78
v_max_f32 v47, v47, v79
v_mfma_f32_16x16x32_bf16 v[196:199], a[32:35], v[124:127], v[196:199]
v_cmp_lt_f32 vcc, 0x41000000, v47
s_cbranch_vccnz L_r1_10
L_b1_10:
v_mfma_f32_16x16x32_bf16 v[192:195], a[32:35], v[120:123], v[192:195]
buffer_load_dwordx4 v26, s[8:11], s42 offen offset:1024 nt lds
v_mfma_f32_16x16x32_bf16 v[200:203], a[36:39], v[120:123], v[200:203]
v_exp_f32 v64, v64
v_mfma_f32_16x16x32_bf16 v[204:207], a[36:39], v[124:127], v[204:207]
v_exp_f32 v65, v65
v_mfma_f32_16x16x32_bf16 v[212:215], a[40:43], v[124:127], v[212:215]
v_exp_f32 v66, v66
v_mfma_f32_16x16x32_bf16 v[208:211], a[40:43], v[120:123], v[208:211]
v_exp_f32 v67, v67
v_mfma_f32_16x16x32_bf16 v[216:219], a[44:47], v[120:123], v[216:219]
v_exp_f32 v68, v68
v_mfma_f32_16x16x32_bf16 v[220:223], a[44:47], v[124:127], v[220:223]
v_exp_f32 v69, v69
v_mfma_f32_16x16x32_bf16 v[228:231], a[48:51], v[124:127], v[228:231]
v_exp_f32 v70, v70
v_mfma_f32_16x16x32_bf16 v[224:227], a[48:51], v[120:123], v[224:227]
v_exp_f32 v71, v71
v_mfma_f32_16x16x32_bf16 v[232:235], a[52:55], v[120:123], v[232:235]
v_exp_f32 v72, v72
v_mfma_f32_16x16x32_bf16 v[236:239], a[52:55], v[124:127], v[236:239]
v_exp_f32 v73, v73
v_mfma_f32_16x16x32_bf16 v[244:247], a[56:59], v[124:127], v[244:247]
v_exp_f32 v74, v74
v_mfma_f32_16x16x32_bf16 v[240:243], a[56:59], v[120:123], v[240:243]
v_exp_f32 v75, v75
v_mfma_f32_16x16x32_bf16 v[248:251], a[60:63], v[120:123], v[248:251]
v_exp_f32 v76, v76
v_mfma_f32_16x16x32_bf16 v[252:255], a[60:63], v[124:127], v[252:255]
s_cmp_lg_u32 s51, 0
s_cbranch_scc1 L_r2_10
L_b2_10:
s_waitcnt vmcnt(4) lgkmcnt(0)
s_barrier
v_mfma_f32_16x16x32_bf16 v[80:83], a[64:67], a[128:131], v[48:51]
ds_read_b64_tr_b16 a[0:1], v5 offset:16384
v_exp_f32 v77, v77
v_mfma_f32_16x16x32_bf16 v[88:91], a[64:67], a[132:135], v[52:55]
ds_read_b64_tr_b16 a[2:3], v5 offset:24576
buffer_load_dwordx4 v27, s[8:11], s42 offen offset:2048 nt lds
v_mfma_f32_16x16x32_bf16 v[80:83], a[68:71], a[136:139], v[80:83]
ds_read_b64_tr_b16 a[4:5], v6 offset:16384
v_exp_f32 v78, v78
v_mfma_f32_16x16x32_bf16 v[88:91], a[68:71], a[140:143], v[88:91]
ds_read_b64_tr_b16 a[6:7], v6 offset:24576
v_exp_f32 v79, v79
v_mfma_f32_16x16x32_bf16 v[80:83], a[72:75], a[144:147], v[80:83]
ds_read_b64_tr_b16 a[8:9], v7 offset:16384
v_cvt_pk_bf16_f32 v112, v64, v65
v_mfma_f32_16x16x32_bf16 v[88:91], a[72:75], a[148:151], v[88:91]
ds_read_b64_tr_b16 a[10:11], v7 offset:24576
v_cvt_pk_bf16_f32 v113, v66, v67
v_mfma_f32_16x16x32_bf16 v[80:83], a[76:79], a[152:155], v[80:83]
ds_read_b64_tr_b16 a[12:13], v8 offset:16384
v_cvt_pk_bf16_f32 v114, v68, v69
v_mfma_f32_16x16x32_bf16 v[88:91], a[76:79], a[156:159], v[88:91]
ds_read_b64_tr_b16 a[14:15], v8 offset:24576
v_cvt_pk_bf16_f32 v115, v70, v71
v_mfma_f32_16x16x32_bf16 v[80:83], a[80:83], a[160:163], v[80:83]
ds_read_b64_tr_b16 a[16:17], v9 offset:16384
buffer_load_dwordx4 v28, s[8:11], s42 offen offset:3072 nt lds
v_mfma_f32_16x16x32_bf16 v[88:91], a[80:83], a[164:167], v[88:91]
ds_read_b64_tr_b16 a[18:19], v9 offset:24576
s_add_u32 s42, s42, 16384
v_mfma_f32_16x16x32_bf16 v[80:83], a[84:87], a[168:171], v[80:83]
ds_read_b64_tr_b16 a[20:21], v10 offset:16384
s_and_b32 s42, s42, 0x3ffff
v_mfma_f32_16x16x32_bf16 v[88:91], a[84:87], a[172:175], v[88:91]
ds_read_b64_tr_b16 a[22:23], v10 offset:24576
v_cvt_pk_bf16_f32 v116, v72, v73
v_mfma_f32_16x16x32_bf16 v[80:83], a[88:91], a[176:179], v[80:83]
ds_read_b64_tr_b16 a[24:25], v11 offset:16384
v_cvt_pk_bf16_f32 v117, v74, v75
v_mfma_f32_16x16x32_bf16 v[88:91], a[88:91], a[180:183], v[88:91]
ds_read_b64_tr_b16 a[26:27], v11 offset:24576
v_cvt_pk_bf16_f32 v118, v76, v77
v_mfma_f32_16x16x32_bf16 v[80:83], a[92:95], a[184:187], v[80:83]
ds_read_b64_tr_b16 a[28:29], v12 offset:16384
s_add_u32 m0, s33, 98304
v_mfma_f32_16x16x32_bf16 v[88:91], a[92:95], a[188:191], v[88:91]
ds_read_b64_tr_b16 a[30:31], v12 offset:24576
buffer_load_dwordx4 v29, s[12:15], s43 offen nt lds
v_mfma_f32_16x16x32_bf16 v[84:87], a[96:99], a[128:131], v[48:51]
ds_read_b64_tr_b16 a[32:33], v5 offset:16640
v_cvt_pk_bf16_f32 v119, v78, v79
v_mfma_f32_16x16x32_bf16 v[92:95], a[96:99], a[132:135], v[52:55]
ds_read_b64_tr_b16 a[34:35], v5 offset:24832
v_mfma_f32_16x16x32_bf16 v[84:87], a[100:103], a[136:139], v[84:87]
ds_read_b64_tr_b16 a[36:37], v6 offset:16640
v_mfma_f32_16x16x32_bf16 v[92:95], a[100:103], a[140:143], v[92:95]
ds_read_b64_tr_b16 a[38:39], v6 offset:24832
v_mul_f32 v80, s48, v80
v_mfma_f32_16x16x32_bf16 v[84:87], a[104:107], a[144:147], v[84:87]
ds_read_b64_tr_b16 a[40:41], v7 offset:16640
v_mul_f32 v81, s48, v81
v_mfma_f32_16x16x32_bf16 v[92:95], a[104:107], a[148:151], v[92:95]
ds_read_b64_tr_b16 a[42:43], v7 offset:24832
v_mul_f32 v82, s48, v82
v_mfma_f32_16x16x32_bf16 v[84:87], a[108:111], a[152:155], v[84:87]
ds_read_b64_tr_b16 a[44:45], v8 offset:16640
buffer_load_dwordx4 v30, s[12:15], s43 offen offset:1024 nt lds
v_mfma_f32_16x16x32_bf16 v[92:95], a[108:111], a[156:159], v[92:95]
ds_read_b64_tr_b16 a[46:47], v8 offset:24832
v_mul_f32 v83, s48, v83
v_mfma_f32_16x16x32_bf16 v[84:87], a[112:115], a[160:163], v[84:87]
ds_read_b64_tr_b16 a[48:49], v9 offset:16640
v_mul_f32 v88, s48, v88
v_mfma_f32_16x16x32_bf16 v[92:95], a[112:115], a[164:167], v[92:95]
ds_read_b64_tr_b16 a[50:51], v9 offset:24832
v_mul_f32 v89, s48, v89
v_mfma_f32_16x16x32_bf16 v[84:87], a[116:119], a[168:171], v[84:87]
ds_read_b64_tr_b16 a[52:53], v10 offset:16640
v_mul_f32 v90, s48, v90
v_mfma_f32_16x16x32_bf16 v[92:95], a[116:119], a[172:175], v[92:95]
ds_read_b64_tr_b16 a[54:55], v10 offset:24832
v_mul_f32 v91, s48, v91
v_mfma_f32_16x16x32_bf16 v[84:87], a[120:123], a[176:179], v[84:87]
ds_read_b64_tr_b16 a[56:57], v11 offset:16640
v_max3_f32 v47, v80, v81, v82
v_mfma_f32_16x16x32_bf16 v[92:95], a[120:123], a[180:183], v[92:95]
ds_read_b64_tr_b16 a[58:59], v11 offset:24832
v_max3_f32 v47, v47, v83, v88
v_mfma_f32_16x16x32_bf16 v[84:87], a[124:127], a[184:187], v[84:87]
ds_read_b64_tr_b16 a[60:61], v12 offset:16640
v_max3_f32 v47, v47, v89, v90
v_mfma_f32_16x16x32_bf16 v[92:95], a[124:127], a[188:191], v[92:95]
ds_read_b64_tr_b16 a[62:63], v12 offset:24832
s_waitcnt vmcnt(4) lgkmcnt(8)
s_barrier
v_mfma_f32_16x16x32_bf16 v[96:99], a[240:243], v[112:115], v[96:99]
ds_read_b128 a[64:67], v1 offset:32768
v_mfma_f32_16x16x32_bf16 v[100:103], a[240:243], v[116:119], v[100:103]
ds_read_b128 a[68:71], v2 offset:32768
buffer_load_dwordx4 v31, s[12:15], s43 offen offset:2048 nt lds
v_mfma_f32_16x16x32_bf16 v[132:135], a[0:3], v[116:119], v[132:135]
ds_read_b128 a[72:75], v3 offset:32768
v_mfma_f32_16x16x32_bf16 v[128:131], a[0:3], v[112:115], v[128:131]
ds_read_b128 a[76:79], v4 offset:32768
v_mul_f32 v84, s48, v84
v_mfma_f32_16x16x32_bf16 v[136:139], a[4:7], v[112:115], v[136:139]
ds_read_b128 a[80:83], v1 offset:33024
v_mul_f32 v85, s48, v85
v_mfma_f32_16x16x32_bf16 v[140:143], a[4:7], v[116:119], v[140:143]
ds_read_b128 a[84:87], v2 offset:33024
v_mul_f32 v86, s48, v86
v_mfma_f32_16x16x32_bf16 v[148:151], a[8:11], v[116:119], v[148:151]
ds_read_b128 a[88:91], v3 offset:33024
v_mul_f32 v87, s48, v87
v_mfma_f32_16x16x32_bf16 v[144:147], a[8:11], v[112:115], v[144:147]
ds_read_b128 a[92:95], v4 offset:33024
s_waitcnt lgkmcnt(8)
v_mfma_f32_16x16x32_bf16 v[152:155], a[12:15], v[112:115], v[152:155]
ds_read_b128 a[96:99], v1 offset:40960
v_mul_f32 v92, s48, v92
v_mfma_f32_16x16x32_bf16 v[156:159], a[12:15], v[116:119], v[156:159]
ds_read_b128 a[100:103], v2 offset:40960
v_mul_f32 v93, s48, v93
v_mfma_f32_16x16x32_bf16 v[164:167], a[16:19], v[116:119], v[164:167]
ds_read_b128 a[104:107], v3 offset:40960
buffer_load_dwordx4 v32, s[12:15], s43 offen offset:3072 nt lds
v_mfma_f32_16x16x32_bf16 v[160:163], a[16:19], v[112:115], v[160:163]
ds_read_b128 a[108:111], v4 offset:40960
s_add_u32 s43, s43, 16384
v_mfma_f32_16x16x32_bf16 v[168:171], a[20:23], v[112:115], v[168:171]
ds_read_b128 a[112:115], v1 offset:41216
s_and_b32 s43, s43, 0x3ffff
v_mfma_f32_16x16x32_bf16 v[172:175], a[20:23], v[116:119], v[172:175]
ds_read_b128 a[116:119], v2 offset:41216
v_mul_f32 v94, s48, v94
v_mfma_f32_16x16x32_bf16 v[180:183], a[24:27], v[116:119], v[180:183]
ds_read_b128 a[120:123], v3 offset:41216
v_mul_f32 v95, s48, v95
v_mfma_f32_16x16x32_bf16 v[176:179], a[24:27], v[112:115], v[176:179]
ds_read_b128 a[124:127], v4 offset:41216
v_max3_f32 v47, v47, v91, v84
v_mfma_f32_16x16x32_bf16 v[184:187], a[28:31], v[112:115], v[184:187]
v_max3_f32 v47, v47, v85, v86
L_pad7:
s_cbranch_execz L_hr1
v_max3_f32 v47, v47, v87, v92
v_mfma_f32_16x16x32_bf16 v[188:191], a[28:31], v[116:119], v[188:191]
v_max3_f32 v47, v47, v93, v94
v_max_f32 v47, v47, v95
v_mfma_f32_16x16x32_bf16 v[196:199], a[32:35], v[116:119], v[196:199]
s_add_u32 m0, s33, 0
v_cmp_lt_f32 vcc, 0x41000000, v47
s_cbranch_vccnz L_r1_11
L_b1_11:
v_mfma_f32_16x16x32_bf16 v[192:195], a[32:35], v[112:115], v[192:195]
buffer_load_dwordx4 v25, s[8:11], s42 offen nt lds
v_mfma_f32_16x16x32_bf16 v[200:203], a[36:39], v[112:115], v[200:203]
v_exp_f32 v80, v80
v_mfma_f32_16x16x32_bf16 v[204:207], a[36:39], v[116:119], v[204:207]
v_exp_f32 v81, v81
v_mfma_f32_16x16x32_bf16 v[212:215], a[40:43], v[116:119], v[212:215]
v_exp_f32 v82, v82
v_mfma_f32_16x16x32_bf16 v[208:211], a[40:43], v[112:115], v[208:211]
v_exp_f32 v83, v83
v_mfma_f32_16x16x32_bf16 v[216:219], a[44:47], v[112:115], v[216:219]
v_exp_f32 v84, v84
v_mfma_f32_16x16x32_bf16 v[220:223], a[44:47], v[116:119], v[220:223]
v_exp_f32 v85, v85
v_mfma_f32_16x16x32_bf16 v[228:231], a[48:51], v[116:119], v[228:231]
v_exp_f32 v86, v86
v_mfma_f32_16x16x32_bf16 v[224:227], a[48:51], v[112:115], v[224:227]
v_exp_f32 v87, v87
v_mfma_f32_16x16x32_bf16 v[232:235], a[52:55], v[112:115], v[232:235]
v_exp_f32 v88, v88
v_mfma_f32_16x16x32_bf16 v[236:239], a[52:55], v[116:119], v[236:239]
v_exp_f32 v89, v89
v_mfma_f32_16x16x32_bf16 v[244:247], a[56:59], v[116:119], v[244:247]
v_exp_f32 v90, v90
v_mfma_f32_16x16x32_bf16 v[240:243], a[56:59], v[112:115], v[240:243]
v_exp_f32 v91, v91
v_mfma_f32_16x16x32_bf16 v[248:251], a[60:63], v[112:115], v[248:251]
v_exp_f32 v92, v92
v_mfma_f32_16x16x32_bf16 v[252:255], a[60:63], v[116:119], v[252:255]
s_cmp_lg_u32 s51, 0
s_cbranch_scc1 L_r2_11
L_b2_11:
s_waitcnt vmcnt(4) lgkmcnt(0)
s_barrier
v_mfma_f32_16x16x32_bf16 v[64:67], a[64:67], a[128:131], v[48:51]
ds_read_b64_tr_b16 a[0:1], v5 offset:0
v_exp_f32 v93, v93
v_mfma_f32_16x16x32_bf16 v[72:75], a[64:67], a[132:135], v[52:55]
ds_read_b64_tr_b16 a[2:3], v5 offset:8192
buffer_load_dwordx4 v26, s[8:11], s42 offen offset:1024 nt lds
v_mfma_f32_16x16x32_bf16 v[64:67], a[68:71], a[136:139], v[64:67]
ds_read_b64_tr_b16 a[4:5], v6 offset:0
v_exp_f32 v94, v94
v_mfma_f32_16x16x32_bf16 v[72:75], a[68:71], a[140:143], v[72:75]
ds_read_b64_tr_b16 a[6:7], v6 offset:8192
v_exp_f32 v95, v95
v_mfma_f32_16x16x32_bf16 v[64:67], a[72:75], a[144:147], v[64:67]
ds_read_b64_tr_b16 a[8:9], v7 offset:0
v_cvt_pk_bf16_f32 v120, v80, v81
v_mfma_f32_16x16x32_bf16 v[72:75], a[72:75], a[148:151], v[72:75]
ds_read_b64_tr_b16 a[10:11], v7 offset:8192
v_cvt_pk_bf16_f32 v121, v82, v83
v_mfma_f32_16x16x32_bf16 v[64:67], a[76:79], a[152:155], v[64:67]
ds_read_b64_tr_b16 a[12:13], v8 offset:0
v_cvt_pk_bf16_f32 v122, v84, v85
v_mfma_f32_16x16x32_bf16 v[72:75], a[76:79], a[156:159], v[72:75]
ds_read_b64_tr_b16 a[14:15], v8 offset:8192
v_cvt_pk_bf16_f32 v123, v86, v87
v_mfma_f32_16x16x32_bf16 v[64:67], a[80:83], a[160:163], v[64:67]
ds_read_b64_tr_b16 a[16:17], v9 offset:0
v_cvt_pk_bf16_f32 v124, v88, v89
v_mfma_f32_16x16x32_bf16 v[72:75], a[80:83], a[164:167], v[72:75]
ds_read_b64_tr_b16 a[18:19], v9 offset:8192
v_cvt_pk_bf16_f32 v125, v90, v91
v_mfma_f32_16x16x32_bf16 v[64:67], a[84:87], a[168:171], v[64:67]
ds_read_b64_tr_b16 a[20:21], v10 offset:0
buffer_load_dwordx4 v27, s[8:11], s42 offen offset:2048 nt lds
v_mfma_f32_16x16x32_bf16 v[72:75], a[84:87], a[172:175], v[72:75]
ds_read_b64_tr_b16 a[22:23], v10 offset:8192
v_cvt_pk_bf16_f32 v126, v92, v93
v_mfma_f32_16x16x32_bf16 v[64:67], a[88:91], a[176:179], v[64:67]
ds_read_b64_tr_b16 a[24:25], v11 offset:0
v_cvt_pk_bf16_f32 v127, v94, v95
v_mfma_f32_16x16x32_bf16 v[72:75], a[88:91], a[180:183], v[72:75]
ds_read_b64_tr_b16 a[26:27], v11 offset:8192
v_mfma_f32_16x16x32_bf16 v[64:67], a[92:95], a[184:187], v[64:67]
ds_read_b64_tr_b16 a[28:29], v12 offset:0
v_mfma_f32_16x16x32_bf16 v[72:75], a[92:95], a[188:191], v[72:75]
ds_read_b64_tr_b16 a[30:31], v12 offset:8192
v_mfma_f32_16x16x32_bf16 v[68:71], a[96:99], a[128:131], v[48:51]
ds_read_b64_tr_b16 a[32:33], v5 offset:256
v_mfma_f32_16x16x32_bf16 v[76:79], a[96:99], a[132:135], v[52:55]
ds_read_b64_tr_b16 a[34:35], v5 offset:8448
v_mfma_f32_16x16x32_bf16 v[68:71], a[100:103], a[136:139], v[68:71]
ds_read_b64_tr_b16 a[36:37], v6 offset:256
v_mfma_f32_16x16x32_bf16 v[76:79], a[100:103], a[140:143], v[76:79]
ds_read_b64_tr_b16 a[38:39], v6 offset:8448
buffer_load_dwordx4 v28, s[8:11], s42 offen offset:3072 nt lds
v_mfma_f32_16x16x32_bf16 v[68:71], a[104:107], a[144:147], v[68:71]
ds_read_b64_tr_b16 a[40:41], v7 offset:256
s_add_u32 s42, s42, 16384
v_mfma_f32_16x16x32_bf16 v[76:79], a[104:107], a[148:151], v[76:79]
ds_read_b64_tr_b16 a[42:43], v7 offset:8448
s_and_b32 s42, s42, 0x3ffff
v_mfma_f32_16x16x32_bf16 v[68:71], a[108:111], a[152:155], v[68:71]
ds_read_b64_tr_b16 a[44:45], v8 offset:256
v_mul_f32 v64, s48, v64
v_mfma_f32_16x16x32_bf16 v[76:79], a[108:111], a[156:159], v[76:79]
ds_read_b64_tr_b16 a[46:47], v8 offset:8448
v_mul_f32 v65, s48, v65
v_mfma_f32_16x16x32_bf16 v[68:71], a[112:115], a[160:163], v[68:71]
ds_read_b64_tr_b16 a[48:49], v9 offset:256
v_mul_f32 v66, s48, v66
v_mfma_f32_16x16x32_bf16 v[76:79], a[112:115], a[164:167], v[76:79]
ds_read_b64_tr_b16 a[50:51], v9 offset:8448
v_mul_f32 v67, s48, v67
v_mfma_f32_16x16x32_bf16 v[68:71], a[116:119], a[168:171], v[68:71]
ds_read_b64_tr_b16 a[52:53], v10 offset:256
v_mul_f32 v72, s48, v72
v_mfma_f32_16x16x32_bf16 v[76:79], a[116:119], a[172:175], v[76:79]
ds_read_b64_tr_b16 a[54:55], v10 offset:8448
v_mul_f32 v73, s48, v73
v_mfma_f32_16x16x32_bf16 v[68:71], a[120:123], a[176:179], v[68:71]
ds_read_b64_tr_b16 a[56:57], v11 offset:256
v_mul_f32 v74, s48, v74
v_mfma_f32_16x16x32_bf16 v[76:79], a[120:123], a[180:183], v[76:79]
ds_read_b64_tr_b16 a[58:59], v11 offset:8448
v_mul_f32 v75, s48, v75
v_mfma_f32_16x16x32_bf16 v[68:71], a[124:127], a[184:187], v[68:71]
ds_read_b64_tr_b16 a[60:61], v12 offset:256
v_max3_f32 v47, v64, v65, v66
v_mfma_f32_16x16x32_bf16 v[76:79], a[124:127], a[188:191], v[76:79]
ds_read_b64_tr_b16 a[62:63], v12 offset:8448
s_waitcnt vmcnt(4) lgkmcnt(8)
s_barrier
v_mfma_f32_16x16x32_bf16 v[96:99], a[240:243], v[120:123], v[96:99]
ds_read_b128 a[64:67], v1 offset:16384
s_add_u32 m0, s33, 81920
v_mfma_f32_16x16x32_bf16 v[100:103], a[240:243], v[124:127], v[100:103]
ds_read_b128 a[68:71], v2 offset:16384
buffer_load_dwordx4 v29, s[12:15], s43 offen nt lds
v_mfma_f32_16x16x32_bf16 v[132:135], a[0:3], v[124:127], v[132:135]
ds_read_b128 a[72:75], v3 offset:16384
v_max3_f32 v47, v47, v67, v72
v_mfma_f32_16x16x32_bf16 v[128:131], a[0:3], v[120:123], v[128:131]
ds_read_b128 a[76:79], v4 offset:16384
v_max3_f32 v47, v47, v73, v74
v_mfma_f32_16x16x32_bf16 v[136:139], a[4:7], v[120:123], v[136:139]
ds_read_b128 a[80:83], v1 offset:16640
v_mul_f32 v68, s48, v68
v_mfma_f32_16x16x32_bf16 v[140:143], a[4:7], v[124:127], v[140:143]
ds_read_b128 a[84:87], v2 offset:16640
v_mul_f32 v69, s48, v69
v_mfma_f32_16x16x32_bf16 v[148:151], a[8:11], v[124:127], v[148:151]
ds_read_b128 a[88:91], v3 offset:16640
v_mul_f32 v70, s48, v70
v_mfma_f32_16x16x32_bf16 v[144:147], a[8:11], v[120:123], v[144:147]
ds_read_b128 a[92:95], v4 offset:16640
s_waitcnt lgkmcnt(8)
v_mfma_f32_16x16x32_bf16 v[152:155], a[12:15], v[120:123], v[152:155]
ds_read_b128 a[96:99], v1 offset:24576
v_mul_f32 v71, s48, v71
v_mfma_f32_16x16x32_bf16 v[156:159], a[12:15], v[124:127], v[156:159]
ds_read_b128 a[100:103], v2 offset:24576
v_mul_f32 v76, s48, v76
v_mfma_f32_16x16x32_bf16 v[164:167], a[16:19], v[124:127], v[164:167]
ds_read_b128 a[104:107], v3 offset:24576
buffer_load_dwordx4 v30, s[12:15], s43 offen offset:1024 nt lds
v_mfma_f32_16x16x32_bf16 v[160:163], a[16:19], v[120:123], v[160:163]
ds_read_b128 a[108:111], v4 offset:24576
v_mul_f32 v77, s48, v77
v_mfma_f32_16x16x32_bf16 v[168:171], a[20:23], v[120:123], v[168:171]
ds_read_b128 a[112:115], v1 offset:24832
v_mul_f32 v78, s48, v78
v_mfma_f32_16x16x32_bf16 v[172:175], a[20:23], v[124:127], v[172:175]
ds_read_b128 a[116:119], v2 offset:24832
v_mul_f32 v79, s48, v79
v_mfma_f32_16x16x32_bf16 v[180:183], a[24:27], v[124:127], v[180:183]
ds_read_b128 a[120:123], v3 offset:24832
v_max3_f32 v47, v47, v75, v68
v_mfma_f32_16x16x32_bf16 v[176:179], a[24:27], v[120:123], v[176:179]
ds_read_b128 a[124:127], v4 offset:24832
v_max3_f32 v47, v47, v69, v70
v_mfma_f32_16x16x32_bf16 v[184:187], a[28:31], v[120:123], v[184:187]
v_max3_f32 v47, v47, v71, v76
v_max3_f32 v47, v47, v77, v78
v_mfma_f32_16x16x32_bf16 v[188:191], a[28:31], v[124:127], v[188:191]
v_max_f32 v47, v47, v79
v_cmp_lt_f32 vcc, 0x41000000, v47
v_mfma_f32_16x16x32_bf16 v[196:199], a[32:35], v[124:127], v[196:199]
s_cbranch_vccnz L_r1_12
L_b1_12:
v_exp_f32 v64, v64
v_mfma_f32_16x16x32_bf16 v[192:195], a[32:35], v[120:123], v[192:195]
buffer_load_dwordx4 v31, s[12:15], s43 offen offset:2048 nt lds
v_mfma_f32_16x16x32_bf16 v[200:203], a[36:39], v[120:123], v[200:203]
v_exp_f32 v65, v65
v_mfma_f32_16x16x32_bf16 v[204:207], a[36:39], v[124:127], v[204:207]
v_exp_f32 v66, v66
v_mfma_f32_16x16x32_bf16 v[212:215], a[40:43], v[124:127], v[212:215]
v_exp_f32 v67, v67
v_mfma_f32_16x16x32_bf16 v[208:211], a[40:43], v[120:123], v[208:211]
v_exp_f32 v68, v68
v_mfma_f32_16x16x32_bf16 v[216:219], a[44:47], v[120:123], v[216:219]
v_exp_f32 v69, v69
v_mfma_f32_16x16x32_bf16 v[220:223], a[44:47], v[124:127], v[220:223]
v_exp_f32 v70, v70
v_mfma_f32_16x16x32_bf16 v[228:231], a[48:51], v[124:127], v[228:231]
v_exp_f32 v71, v71
v_mfma_f32_16x16x32_bf16 v[224:227], a[48:51], v[120:123], v[224:227]
v_exp_f32 v72, v72
v_mfma_f32_16x16x32_bf16 v[232:235], a[52:55], v[120:123], v[232:235]
v_exp_f32 v73, v73
v_mfma_f32_16x16x32_bf16 v[236:239], a[52:55], v[124:127], v[236:239]
v_exp_f32 v74, v74
v_mfma_f32_16x16x32_bf16 v[244:247], a[56:59], v[124:127], v[244:247]
v_exp_f32 v75, v75
v_mfma_f32_16x16x32_bf16 v[240:243], a[56:59], v[120:123], v[240:243]
v_exp_f32 v76, v76
v_mfma_f32_16x16x32_bf16 v[248:251], a[60:63], v[120:123], v[248:251]
v_exp_f32 v77, v77
v_mfma_f32_16x16x32_bf16 v[252:255], a[60:63], v[124:127], v[252:255]
s_cmp_lg_u32 s51, 0
s_cbranch_scc1 L_r2_12
L_b2_12:
s_waitcnt vmcnt(4) lgkmcnt(0)
s_barrier
v_mfma_f32_16x16x32_bf16 v[80:83], a[64:67], a[128:131], v[48:51]
ds_read_b64_tr_b16 a[0:1], v5 offset:32768
v_exp_f32 v78, v78
v_mfma_f32_16x16x32_bf16 v[88:91], a[64:67], a[132:135], v[52:55]
ds_read_b64_tr_b16 a[2:3], v5 offset:40960
buffer_load_dwordx4 v32, s[12:15], s43 offen offset:3072 nt lds
v_mfma_f32_16x16x32_bf16 v[80:83], a[68:71], a[136:139], v[80:83]
ds_read_b64_tr_b16 a[4:5], v6 offset:32768
s_add_u32 s43, s43, 16384
v_mfma_f32_16x16x32_bf16 v[88:91], a[68:71], a[140:143], v[88:91]
ds_read_b64_tr_b16 a[6:7], v6 offset:40960
s_and_b32 s43, s43, 0x3ffff
v_mfma_f32_16x16x32_bf16 v[80:83], a[72:75], a[144:147], v[80:83]
ds_read_b64_tr_b16 a[8:9], v7 offset:32768
v_exp_f32 v79, v79
v_mfma_f32_16x16x32_bf16 v[88:91], a[72:75], a[148:151], v[88:91]
ds_read_b64_tr_b16 a[10:11], v7 offset:40960
v_cvt_pk_bf16_f32 v112, v64, v65
v_mfma_f32_16x16x32_bf16 v[80:83], a[76:79], a[152:155], v[80:83]
ds_read_b64_tr_b16 a[12:13], v8 offset:32768
v_cvt_pk_bf16_f32 v113, v66, v67
v_mfma_f32_16x16x32_bf16 v[88:91], a[76:79], a[156:159], v[88:91]
ds_read_b64_tr_b16 a[14:15], v8 offset:40960
s_add_u32 m0, s33, 16384
v_mfma_f32_16x16x32_bf16 v[80:83], a[80:83], a[160:163], v[80:83]
ds_read_b64_tr_b16 a[16:17], v9 offset:32768
buffer_load_dwordx4 v25, s[8:11], s42 offen nt lds
v_mfma_f32_16x16x32_bf16 v[88:91], a[80:83], a[164:167], v[88:91]
ds_read_b64_tr_b16 a[18:19], v9 offset:40960
v_cvt_pk_bf16_f32 v114, v68, v69
v_mfma_f32_16x16x32_bf16 v[80:83], a[84:87], a[168:171], v[80:83]
ds_read_b64_tr_b16 a[20:21], v10 offset:32768
v_cvt_pk_bf16_f32 v115, v70, v71
v_mfma_f32_16x16x32_bf16 v[88:91], a[84:87], a[172:175], v[88:91]
ds_read_b64_tr_b16 a[22:23], v10 offset:40960
v_cvt_pk_bf16_f32 v116, v72, v73
v_mfma_f32_16x16x32_bf16 v[80:83], a[88:91], a[176:179], v[80:83]
ds_read_b64_tr_b16 a[24:25], v11 offset:32768
v_cvt_pk_bf16_f32 v117, v74, v75
v_mfma_f32_16x16x32_bf16 v[88:91], a[88:91], a[180:183], v[88:91]
ds_read_b64_tr_b16 a[26:27], v11 offset:40960
v_cvt_pk_bf16_f32 v118, v76, v77
v_mfma_f32_16x16x32_bf16 v[80:83], a[92:95], a[184:187], v[80:83]
ds_read_b64_tr_b16 a[28:29], v12 offset:32768
v_cvt_pk_bf16_f32 v119, v78, v79
v_mfma_f32_16x16x32_bf16 v[88:91], a[92:95], a[188:191], v[88:91]
ds_read_b64_tr_b16 a[30:31], v12 offset:40960
buffer_load_dwordx4 v26, s[8:11], s42 offen offset:1024 nt lds
v_mfma_f32_16x16x32_bf16 v[84:87], a[96:99], a[128:131], v[48:51]
ds_read_b64_tr_b16 a[32:33], v5 offset:33024
v_mfma_f32_16x16x32_bf16 v[92:95], a[96:99], a[132:135], v[52:55]
ds_read_b64_tr_b16 a[34:35], v5 offset:41216
v_mfma_f32_16x16x32_bf16 v[84:87], a[100:103], a[136:139], v[84:87]
ds_read_b64_tr_b16 a[36:37], v6 offset:33024
v_mfma_f32_16x16x32_bf16 v[92:95], a[100:103], a[140:143], v[92:95]
ds_read_b64_tr_b16 a[38:39], v6 offset:41216
v_mul_f32 v80, s48, v80
v_mfma_f32_16x16x32_bf16 v[84:87], a[104:107], a[144:147], v[84:87]
ds_read_b64_tr_b16 a[40:41], v7 offset:33024
v_mul_f32 v81, s48, v81
v_mfma_f32_16x16x32_bf16 v[92:95], a[104:107], a[148:151], v[92:95]
ds_read_b64_tr_b16 a[42:43], v7 offset:41216
v_mul_f32 v82, s48, v82
v_mfma_f32_16x16x32_bf16 v[84:87], a[108:111], a[152:155], v[84:87]
ds_read_b64_tr_b16 a[44:45], v8 offset:33024
buffer_load_dwordx4 v27, s[8:11], s42 offen offset:2048 nt lds
v_mfma_f32_16x16x32_bf16 v[92:95], a[108:111], a[156:159], v[92:95]
ds_read_b64_tr_b16 a[46:47], v8 offset:41216
v_mul_f32 v83, s48, v83
v_mfma_f32_16x16x32_bf16 v[84:87], a[112:115], a[160:163], v[84:87]
ds_read_b64_tr_b16 a[48:49], v9 offset:33024
v_mul_f32 v88, s48, v88
v_mfma_f32_16x16x32_bf16 v[92:95], a[112:115], a[164:167], v[92:95]
ds_read_b64_tr_b16 a[50:51], v9 offset:41216
v_mul_f32 v89, s48, v89
v_mfma_f32_16x16x32_bf16 v[84:87], a[116:119], a[168:171], v[84:87]
ds_read_b64_tr_b16 a[52:53], v10 offset:33024
v_mul_f32 v90, s48, v90
v_mfma_f32_16x16x32_bf16 v[92:95], a[116:119], a[172:175], v[92:95]
ds_read_b64_tr_b16 a[54:55], v10 offset:41216
v_mul_f32 v91, s48, v91
v_mfma_f32_16x16x32_bf16 v[84:87], a[120:123], a[176:179], v[84:87]
ds_read_b64_tr_b16 a[56:57], v11 offset:33024
v_max3_f32 v47, v80, v81, v82
v_mfma_f32_16x16x32_bf16 v[92:95], a[120:123], a[180:183], v[92:95]
ds_read_b64_tr_b16 a[58:59], v11 offset:41216
v_max3_f32 v47, v47, v83, v88
v_mfma_f32_16x16x32_bf16 v[84:87], a[124:127], a[184:187], v[84:87]
ds_read_b64_tr_b16 a[60:61], v12 offset:33024
v_max3_f32 v47, v47, v89, v90
v_mfma_f32_16x16x32_bf16 v[92:95], a[124:127], a[188:191], v[92:95]
ds_read_b64_tr_b16 a[62:63], v12 offset:41216
s_waitcnt vmcnt(4) lgkmcnt(8)
s_barrier
v_mfma_f32_16x16x32_bf16 v[96:99], a[240:243], v[112:115], v[96:99]
ds_read_b128 a[64:67], v1 offset:0
v_mfma_f32_16x16x32_bf16 v[100:103], a[240:243], v[116:119], v[100:103]
ds_read_b128 a[68:71], v2 offset:0
buffer_load_dwordx4 v28, s[8:11], s42 offen offset:3072 nt lds
v_mfma_f32_16x16x32_bf16 v[132:135], a[0:3], v[116:119], v[132:135]
ds_read_b128 a[72:75], v3 offset:0
s_add_u32 s42, s42, 16384
v_mfma_f32_16x16x32_bf16 v[128:131], a[0:3], v[112:115], v[128:131]
ds_read_b128 a[76:79], v4 offset:0
s_and_b32 s42, s42, 0x3ffff
v_mfma_f32_16x16x32_bf16 v[136:139], a[4:7], v[112:115], v[136:139]
ds_read_b128 a[80:83], v1 offset:256
v_mul_f32 v84, s48, v84
v_mfma_f32_16x16x32_bf16 v[140:143], a[4:7], v[116:119], v[140:143]
ds_read_b128 a[84:87], v2 offset:256
v_mul_f32 v85, s48, v85
v_mfma_f32_16x16x32_bf16 v[148:151], a[8:11], v[116:119], v[148:151]
ds_read_b128 a[88:91], v3 offset:256
v_mul_f32 v86, s48, v86
v_mfma_f32_16x16x32_bf16 v[144:147], a[8:11], v[112:115], v[144:147]
ds_read_b128 a[92:95], v4 offset:256
s_add_u32 m0, s33, 65536
v_mfma_f32_16x16x32_bf16 v[152:155], a[12:15], v[112:115], v[152:155]
ds_read_b128 a[96:99], v1 offset:8192
s_waitcnt lgkmcnt(9)
v_mfma_f32_16x16x32_bf16 v[156:159], a[12:15], v[116:119], v[156:159]
ds_read_b128 a[100:103], v2 offset:8192
buffer_load_dwordx4 v29, s[12:15], s43 offen nt lds
v_mfma_f32_16x16x32_bf16 v[164:167], a[16:19], v[116:119], v[164:167]
ds_read_b128 a[104:107], v3 offset:8192
v_mul_f32 v87, s48, v87
v_mfma_f32_16x16x32_bf16 v[160:163], a[16:19], v[112:115], v[160:163]
ds_read_b128 a[108:111], v4 offset:8192
v_mul_f32 v92, s48, v92
v_mfma_f32_16x16x32_bf16 v[168:171], a[20:23], v[112:115], v[168:171]
ds_read_b128 a[112:115], v1 offset:8448
v_mul_f32 v93, s48, v93
v_mfma_f32_16x16x32_bf16 v[172:175], a[20:23], v[116:119], v[172:175]
ds_read_b128 a[116:119], v2 offset:8448
v_mul_f32 v94, s48, v94
v_mfma_f32_16x16x32_bf16 v[180:183], a[24:27], v[116:119], v[180:183]
ds_read_b128 a[120:123], v3 offset:8448
v_mul_f32 v95, s48, v95
v_mfma_f32_16x16x32_bf16 v[176:179], a[24:27], v[112:115], v[176:179]
ds_read_b128 a[124:127], v4 offset:8448
v_max3_f32 v47, v47, v91, v84
v_mfma_f32_16x16x32_bf16 v[184:187], a[28:31], v[112:115], v[184:187]
buffer_load_dwordx4 v30, s[12:15], s43 offen offset:1024 nt lds
v_max3_f32 v47, v47, v85, v86
v_mfma_f32_16x16x32_bf16 v[188:191], a[28:31], v[116:119], v[188:191]
v_max3_f32 v47, v47, v87, v92
v_max3_f32 v47, v47, v93, v94
v_mfma_f32_16x16x32_bf16 v[196:199], a[32:35], v[116:119], v[196:199]
v_max_f32 v47, v47, v95
v_cmp_lt_f32 vcc, 0x41000000, v47
v_mfma_f32_16x16x32_bf16 v[192:195], a[32:35], v[112:115], v[192:195]
s_cbranch_vccnz L_r1_13
L_b1_13:
v_exp_f32 v80, v80
v_mfma_f32_16x16x32_bf16 v[200:203], a[36:39], v[112:115], v[200:203]
v_exp_f32 v81, v81
v_mfma_f32_16x16x32_bf16 v[204:207], a[36:39], v[116:119], v[204:207]
v_exp_f32 v82, v82
v_mfma_f32_16x16x32_bf16 v[212:215], a[40:43], v[116:119], v[212:215]
buffer_load_dword v0, v61, s[60:63], 0 offen sc1
v_mfma_f32_16x16x32_bf16 v[208:211], a[40:43], v[112:115], v[208:211]
v_exp_f32 v83, v83
v_mfma_f32_16x16x32_bf16 v[216:219], a[44:47], v[112:115], v[216:219]
v_exp_f32 v84, v84
v_mfma_f32_16x16x32_bf16 v[220:223], a[44:47], v[116:119], v[220:223]
v_exp_f32 v85, v85
v_mfma_f32_16x16x32_bf16 v[228:231], a[48:51], v[116:119], v[228:231]
v_exp_f32 v86, v86
v_mfma_f32_16x16x32_bf16 v[224:227], a[48:51], v[112:115], v[224:227]
v_exp_f32 v87, v87
v_mfma_f32_16x16x32_bf16 v[232:235], a[52:55], v[112:115], v[232:235]
v_exp_f32 v88, v88
v_mfma_f32_16x16x32_bf16 v[236:239], a[52:55], v[116:119], v[236:239]
v_exp_f32 v89, v89
v_mfma_f32_16x16x32_bf16 v[244:247], a[56:59], v[116:119], v[244:247]
v_exp_f32 v90, v90
v_mfma_f32_16x16x32_bf16 v[240:243], a[56:59], v[112:115], v[240:243]
v_exp_f32 v91, v91
v_mfma_f32_16x16x32_bf16 v[248:251], a[60:63], v[112:115], v[248:251]
v_exp_f32 v92, v92
v_mfma_f32_16x16x32_bf16 v[252:255], a[60:63], v[116:119], v[252:255]
s_cmp_lg_u32 s51, 0
s_cbranch_scc1 L_r2_13
L_b2_13:
s_waitcnt vmcnt(4) lgkmcnt(0)
s_barrier
v_mfma_f32_16x16x32_bf16 v[64:67], a[64:67], a[128:131], v[48:51]
ds_read_b64_tr_b16 a[0:1], v5 offset:16384
v_exp_f32 v93, v93
v_mfma_f32_16x16x32_bf16 v[72:75], a[64:67], a[132:135], v[52:55]
ds_read_b64_tr_b16 a[2:3], v5 offset:24576
buffer_load_dwordx4 v31, s[12:15], s43 offen offset:2048 nt lds
v_mfma_f32_16x16x32_bf16 v[64:67], a[68:71], a[136:139], v[64:67]
ds_read_b64_tr_b16 a[4:5], v6 offset:16384
v_exp_f32 v94, v94
v_mfma_f32_16x16x32_bf16 v[72:75], a[68:71], a[140:143], v[72:75]
ds_read_b64_tr_b16 a[6:7], v6 offset:24576
v_exp_f32 v95, v95
v_mfma_f32_16x16x32_bf16 v[64:67], a[72:75], a[144:147], v[64:67]
ds_read_b64_tr_b16 a[8:9], v7 offset:16384
v_cvt_pk_bf16_f32 v120, v80, v81
v_mfma_f32_16x16x32_bf16 v[72:75], a[72:75], a[148:151], v[72:75]
ds_read_b64_tr_b16 a[10:11], v7 offset:24576
v_cvt_pk_bf16_f32 v121, v82, v83
v_mfma_f32_16x16x32_bf16 v[64:67], a[76:79], a[152:155], v[64:67]
ds_read_b64_tr_b16 a[12:13], v8 offset:16384
v_cvt_pk_bf16_f32 v122, v84, v85
v_mfma_f32_16x16x32_bf16 v[72:75], a[76:79], a[156:159], v[72:75]
ds_read_b64_tr_b16 a[14:15], v8 offset:24576
v_cvt_pk_bf16_f32 v123, v86, v87
v_mfma_f32_16x16x32_bf16 v[64:67], a[80:83], a[160:163], v[64:67]
ds_read_b64_tr_b16 a[16:17], v9 offset:16384
v_cvt_pk_bf16_f32 v124, v88, v89
v_mfma_f32_16x16x32_bf16 v[72:75], a[80:83], a[164:167], v[72:75]
ds_read_b64_tr_b16 a[18:19], v9 offset:24576
v_cvt_pk_bf16_f32 v125, v90, v91
v_mfma_f32_16x16x32_bf16 v[64:67], a[84:87], a[168:171], v[64:67]
ds_read_b64_tr_b16 a[20:21], v10 offset:16384
buffer_load_dwordx4 v32, s[12:15], s43 offen offset:3072 nt lds
v_mfma_f32_16x16x32_bf16 v[72:75], a[84:87], a[172:175], v[72:75]
ds_read_b64_tr_b16 a[22:23], v10 offset:24576
s_add_u32 s43, s43, 16384
v_mfma_f32_16x16x32_bf16 v[64:67], a[88:91], a[176:179], v[64:67]
ds_read_b64_tr_b16 a[24:25], v11 offset:16384
s_and_b32 s43, s43, 0x3ffff
v_mfma_f32_16x16x32_bf16 v[72:75], a[88:91], a[180:183], v[72:75]
ds_read_b64_tr_b16 a[26:27], v11 offset:24576
v_cvt_pk_bf16_f32 v126, v92, v93
v_mfma_f32_16x16x32_bf16 v[64:67], a[92:95], a[184:187], v[64:67]
ds_read_b64_tr_b16 a[28:29], v12 offset:16384
v_cvt_pk_bf16_f32 v127, v94, v95
v_mfma_f32_16x16x32_bf16 v[72:75], a[92:95], a[188:191], v[72:75]
ds_read_b64_tr_b16 a[30:31], v12 offset:24576
v_mfma_f32_16x16x32_bf16 v[68:71], a[96:99], a[128:131], v[48:51]
ds_read_b64_tr_b16 a[32:33], v5 offset:16640
v_mfma_f32_16x16x32_bf16 v[76:79], a[96:99], a[132:135], v[52:55]
ds_read_b64_tr_b16 a[34:35], v5 offset:24832
v_mfma_f32_16x16x32_bf16 v[68:71], a[100:103], a[136:139], v[68:71]
ds_read_b64_tr_b16 a[36:37], v6 offset:16640
s_add_u32 m0, s33, 98304
v_mfma_f32_16x16x32_bf16 v[76:79], a[100:103], a[140:143], v[76:79]
ds_read_b64_tr_b16 a[38:39], v6 offset:24832
buffer_load_dwordx4 v29, s[12:15], s43 offen nt lds
v_mfma_f32_16x16x32_bf16 v[68:71], a[104:107], a[144:147], v[68:71]
ds_read_b64_tr_b16 a[40:41], v7 offset:16640
v_mul_f32 v64, s48, v64
v_mfma_f32_16x16x32_bf16 v[76:79], a[104:107], a[148:151], v[76:79]
ds_read_b64_tr_b16 a[42:43], v7 offset:24832
v_mul_f32 v65, s48, v65
v_mfma_f32_16x16x32_bf16 v[68:71], a[108:111], a[152:155], v[68:71]
ds_read_b64_tr_b16 a[44:45], v8 offset:16640
v_mul_f32 v66, s48, v66
v_mfma_f32_16x16x32_bf16 v[76:79], a[108:111], a[156:159], v[76:79]
ds_read_b64_tr_b16 a[46:47], v8 offset:24832
v_mul_f32 v67, s48, v67
v_mfma_f32_16x16x32_bf16 v[68:71], a[112:115], a[160:163], v[68:71]
ds_read_b64_tr_b16 a[48:49], v9 offset:16640
v_mul_f32 v72, s48, v72
v_mfma_f32_16x16x32_bf16 v[76:79], a[112:115], a[164:167], v[76:79]
ds_read_b64_tr_b16 a[50:51], v9 offset:24832
v_mul_f32 v73, s48, v73
v_mfma_f32_16x16x32_bf16 v[68:71], a[116:119], a[168:171], v[68:71]
ds_read_b64_tr_b16 a[52:53], v10 offset:16640
v_mul_f32 v74, s48, v74
v_mfma_f32_16x16x32_bf16 v[76:79], a[116:119], a[172:175], v[76:79]
ds_read_b64_tr_b16 a[54:55], v10 offset:24832
v_mul_f32 v75, s48, v75
v_mfma_f32_16x16x32_bf16 v[68:71], a[120:123], a[176:179], v[68:71]
ds_read_b64_tr_b16 a[56:57], v11 offset:16640
v_max3_f32 v47, v64, v65, v66
v_mfma_f32_16x16x32_bf16 v[76:79], a[120:123], a[180:183], v[76:79]
ds_read_b64_tr_b16 a[58:59], v11 offset:24832
v_max3_f32 v47, v47, v67, v72
v_mfma_f32_16x16x32_bf16 v[68:71], a[124:127], a[184:187], v[68:71]
ds_read_b64_tr_b16 a[60:61], v12 offset:16640
v_max3_f32 v47, v47, v73, v74
v_mfma_f32_16x16x32_bf16 v[76:79], a[124:127], a[188:191], v[76:79]
ds_read_b64_tr_b16 a[62:63], v12 offset:24832
s_waitcnt vmcnt(6) lgkmcnt(8)
s_barrier
v_mfma_f32_16x16x32_bf16 v[96:99], a[240:243], v[120:123], v[96:99]
ds_read_b128 a[64:67], v1 offset:16384
v_mfma_f32_16x16x32_bf16 v[100:103], a[240:243], v[124:127], v[100:103]
ds_read_b128 a[68:71], v2 offset:16384
buffer_load_dwordx4 v30, s[12:15], s43 offen offset:1024 nt lds
v_mfma_f32_16x16x32_bf16 v[132:135], a[0:3], v[124:127], v[132:135]
ds_read_b128 a[72:75], v3 offset:16384
v_mfma_f32_16x16x32_bf16 v[128:131], a[0:3], v[120:123], v[128:131]
ds_read_b128 a[76:79], v4 offset:16384
v_mul_f32 v68, s48, v68
v_mfma_f32_16x16x32_bf16 v[136:139], a[4:7], v[120:123], v[136:139]
ds_read_b128 a[80:83], v1 offset:16640
v_mul_f32 v69, s48, v69
v_mfma_f32_16x16x32_bf16 v[140:143], a[4:7], v[124:127], v[140:143]
ds_read_b128 a[84:87], v2 offset:16640
buffer_load_dwordx4 v31, s[12:15], s43 offen offset:2048 nt lds
v_mfma_f32_16x16x32_bf16 v[148:151], a[8:11], v[124:127], v[148:151]
ds_read_b128 a[88:91], v3 offset:16640
v_mul_f32 v70, s48, v70
v_mfma_f32_16x16x32_bf16 v[144:147], a[8:11], v[120:123], v[144:147]
ds_read_b128 a[92:95], v4 offset:16640
s_waitcnt lgkmcnt(8)
v_mfma_f32_16x16x32_bf16 v[152:155], a[12:15], v[120:123], v[152:155]
ds_read_b128 a[96:99], v1 offset:24576
v_mul_f32 v71, s48, v71
v_mfma_f32_16x16x32_bf16 v[156:159], a[12:15], v[124:127], v[156:159]
ds_read_b128 a[100:103], v2 offset:24576
buffer_load_dwordx4 v32, s[12:15], s43 offen offset:3072 nt lds
v_mfma_f32_16x16x32_bf16 v[164:167], a[16:19], v[124:127], v[164:167]
ds_read_b128 a[104:107], v3 offset:24576
s_add_u32 s43, s43, 16384
v_mfma_f32_16x16x32_bf16 v[160:163], a[16:19], v[120:123], v[160:163]
ds_read_b128 a[108:111], v4 offset:24576
s_and_b32 s43, s43, 0x3ffff
v_mfma_f32_16x16x32_bf16 v[168:171], a[20:23], v[120:123], v[168:171]
ds_read_b128 a[112:115], v1 offset:24832
s_add_u32 m0, s33, 131072
v_mfma_f32_16x16x32_bf16 v[172:175], a[20:23], v[124:127], v[172:175]
ds_read_b128 a[116:119], v2 offset:24832
v_mul_f32 v76, s48, v76
v_mfma_f32_16x16x32_bf16 v[180:183], a[24:27], v[124:127], v[180:183]
ds_read_b128 a[120:123], v3 offset:24832
v_mul_f32 v77, s48, v77
v_mfma_f32_16x16x32_bf16 v[176:179], a[24:27], v[120:123], v[176:179]
ds_read_b128 a[124:127], v4 offset:24832
v_mul_f32 v78, s48, v78
v_mfma_f32_16x16x32_bf16 v[184:187], a[28:31], v[120:123], v[184:187]
buffer_load_dwordx4 v41, s[20:23], s44 offen lds
v_mul_f32 v79, s48, v79
v_mfma_f32_16x16x32_bf16 v[188:191], a[28:31], v[124:127], v[188:191]
buffer_load_dwordx4 v42, s[20:23], s44 offen offset:1024 lds
v_max3_f32 v47, v47, v75, v68
v_mfma_f32_16x16x32_bf16 v[196:199], a[32:35], v[124:127], v[196:199]
v_max3_f32 v47, v47, v69, v70
v_max3_f32 v47, v47, v71, v76
v_mfma_f32_16x16x32_bf16 v[192:195], a[32:35], v[120:123], v[192:195]
v_max3_f32 v47, v47, v77, v78
v_max_f32 v47, v47, v79
v_mfma_f32_16x16x32_bf16 v[200:203], a[36:39], v[120:123], v[200:203]
v_cmp_lt_f32 vcc, 0x41000000, v47
s_cbranch_vccnz L_r1_14
L_b1_14:
v_mfma_f32_16x16x32_bf16 v[204:207], a[36:39], v[124:127], v[204:207]
buffer_load_dwordx4 v43, s[20:23], s44 offen offset:2048 lds
v_mfma_f32_16x16x32_bf16 v[212:215], a[40:43], v[124:127], v[212:215]
v_exp_f32 v64, v64
v_mfma_f32_16x16x32_bf16 v[208:211], a[40:43], v[120:123], v[208:211]
v_exp_f32 v65, v65
v_mfma_f32_16x16x32_bf16 v[216:219], a[44:47], v[120:123], v[216:219]
v_exp_f32 v66, v66
v_mfma_f32_16x16x32_bf16 v[220:223], a[44:47], v[124:127], v[220:223]
buffer_load_dwordx4 v44, s[20:23], s44 offen offset:3072 lds
s_add_u32 s44, s44, 114688
v_mfma_f32_16x16x32_bf16 v[228:231], a[48:51], v[124:127], v[228:231]
v_exp_f32 v67, v67
v_mfma_f32_16x16x32_bf16 v[224:227], a[48:51], v[120:123], v[224:227]
v_exp_f32 v68, v68
v_mfma_f32_16x16x32_bf16 v[232:235], a[52:55], v[120:123], v[232:235]
L_pad8:
s_cbranch_execz L_hr1
v_exp_f32 v69, v69
v_mfma_f32_16x16x32_bf16 v[236:239], a[52:55], v[124:127], v[236:239]
v_exp_f32 v70, v70
v_mfma_f32_16x16x32_bf16 v[244:247], a[56:59], v[124:127], v[244:247]
v_exp_f32 v71, v71
v_mfma_f32_16x16x32_bf16 v[240:243], a[56:59], v[120:123], v[240:243]
v_exp_f32 v72, v72
v_mfma_f32_16x16x32_bf16 v[248:251], a[60:63], v[120:123], v[248:251]
v_exp_f32 v73, v73
v_mfma_f32_16x16x32_bf16 v[252:255], a[60:63], v[124:127], v[252:255]
s_cmp_lg_u32 s51, 0
s_cbranch_scc1 L_r2_14
L_b2_14:
s_waitcnt vmcnt(8) lgkmcnt(0)
s_barrier
v_mfma_f32_16x16x32_bf16 v[80:83], a[64:67], a[128:131], v[48:51]
ds_read_b64_tr_b16 a[0:1], v5 offset:0
s_add_u32 m0, s33, 147456
v_mfma_f32_16x16x32_bf16 v[88:91], a[64:67], a[132:135], v[52:55]
ds_read_b64_tr_b16 a[2:3], v5 offset:8192
buffer_load_dwordx4 v41, s[20:23], s44 offen lds
v_mfma_f32_16x16x32_bf16 v[80:83], a[68:71], a[136:139], v[80:83]
ds_read_b64_tr_b16 a[4:5], v6 offset:0
v_exp_f32 v74, v74
v_mfma_f32_16x16x32_bf16 v[88:91], a[68:71], a[140:143], v[88:91]
ds_read_b64_tr_b16 a[6:7], v6 offset:8192
v_exp_f32 v75, v75
v_mfma_f32_16x16x32_bf16 v[80:83], a[72:75], a[144:147], v[80:83]
ds_read_b64_tr_b16 a[8:9], v7 offset:0
v_exp_f32 v76, v76
v_mfma_f32_16x16x32_bf16 v[88:91], a[72:75], a[148:151], v[88:91]
ds_read_b64_tr_b16 a[10:11], v7 offset:8192
v_exp_f32 v77, v77
v_mfma_f32_16x16x32_bf16 v[80:83], a[76:79], a[152:155], v[80:83]
ds_read_b64_tr_b16 a[12:13], v8 offset:0
v_exp_f32 v78, v78
v_mfma_f32_16x16x32_bf16 v[88:91], a[76:79], a[156:159], v[88:91]
ds_read_b64_tr_b16 a[14:15], v8 offset:8192
v_exp_f32 v79, v79
v_mfma_f32_16x16x32_bf16 v[80:83], a[80:83], a[160:163], v[80:83]
ds_read_b64_tr_b16 a[16:17], v9 offset:0
buffer_load_dwordx4 v42, s[20:23], s44 offen offset:1024 lds
v_mfma_f32_16x16x32_bf16 v[88:91], a[80:83], a[164:167], v[88:91]
ds_read_b64_tr_b16 a[18:19], v9 offset:8192
v_cvt_pk_bf16_f32 v112, v64, v65
v_mfma_f32_16x16x32_bf16 v[80:83], a[84:87], a[168:171], v[80:83]
ds_read_b64_tr_b16 a[20:21], v10 offset:0
v_cvt_pk_bf16_f32 v113, v66, v67
v_mfma_f32_16x16x32_bf16 v[88:91], a[84:87], a[172:175], v[88:91]
ds_read_b64_tr_b16 a[22:23], v10 offset:8192
v_cvt_pk_bf16_f32 v114, v68, v69
v_mfma_f32_16x16x32_bf16 v[80:83], a[88:91], a[176:179], v[80:83]
ds_read_b64_tr_b16 a[24:25], v11 offset:0
v_cvt_pk_bf16_f32 v115, v70, v71
v_mfma_f32_16x16x32_bf16 v[88:91], a[88:91], a[180:183], v[88:91]
ds_read_b64_tr_b16 a[26:27], v11 offset:8192
v_cvt_pk_bf16_f32 v116, v72, v73
v_mfma_f32_16x16x32_bf16 v[80:83], a[92:95], a[184:187], v[80:83]
ds_read_b64_tr_b16 a[28:29], v12 offset:0
v_cvt_pk_bf16_f32 v117, v74, v75
v_mfma_f32_16x16x32_bf16 v[88:91], a[92:95], a[188:191], v[88:91]
ds_read_b64_tr_b16 a[30:31], v12 offset:8192
buffer_load_dwordx4 v43, s[20:23], s44 offen offset:2048 lds
v_mfma_f32_16x16x32_bf16 v[84:87], a[96:99], a[128:131], v[48:51]
ds_read_b64_tr_b16 a[32:33], v5 offset:256
v_cvt_pk_bf16_f32 v118, v76, v77
v_mfma_f32_16x16x32_bf16 v[92:95], a[96:99], a[132:135], v[52:55]
ds_read_b64_tr_b16 a[34:35], v5 offset:8448
v_cvt_pk_bf16_f32 v119, v78, v79
v_mfma_f32_16x16x32_bf16 v[84:87], a[100:103], a[136:139], v[84:87]
ds_read_b64_tr_b16 a[36:37], v6 offset:256
v_mfma_f32_16x16x32_bf16 v[92:95], a[100:103], a[140:143], v[92:95]
ds_read_b64_tr_b16 a[38:39], v6 offset:8448
v_mul_f32 v80, s48, v80
v_mfma_f32_16x16x32_bf16 v[84:87], a[104:107], a[144:147], v[84:87]
ds_read_b64_tr_b16 a[40:41], v7 offset:256
v_mul_f32 v81, s48, v81
v_mfma_f32_16x16x32_bf16 v[92:95], a[104:107], a[148:151], v[92:95]
ds_read_b64_tr_b16 a[42:43], v7 offset:8448
v_mul_f32 v82, s48, v82
v_mfma_f32_16x16x32_bf16 v[84:87], a[108:111], a[152:155], v[84:87]
ds_read_b64_tr_b16 a[44:45], v8 offset:256
buffer_load_dwordx4 v44, s[20:23], s44 offen offset:3072 lds
v_mfma_f32_16x16x32_bf16 v[92:95], a[108:111], a[156:159], v[92:95]
ds_read_b64_tr_b16 a[46:47], v8 offset:8448
s_sub_u32 s44, s44, 114560
v_mfma_f32_16x16x32_bf16 v[84:87], a[112:115], a[160:163], v[84:87]
ds_read_b64_tr_b16 a[48:49], v9 offset:256
s_cmp_eq_u32 s44, 896
s_cselect_b32 s44, 0, s44
v_mfma_f32_16x16x32_bf16 v[92:95], a[112:115], a[164:167], v[92:95]
ds_read_b64_tr_b16 a[50:51], v9 offset:8448
v_mul_f32 v83, s48, v83
v_mfma_f32_16x16x32_bf16 v[84:87], a[116:119], a[168:171], v[84:87]
ds_read_b64_tr_b16 a[52:53], v10 offset:256
v_mul_f32 v88, s48, v88
v_mfma_f32_16x16x32_bf16 v[92:95], a[116:119], a[172:175], v[92:95]
ds_read_b64_tr_b16 a[54:55], v10 offset:8448
v_mul_f32 v89, s48, v89
v_mfma_f32_16x16x32_bf16 v[84:87], a[120:123], a[176:179], v[84:87]
ds_read_b64_tr_b16 a[56:57], v11 offset:256
v_mul_f32 v90, s48, v90
v_mfma_f32_16x16x32_bf16 v[92:95], a[120:123], a[180:183], v[92:95]
ds_read_b64_tr_b16 a[58:59], v11 offset:8448
v_mul_f32 v91, s48, v91
v_mfma_f32_16x16x32_bf16 v[84:87], a[124:127], a[184:187], v[84:87]
ds_read_b64_tr_b16 a[60:61], v12 offset:256
v_max3_f32 v47, v80, v81, v82
v_mfma_f32_16x16x32_bf16 v[92:95], a[124:127], a[188:191], v[92:95]
ds_read_b64_tr_b16 a[62:63], v12 offset:8448
s_waitcnt vmcnt(8) lgkmcnt(8)
s_barrier
v_mfma_f32_16x16x32_bf16 v[96:99], a[240:243], v[112:115], v[96:99]
ds_read_b64_tr_b16 a[64:65], v5 offset:32768
s_add_u32 m0, s33, 114688
v_max3_f32 v47, v47, v83, v88
v_mfma_f32_16x16x32_bf16 v[100:103], a[240:243], v[116:119], v[100:103]
ds_read_b64_tr_b16 a[66:67], v5 offset:40960
buffer_load_dwordx4 v41, s[20:23], s44 offen lds
v_mfma_f32_16x16x32_bf16 v[132:135], a[0:3], v[116:119], v[132:135]
ds_read_b64_tr_b16 a[68:69], v6 offset:32768
v_max3_f32 v47, v47, v89, v90
v_mfma_f32_16x16x32_bf16 v[128:131], a[0:3], v[112:115], v[128:131]
ds_read_b64_tr_b16 a[70:71], v6 offset:40960
v_mul_f32 v84, s48, v84
v_mul_f32 v85, s48, v85
v_mfma_f32_16x16x32_bf16 v[136:139], a[4:7], v[112:115], v[136:139]
ds_read_b64_tr_b16 a[72:73], v7 offset:32768
v_mul_f32 v86, s48, v86
v_mul_f32 v87, s48, v87
v_mfma_f32_16x16x32_bf16 v[140:143], a[4:7], v[116:119], v[140:143]
ds_read_b64_tr_b16 a[74:75], v7 offset:40960
v_mul_f32 v92, s48, v92
v_mul_f32 v93, s48, v93
v_mfma_f32_16x16x32_bf16 v[148:151], a[8:11], v[116:119], v[148:151]
ds_read_b64_tr_b16 a[76:77], v8 offset:32768
v_mul_f32 v94, s48, v94
v_mul_f32 v95, s48, v95
v_mfma_f32_16x16x32_bf16 v[144:147], a[8:11], v[112:115], v[144:147]
ds_read_b64_tr_b16 a[78:79], v8 offset:40960
s_waitcnt lgkmcnt(8)
v_max3_f32 v47, v47, v91, v84
v_mfma_f32_16x16x32_bf16 v[152:155], a[12:15], v[112:115], v[152:155]
ds_read_b64_tr_b16 a[80:81], v9 offset:32768
buffer_load_dwordx4 v42, s[20:23], s44 offen offset:1024 lds
v_mfma_f32_16x16x32_bf16 v[156:159], a[12:15], v[116:119], v[156:159]
ds_read_b64_tr_b16 a[82:83], v9 offset:40960
v_max3_f32 v47, v47, v85, v86
v_max3_f32 v47, v47, v87, v92
v_mfma_f32_16x16x32_bf16 v[164:167], a[16:19], v[116:119], v[164:167]
ds_read_b64_tr_b16 a[84:85], v10 offset:32768
v_max3_f32 v47, v47, v93, v94
v_max_f32 v47, v47, v95
v_mfma_f32_16x16x32_bf16 v[160:163], a[16:19], v[112:115], v[160:163]
ds_read_b64_tr_b16 a[86:87], v10 offset:40960
v_cmp_lt_f32 vcc, 0x41000000, v47
s_cbranch_vccnz L_r1_15
L_b1_15:
v_mfma_f32_16x16x32_bf16 v[168:171], a[20:23], v[112:115], v[168:171]
ds_read_b64_tr_b16 a[88:89], v11 offset:32768
v_exp_f32 v80, v80
v_mfma_f32_16x16x32_bf16 v[172:175], a[20:23], v[116:119], v[172:175]
ds_read_b64_tr_b16 a[90:91], v11 offset:40960
v_exp_f32 v81, v81
v_mfma_f32_16x16x32_bf16 v[180:183], a[24:27], v[116:119], v[180:183]
ds_read_b64_tr_b16 a[92:93], v12 offset:32768
v_exp_f32 v82, v82
v_mfma_f32_16x16x32_bf16 v[176:179], a[24:27], v[112:115], v[176:179]
ds_read_b64_tr_b16 a[94:95], v12 offset:40960
v_exp_f32 v83, v83
v_mfma_f32_16x16x32_bf16 v[184:187], a[28:31], v[112:115], v[184:187]
buffer_load_dwordx4 v43, s[20:23], s44 offen offset:2048 lds
v_exp_f32 v84, v84
v_mfma_f32_16x16x32_bf16 v[188:191], a[28:31], v[116:119], v[188:191]
ds_read_b64_tr_b16 a[96:97], v5 offset:33024
v_exp_f32 v85, v85
v_mfma_f32_16x16x32_bf16 v[196:199], a[32:35], v[116:119], v[196:199]
ds_read_b64_tr_b16 a[98:99], v5 offset:41216
v_exp_f32 v86, v86
v_mfma_f32_16x16x32_bf16 v[192:195], a[32:35], v[112:115], v[192:195]
ds_read_b64_tr_b16 a[100:101], v6 offset:33024
v_exp_f32 v87, v87
v_mfma_f32_16x16x32_bf16 v[200:203], a[36:39], v[112:115], v[200:203]
ds_read_b64_tr_b16 a[102:103], v6 offset:41216
v_exp_f32 v88, v88
v_mfma_f32_16x16x32_bf16 v[204:207], a[36:39], v[116:119], v[204:207]
ds_read_b64_tr_b16 a[104:105], v7 offset:33024
v_exp_f32 v89, v89
v_mfma_f32_16x16x32_bf16 v[212:215], a[40:43], v[116:119], v[212:215]
ds_read_b64_tr_b16 a[106:107], v7 offset:41216
buffer_load_dwordx4 v44, s[20:23], s44 offen offset:3072 lds
v_mfma_f32_16x16x32_bf16 v[208:211], a[40:43], v[112:115], v[208:211]
ds_read_b64_tr_b16 a[108:109], v8 offset:33024
s_add_u32 s44, s44, 114688
v_exp_f32 v90, v90
v_mfma_f32_16x16x32_bf16 v[216:219], a[44:47], v[112:115], v[216:219]
ds_read_b64_tr_b16 a[110:111], v8 offset:41216
v_exp_f32 v91, v91
v_mfma_f32_16x16x32_bf16 v[220:223], a[44:47], v[116:119], v[220:223]
ds_read_b64_tr_b16 a[112:113], v9 offset:33024
v_exp_f32 v92, v92
v_mfma_f32_16x16x32_bf16 v[228:231], a[48:51], v[116:119], v[228:231]
ds_read_b64_tr_b16 a[114:115], v9 offset:41216
v_exp_f32 v93, v93
v_mfma_f32_16x16x32_bf16 v[224:227], a[48:51], v[112:115], v[224:227]
ds_read_b64_tr_b16 a[116:117], v10 offset:33024
v_exp_f32 v94, v94
v_mfma_f32_16x16x32_bf16 v[232:235], a[52:55], v[112:115], v[232:235]
ds_read_b64_tr_b16 a[118:119], v10 offset:41216
v_exp_f32 v95, v95
v_mfma_f32_16x16x32_bf16 v[236:239], a[52:55], v[116:119], v[236:239]
ds_read_b64_tr_b16 a[120:121], v11 offset:33024
v_cvt_pk_bf16_f32 v120, v80, v81
v_cvt_pk_bf16_f32 v121, v82, v83
v_mfma_f32_16x16x32_bf16 v[244:247], a[56:59], v[116:119], v[244:247]
ds_read_b64_tr_b16 a[122:123], v11 offset:41216
v_cvt_pk_bf16_f32 v122, v84, v85
v_cvt_pk_bf16_f32 v123, v86, v87
v_mfma_f32_16x16x32_bf16 v[240:243], a[56:59], v[112:115], v[240:243]
ds_read_b64_tr_b16 a[124:125], v12 offset:33024
v_cvt_pk_bf16_f32 v124, v88, v89
v_cvt_pk_bf16_f32 v125, v90, v91
v_mfma_f32_16x16x32_bf16 v[248:251], a[60:63], v[112:115], v[248:251]
ds_read_b64_tr_b16 a[126:127], v12 offset:41216
v_cvt_pk_bf16_f32 v126, v92, v93
v_cvt_pk_bf16_f32 v127, v94, v95
v_mfma_f32_16x16x32_bf16 v[252:255], a[60:63], v[116:119], v[252:255]
s_and_b32 s39, s33, 0x2000
v_add_u32 v59, s39, v13
v_xor_b32 v13, 96, v16
v_xor_b32 v14, 64, v16
v_xor_b32 v15, 32, v16
v_and_b32 v60, 7, v62
v_mul_u32_u24 v56, 1792, v60
v_min_u32 v60, 1, v60
v_lshlrev_b32 v60, 2, v60
v_bfe_u32 v57, v62, 3, 1
v_lshl_add_u32 v56, v57, 3, v56
v_bfe_u32 v57, v62, 4, 1
v_lshl_add_u32 v56, v57, 5, v56
s_cmp_lg_u32 s51, 0
s_cbranch_scc1 L_r2_15
L_b2_15:
s_waitcnt vmcnt(8) lgkmcnt(8)
s_barrier
v_mfma_f32_16x16x32_bf16 v[96:99], a[240:243], v[120:123], v[96:99]
ds_read_b64_tr_b16 a[0:1], v21 offset:0
s_add_u32 m0, s33, 49152
v_mfma_f32_16x16x32_bf16 v[100:103], a[240:243], v[124:127], v[100:103]
ds_read_b64_tr_b16 a[2:3], v21 offset:2048
buffer_load_dwordx4 v41, s[20:23], s44 offen lds
v_mfma_f32_16x16x32_bf16 v[132:135], a[64:67], v[124:127], v[132:135]
ds_read_b64_tr_b16 a[4:5], v22 offset:0
v_mfma_f32_16x16x32_bf16 v[128:131], a[64:67], v[120:123], v[128:131]
ds_read_b64_tr_b16 a[6:7], v22 offset:2048
v_mfma_f32_16x16x32_bf16 v[136:139], a[68:71], v[120:123], v[136:139]
ds_read_b64_tr_b16 a[8:9], v23 offset:0
buffer_load_dwordx4 v42, s[20:23], s44 offen offset:1024 lds
v_mfma_f32_16x16x32_bf16 v[140:143], a[68:71], v[124:127], v[140:143]
ds_read_b64_tr_b16 a[10:11], v23 offset:2048
v_rcp_f32 v37, v96
v_rcp_f32 v38, v100
v_mfma_f32_16x16x32_bf16 v[148:151], a[72:75], v[124:127], v[148:151]
ds_read_b64_tr_b16 a[12:13], v24 offset:0
v_mfma_f32_16x16x32_bf16 v[144:147], a[72:75], v[120:123], v[144:147]
ds_read_b64_tr_b16 a[14:15], v24 offset:2048
s_waitcnt lgkmcnt(8)
v_mfma_f32_16x16x32_bf16 v[152:155], a[76:79], v[120:123], v[152:155]
ds_read_b64_tr_b16 a[16:17], v21 offset:4096
buffer_load_dwordx4 v43, s[20:23], s44 offen offset:2048 lds
v_mfma_f32_16x16x32_bf16 v[156:159], a[76:79], v[124:127], v[156:159]
ds_read_b64_tr_b16 a[18:19], v21 offset:6144
v_mul_f32 v128, v128, v37
v_mul_f32 v129, v129, v37
v_mul_f32 v130, v130, v37
v_mfma_f32_16x16x32_bf16 v[164:167], a[80:83], v[124:127], v[164:167]
ds_read_b64_tr_b16 a[20:21], v22 offset:4096
v_mul_f32 v131, v131, v37
v_cvt_pk_bf16_f32 v64, v128, v129
v_cvt_pk_bf16_f32 v65, v130, v131
v_mfma_f32_16x16x32_bf16 v[160:163], a[80:83], v[120:123], v[160:163]
ds_read_b64_tr_b16 a[22:23], v22 offset:6144
buffer_load_dwordx4 v44, s[20:23], s44 offen offset:3072 lds
v_mul_f32 v136, v136, v37
v_mfma_f32_16x16x32_bf16 v[168:171], a[84:87], v[120:123], v[168:171]
ds_read_b64_tr_b16 a[24:25], v23 offset:4096
s_sub_u32 s44, s44, 114560
v_mul_f32 v137, v137, v37
v_mul_f32 v138, v138, v37
v_mfma_f32_16x16x32_bf16 v[172:175], a[84:87], v[124:127], v[172:175]
ds_read_b64_tr_b16 a[26:27], v23 offset:6144
v_mul_f32 v139, v139, v37
v_cvt_pk_bf16_f32 v66, v136, v137
v_cvt_pk_bf16_f32 v67, v138, v139
v_mfma_f32_16x16x32_bf16 v[180:183], a[88:91], v[124:127], v[180:183]
ds_read_b64_tr_b16 a[28:29], v24 offset:4096
s_cmp_eq_u32 s44, 896
s_cselect_b32 s44, 0, s44
v_mul_f32 v132, v132, v38
v_mfma_f32_16x16x32_bf16 v[176:179], a[88:91], v[120:123], v[176:179]
ds_read_b64_tr_b16 a[30:31], v24 offset:6144
s_add_u32 m0, s33, 32768
v_mul_f32 v133, v133, v38
v_mul_f32 v134, v134, v38
v_mfma_f32_16x16x32_bf16 v[184:187], a[92:95], v[120:123], v[184:187]
buffer_load_dwordx4 v41, s[20:23], s44 offen lds
v_mul_f32 v135, v135, v38
v_cvt_pk_bf16_f32 v68, v132, v133
v_cvt_pk_bf16_f32 v69, v134, v135
v_mfma_f32_16x16x32_bf16 v[188:191], a[92:95], v[124:127], v[188:191]
ds_read_b64_tr_b16 a[32:33], v21 offset:8192
v_mul_f32 v140, v140, v38
v_mul_f32 v141, v141, v38
v_mul_f32 v142, v142, v38
v_mfma_f32_16x16x32_bf16 v[196:199], a[96:99], v[124:127], v[196:199]
ds_read_b64_tr_b16 a[34:35], v21 offset:10240
buffer_load_dwordx4 v42, s[20:23], s44 offen offset:1024 lds
v_mul_f32 v143, v143, v38
v_mfma_f32_16x16x32_bf16 v[192:195], a[96:99], v[120:123], v[192:195]
ds_read_b64_tr_b16 a[36:37], v22 offset:8192
v_cvt_pk_bf16_f32 v70, v140, v141
v_cvt_pk_bf16_f32 v71, v142, v143
v_mul_f32 v144, v144, v37
v_mfma_f32_16x16x32_bf16 v[200:203], a[100:103], v[120:123], v[200:203]
ds_read_b64_tr_b16 a[38:39], v22 offset:10240
v_mul_f32 v145, v145, v37
v_mul_f32 v146, v146, v37
v_mul_f32 v147, v147, v37
v_mfma_f32_16x16x32_bf16 v[204:207], a[100:103], v[124:127], v[204:207]
ds_read_b64_tr_b16 a[40:41], v23 offset:8192
v_cvt_pk_bf16_f32 v72, v144, v145
v_cvt_pk_bf16_f32 v73, v146, v147
v_mul_f32 v152, v152, v37
v_mfma_f32_16x16x32_bf16 v[212:215], a[104:107], v[124:127], v[212:215]
ds_read_b64_tr_b16 a[42:43], v23 offset:10240
buffer_load_dwordx4 v43, s[20:23], s44 offen offset:2048 lds
v_mul_f32 v153, v153, v37
v_mfma_f32_16x16x32_bf16 v[208:211], a[104:107], v[120:123], v[208:211]
ds_read_b64_tr_b16 a[44:45], v24 offset:8192
v_mul_f32 v154, v154, v37
v_mul_f32 v155, v155, v37
v_cvt_pk_bf16_f32 v74, v152, v153
v_mfma_f32_16x16x32_bf16 v[216:219], a[108:111], v[120:123], v[216:219]
ds_read_b64_tr_b16 a[46:47], v24 offset:10240
v_cvt_pk_bf16_f32 v75, v154, v155
v_mul_f32 v148, v148, v38
v_mul_f32 v149, v149, v38
v_mfma_f32_16x16x32_bf16 v[220:223], a[108:111], v[124:127], v[220:223]
ds_read_b64_tr_b16 a[48:49], v21 offset:12288
buffer_load_dwordx4 v44, s[20:23], s44 offen offset:3072 lds
v_mul_f32 v150, v150, v38
v_mfma_f32_16x16x32_bf16 v[228:231], a[112:115], v[124:127], v[228:231]
ds_read_b64_tr_b16 a[50:51], v21 offset:14336
s_add_u32 s44, s44, 114688
v_mul_f32 v151, v151, v38
v_cvt_pk_bf16_f32 v76, v148, v149
v_mfma_f32_16x16x32_bf16 v[224:227], a[112:115], v[120:123], v[224:227]
ds_read_b64_tr_b16 a[52:53], v22 offset:12288
v_cvt_pk_bf16_f32 v77, v150, v151
v_mul_f32 v156, v156, v38
v_mul_f32 v157, v157, v38
v_mfma_f32_16x16x32_bf16 v[232:235], a[116:119], v[120:123], v[232:235]
ds_read_b64_tr_b16 a[54:55], v22 offset:14336
v_mul_f32 v158, v158, v38
v_mul_f32 v159, v159, v38
v_cvt_pk_bf16_f32 v78, v156, v157
v_mfma_f32_16x16x32_bf16 v[236:239], a[116:119], v[124:127], v[236:239]
ds_read_b64_tr_b16 a[56:57], v23 offset:12288
v_cvt_pk_bf16_f32 v79, v158, v159
v_mul_f32 v160, v160, v37
v_mul_f32 v161, v161, v37
v_mfma_f32_16x16x32_bf16 v[244:247], a[120:123], v[124:127], v[244:247]
ds_read_b64_tr_b16 a[58:59], v23 offset:14336
v_mul_f32 v162, v162, v37
v_mul_f32 v163, v163, v37
v_cvt_pk_bf16_f32 v80, v160, v161
v_mfma_f32_16x16x32_bf16 v[240:243], a[120:123], v[120:123], v[240:243]
ds_read_b64_tr_b16 a[60:61], v24 offset:12288
v_cvt_pk_bf16_f32 v81, v162, v163
v_mul_f32 v168, v168, v37
v_mul_f32 v169, v169, v37
v_mfma_f32_16x16x32_bf16 v[248:251], a[124:127], v[120:123], v[248:251]
ds_read_b64_tr_b16 a[62:63], v24 offset:14336
v_mul_f32 v170, v170, v37
v_mul_f32 v171, v171, v37
v_cvt_pk_bf16_f32 v82, v168, v169
v_mfma_f32_16x16x32_bf16 v[252:255], a[124:127], v[124:127], v[252:255]
v_cvt_pk_bf16_f32 v83, v170, v171
v_mul_f32 v164, v164, v38
v_mul_f32 v165, v165, v38
s_waitcnt vmcnt(12) lgkmcnt(8)
s_barrier
v_readfirstlane_b32 s3, v0
s_cmp_lt_u32 s3, 0x100000
s_cbranch_scc1 L_chk
L_chkb:
s_mov_b32 s100, s3
v_mfma_f32_16x16x32_bf16 v[128:131], a[0:3], v[64:67], 0
ds_read_b64_tr_b16 a[64:65], v21 offset:16384
s_add_u32 m0, s33, 98304
v_mul_f32 v166, v166, v38
v_mul_f32 v167, v167, v38
v_mfma_f32_16x16x32_bf16 v[132:135], a[0:3], v[68:71], 0
ds_read_b64_tr_b16 a[66:67], v21 offset:18432
buffer_load_dwordx4 v41, s[20:23], s44 offen lds
v_cvt_pk_bf16_f32 v84, v164, v165
v_mfma_f32_16x16x32_bf16 v[140:143], a[4:7], v[68:71], 0
ds_read_b64_tr_b16 a[68:69], v22 offset:16384
v_cvt_pk_bf16_f32 v85, v166, v167
v_mul_f32 v172, v172, v38
v_mul_f32 v173, v173, v38
v_mfma_f32_16x16x32_bf16 v[136:139], a[4:7], v[64:67], 0
ds_read_b64_tr_b16 a[70:71], v22 offset:18432
v_mul_f32 v174, v174, v38
v_mul_f32 v175, v175, v38
v_cvt_pk_bf16_f32 v86, v172, v173
v_mfma_f32_16x16x32_bf16 v[144:147], a[8:11], v[64:67], 0
ds_read_b64_tr_b16 a[72:73], v23 offset:16384
buffer_load_dwordx4 v42, s[20:23], s44 offen offset:1024 lds
v_cvt_pk_bf16_f32 v87, v174, v175
v_mfma_f32_16x16x32_bf16 v[148:151], a[8:11], v[68:71], 0
ds_read_b64_tr_b16 a[74:75], v23 offset:18432
v_mul_f32 v176, v176, v37
v_mul_f32 v177, v177, v37
v_mul_f32 v178, v178, v37
v_mfma_f32_16x16x32_bf16 v[156:159], a[12:15], v[68:71], 0
ds_read_b64_tr_b16 a[76:77], v24 offset:16384
v_mul_f32 v179, v179, v37
v_cvt_pk_bf16_f32 v88, v176, v177
v_cvt_pk_bf16_f32 v89, v178, v179
v_mfma_f32_16x16x32_bf16 v[152:155], a[12:15], v[64:67], 0
ds_read_b64_tr_b16 a[78:79], v24 offset:18432
s_waitcnt lgkmcnt(8)
v_mul_f32 v184, v184, v37
v_mul_f32 v185, v185, v37
v_mfma_f32_16x16x32_bf16 v[128:131], a[16:19], v[72:75], v[128:131]
ds_read_b64_tr_b16 a[80:81], v21 offset:20480
buffer_load_dwordx4 v43, s[20:23], s44 offen offset:2048 lds
v_mul_f32 v186, v186, v37
v_mfma_f32_16x16x32_bf16 v[132:135], a[16:19], v[76:79], v[132:135]
ds_read_b64_tr_b16 a[82:83], v21 offset:22528
v_mul_f32 v187, v187, v37
v_cvt_pk_bf16_f32 v90, v184, v185
v_cvt_pk_bf16_f32 v91, v186, v187
v_mfma_f32_16x16x32_bf16 v[140:143], a[20:23], v[76:79], v[140:143]
ds_read_b64_tr_b16 a[84:85], v22 offset:20480
v_mul_f32 v180, v180, v38
v_mul_f32 v181, v181, v38
v_mul_f32 v182, v182, v38
v_mfma_f32_16x16x32_bf16 v[136:139], a[20:23], v[72:75], v[136:139]
ds_read_b64_tr_b16 a[86:87], v22 offset:22528
buffer_load_dwordx4 v44, s[20:23], s44 offen offset:3072 lds
v_mul_f32 v183, v183, v38
v_mfma_f32_16x16x32_bf16 v[144:147], a[24:27], v[72:75], v[144:147]
ds_read_b64_tr_b16 a[88:89], v23 offset:20480
s_sub_u32 s44, s44, 114560
v_cvt_pk_bf16_f32 v92, v180, v181
v_cvt_pk_bf16_f32 v93, v182, v183
v_mfma_f32_16x16x32_bf16 v[148:151], a[24:27], v[76:79], v[148:151]
ds_read_b64_tr_b16 a[90:91], v23 offset:22528
s_cmp_eq_u32 s44, 896
s_cselect_b32 s44, 0, s44
v_mul_f32 v188, v188, v38
v_mfma_f32_16x16x32_bf16 v[156:159], a[28:31], v[76:79], v[156:159]
ds_read_b64_tr_b16 a[92:93], v24 offset:20480
s_add_u32 m0, s33, 81920
v_mul_f32 v189, v189, v38
v_mul_f32 v190, v190, v38
v_mfma_f32_16x16x32_bf16 v[152:155], a[28:31], v[72:75], v[152:155]
ds_read_b64_tr_b16 a[94:95], v24 offset:22528
buffer_load_dwordx4 v41, s[20:23], s44 offen lds
v_mul_f32 v191, v191, v38
v_mfma_f32_16x16x32_bf16 v[128:131], a[32:35], v[80:83], v[128:131]
ds_read_b64_tr_b16 a[96:97], v21 offset:24576
v_cvt_pk_bf16_f32 v94, v188, v189
v_cvt_pk_bf16_f32 v95, v190, v191
v_mul_f32 v192, v192, v37
v_mfma_f32_16x16x32_bf16 v[132:135], a[32:35], v[84:87], v[132:135]
ds_read_b64_tr_b16 a[98:99], v21 offset:26624
v_mul_f32 v193, v193, v37
v_mul_f32 v194, v194, v37
v_mul_f32 v195, v195, v37
v_mfma_f32_16x16x32_bf16 v[140:143], a[36:39], v[84:87], v[140:143]
ds_read_b64_tr_b16 a[100:101], v22 offset:24576
buffer_load_dwordx4 v42, s[20:23], s44 offen offset:1024 lds
v_cvt_pk_bf16_f32 v96, v192, v193
v_mfma_f32_16x16x32_bf16 v[136:139], a[36:39], v[80:83], v[136:139]
ds_read_b64_tr_b16 a[102:103], v22 offset:26624
v_cvt_pk_bf16_f32 v97, v194, v195
v_mul_f32 v200, v200, v37
v_mul_f32 v201, v201, v37
v_mfma_f32_16x16x32_bf16 v[144:147], a[40:43], v[80:83], v[144:147]
ds_read_b64_tr_b16 a[104:105], v23 offset:24576
v_mul_f32 v202, v202, v37
v_mul_f32 v203, v203, v37
v_cvt_pk_bf16_f32 v98, v200, v201
v_mfma_f32_16x16x32_bf16 v[148:151], a[40:43], v[84:87], v[148:151]
ds_read_b64_tr_b16 a[106:107], v23 offset:26624
v_cvt_pk_bf16_f32 v99, v202, v203
v_mul_f32 v196, v196, v38
v_mul_f32 v197, v197, v38
v_mfma_f32_16x16x32_bf16 v[156:159], a[44:47], v[84:87], v[156:159]
ds_read_b64_tr_b16 a[108:109], v24 offset:24576
buffer_load_dwordx4 v43, s[20:23], s44 offen offset:2048 lds
v_mul_f32 v198, v198, v38
v_mfma_f32_16x16x32_bf16 v[152:155], a[44:47], v[80:83], v[152:155]
ds_read_b64_tr_b16 a[110:111], v24 offset:26624
v_mul_f32 v199, v199, v38
v_cvt_pk_bf16_f32 v100, v196, v197
v_cvt_pk_bf16_f32 v101, v198, v199
v_mfma_f32_16x16x32_bf16 v[128:131], a[48:51], v[88:91], v[128:131]
ds_read_b64_tr_b16 a[112:113], v21 offset:28672
v_mul_f32 v204, v204, v38
v_mul_f32 v205, v205, v38
v_mul_f32 v206, v206, v38
v_mfma_f32_16x16x32_bf16 v[132:135], a[48:51], v[92:95], v[132:135]
ds_read_b64_tr_b16 a[114:115], v21 offset:30720
buffer_load_dwordx4 v44, s[20:23], s44 offen offset:3072 lds
v_mul_f32 v207, v207, v38
v_mfma_f32_16x16x32_bf16 v[140:143], a[52:55], v[92:95], v[140:143]
ds_read_b64_tr_b16 a[116:117], v22 offset:28672
s_add_u32 s44, s44, 114688
v_cvt_pk_bf16_f32 v102, v204, v205
v_cvt_pk_bf16_f32 v103, v206, v207
v_mfma_f32_16x16x32_bf16 v[136:139], a[52:55], v[88:91], v[136:139]
ds_read_b64_tr_b16 a[118:119], v22 offset:30720
v_mul_f32 v208, v208, v37
v_mul_f32 v209, v209, v37
v_mul_f32 v210, v210, v37
v_mfma_f32_16x16x32_bf16 v[144:147], a[56:59], v[88:91], v[144:147]
ds_read_b64_tr_b16 a[120:121], v23 offset:28672
v_mul_f32 v211, v211, v37
v_cvt_pk_bf16_f32 v104, v208, v209
v_cvt_pk_bf16_f32 v105, v210, v211
v_mfma_f32_16x16x32_bf16 v[148:151], a[56:59], v[92:95], v[148:151]
ds_read_b64_tr_b16 a[122:123], v23 offset:30720
v_mul_f32 v216, v216, v37
v_mul_f32 v217, v217, v37
v_mul_f32 v218, v218, v37
v_mfma_f32_16x16x32_bf16 v[156:159], a[60:63], v[92:95], v[156:159]
ds_read_b64_tr_b16 a[124:125], v24 offset:28672
v_mul_f32 v219, v219, v37
v_cvt_pk_bf16_f32 v106, v216, v217
v_cvt_pk_bf16_f32 v107, v218, v219
v_mfma_f32_16x16x32_bf16 v[152:155], a[60:63], v[88:91], v[152:155]
ds_read_b64_tr_b16 a[126:127], v24 offset:30720
v_mul_f32 v212, v212, v38
s_lshl_b32 s101, s32, 2
s_lshr_b32 s101, s100, s101
s_and_b32 s55, s101, 5
s_bcnt1_i32_b32 s55, s55
s_and_b32 s101, s101, 10
s_bcnt1_i32_b32 s101, s101
s_cmp_gt_u32 s101, s55
s_cselect_b32 s45, 8192, 0
s_cmp_eq_u32 s101, s55
s_cselect_b32 s54, 8192, 0
s_sub_u32 s50, 16384, s54
s_add_u32 s54, s54, 16384
s_waitcnt vmcnt(16) lgkmcnt(8)
s_barrier
v_mfma_f32_16x16x32_bf16 v[128:131], a[64:67], v[96:99], v[128:131]
ds_read_b64_tr_b16 a[0:1], v17 offset:49152
s_add_u32 m0, s33, 131072
v_mul_f32 v213, v213, v38
v_mfma_f32_16x16x32_bf16 v[132:135], a[64:67], v[100:103], v[132:135]
ds_read_b64_tr_b16 a[2:3], v17 offset:51200
buffer_load_dwordx4 v41, s[20:23], s44 offen lds
v_mfma_f32_16x16x32_bf16 v[140:143], a[68:71], v[100:103], v[140:143]
ds_read_b64_tr_b16 a[4:5], v18 offset:49152
v_mul_f32 v214, v214, v38
v_mul_f32 v215, v215, v38
v_mfma_f32_16x16x32_bf16 v[136:139], a[68:71], v[96:99], v[136:139]
ds_read_b64_tr_b16 a[6:7], v18 offset:51200
v_cvt_pk_bf16_f32 v108, v212, v213
v_cvt_pk_bf16_f32 v109, v214, v215
v_mfma_f32_16x16x32_bf16 v[144:147], a[72:75], v[96:99], v[144:147]
ds_read_b64_tr_b16 a[8:9], v19 offset:49152
buffer_load_dwordx4 v42, s[20:23], s44 offen offset:1024 lds
v_mfma_f32_16x16x32_bf16 v[148:151], a[72:75], v[100:103], v[148:151]
ds_read_b64_tr_b16 a[10:11], v19 offset:51200
v_mul_f32 v220, v220, v38
v_mul_f32 v221, v221, v38
v_mfma_f32_16x16x32_bf16 v[156:159], a[76:79], v[100:103], v[156:159]
ds_read_b64_tr_b16 a[12:13], v20 offset:49152
v_mul_f32 v222, v222, v38
v_mul_f32 v223, v223, v38
v_mfma_f32_16x16x32_bf16 v[152:155], a[76:79], v[96:99], v[152:155]
ds_read_b64_tr_b16 a[14:15], v20 offset:51200
s_waitcnt lgkmcnt(8)
v_cvt_pk_bf16_f32 v110, v220, v221
v_cvt_pk_bf16_f32 v111, v222, v223
v_mfma_f32_16x16x32_bf16 v[128:131], a[80:83], v[104:107], v[128:131]
ds_read_b64_tr_b16 a[16:17], v17 offset:53248
buffer_load_dwordx4 v43, s[20:23], s44 offen offset:2048 lds
v_mfma_f32_16x16x32_bf16 v[132:135], a[80:83], v[108:111], v[132:135]
ds_read_b64_tr_b16 a[18:19], v17 offset:55296
v_mul_f32 v224, v224, v37
v_mul_f32 v225, v225, v37
v_mfma_f32_16x16x32_bf16 v[140:143], a[84:87], v[108:111], v[140:143]
ds_read_b64_tr_b16 a[20:21], v18 offset:53248
v_mul_f32 v226, v226, v37
v_mul_f32 v227, v227, v37
v_mfma_f32_16x16x32_bf16 v[136:139], a[84:87], v[104:107], v[136:139]
ds_read_b64_tr_b16 a[22:23], v18 offset:55296
buffer_load_dwordx4 v44, s[20:23], s44 offen offset:3072 lds
v_mfma_f32_16x16x32_bf16 v[144:147], a[88:91], v[104:107], v[144:147]
ds_read_b64_tr_b16 a[24:25], v19 offset:53248
L_pad9:
s_cbranch_execz L_hr2
s_sub_u32 s44, s44, 114560
v_cvt_pk_bf16_f32 v112, v224, v225
v_mfma_f32_16x16x32_bf16 v[148:151], a[88:91], v[108:111], v[148:151]
ds_read_b64_tr_b16 a[26:27], v19 offset:55296
s_cmp_eq_u32 s44, 896
s_cselect_b32 s44, 0, s44
v_mfma_f32_16x16x32_bf16 v[156:159], a[92:95], v[108:111], v[156:159]
ds_read_b64_tr_b16 a[28:29], v20 offset:53248
s_add_u32 m0, s33, 16384
v_cvt_pk_bf16_f32 v113, v226, v227
v_mfma_f32_16x16x32_bf16 v[152:155], a[92:95], v[104:107], v[152:155]
ds_read_b64_tr_b16 a[30:31], v20 offset:55296
buffer_load_dwordx4 v41, s[20:23], s44 offen lds
v_mul_f32 v232, v232, v37
v_mul_f32 v233, v233, v37
v_mul_f32 v234, v234, v37
v_mul_f32 v235, v235, v37
v_cvt_pk_bf16_f32 v114, v232, v233
v_cvt_pk_bf16_f32 v115, v234, v235
v_mul_f32 v228, v228, v38
v_mul_f32 v229, v229, v38
v_mul_f32 v230, v230, v38
v_mul_f32 v231, v231, v38
v_cvt_pk_bf16_f32 v116, v228, v229
v_cvt_pk_bf16_f32 v117, v230, v231
v_mul_f32 v236, v236, v38
v_mul_f32 v237, v237, v38
v_mul_f32 v238, v238, v38
v_mul_f32 v239, v239, v38
v_cvt_pk_bf16_f32 v118, v236, v237
v_cvt_pk_bf16_f32 v119, v238, v239
v_mfma_f32_16x16x32_bf16 v[128:131], a[96:99], v[112:115], v[128:131]
ds_read_b64_tr_b16 a[32:33], v17 offset:57344
v_mul_f32 v240, v240, v37
v_mul_f32 v241, v241, v37
v_mfma_f32_16x16x32_bf16 v[132:135], a[96:99], v[116:119], v[132:135]
ds_read_b64_tr_b16 a[34:35], v17 offset:59392
v_mul_f32 v242, v242, v37
v_mul_f32 v243, v243, v37
v_mfma_f32_16x16x32_bf16 v[140:143], a[100:103], v[116:119], v[140:143]
ds_read_b64_tr_b16 a[36:37], v18 offset:57344
buffer_load_dwordx4 v42, s[20:23], s44 offen offset:1024 lds
v_mfma_f32_16x16x32_bf16 v[136:139], a[100:103], v[112:115], v[136:139]
ds_read_b64_tr_b16 a[38:39], v18 offset:59392
v_cvt_pk_bf16_f32 v120, v240, v241
v_cvt_pk_bf16_f32 v121, v242, v243
v_mfma_f32_16x16x32_bf16 v[144:147], a[104:107], v[112:115], v[144:147]
ds_read_b64_tr_b16 a[40:41], v19 offset:57344
v_mul_f32 v248, v248, v37
v_mul_f32 v249, v249, v37
v_mfma_f32_16x16x32_bf16 v[148:151], a[104:107], v[116:119], v[148:151]
ds_read_b64_tr_b16 a[42:43], v19 offset:59392
v_mul_f32 v250, v250, v37
v_mul_f32 v251, v251, v37
v_mfma_f32_16x16x32_bf16 v[156:159], a[108:111], v[116:119], v[156:159]
ds_read_b64_tr_b16 a[44:45], v20 offset:57344
buffer_load_dwordx4 v43, s[20:23], s44 offen offset:2048 lds
v_mfma_f32_16x16x32_bf16 v[152:155], a[108:111], v[112:115], v[152:155]
ds_read_b64_tr_b16 a[46:47], v20 offset:59392
v_cvt_pk_bf16_f32 v122, v248, v249
v_cvt_pk_bf16_f32 v123, v250, v251
v_mul_f32 v244, v244, v38
v_mul_f32 v245, v245, v38
v_mul_f32 v246, v246, v38
v_mul_f32 v247, v247, v38
v_cvt_pk_bf16_f32 v124, v244, v245
v_cvt_pk_bf16_f32 v125, v246, v247
v_mul_f32 v252, v252, v38
v_mul_f32 v253, v253, v38
v_mul_f32 v254, v254, v38
v_mul_f32 v255, v255, v38
v_cvt_pk_bf16_f32 v126, v252, v253
v_cvt_pk_bf16_f32 v127, v254, v255
v_mfma_f32_16x16x32_bf16 v[128:131], a[112:115], v[120:123], v[128:131]
ds_read_b64_tr_b16 a[48:49], v17 offset:61440
s_and_b32 s101, s35, 12
s_lshr_b32 s101, s100, s101
v_mfma_f32_16x16x32_bf16 v[132:135], a[112:115], v[124:127], v[132:135]
ds_read_b64_tr_b16 a[50:51], v17 offset:63488
buffer_load_dwordx4 v44, s[20:23], s44 offen offset:3072 lds
v_mfma_f32_16x16x32_bf16 v[140:143], a[116:119], v[124:127], v[140:143]
ds_read_b64_tr_b16 a[52:53], v18 offset:61440
s_add_u32 s44, s44, 114688
s_and_b32 s55, s101, 5
v_mfma_f32_16x16x32_bf16 v[136:139], a[116:119], v[120:123], v[136:139]
ds_read_b64_tr_b16 a[54:55], v18 offset:63488
s_bcnt1_i32_b32 s55, s55
s_and_b32 s101, s101, 10
v_mfma_f32_16x16x32_bf16 v[144:147], a[120:123], v[120:123], v[144:147]
ds_read_b64_tr_b16 a[56:57], v19 offset:61440
s_bcnt1_i32_b32 s101, s101
v_mfma_f32_16x16x32_bf16 v[148:151], a[120:123], v[124:127], v[148:151]
ds_read_b64_tr_b16 a[58:59], v19 offset:63488
v_mfma_f32_16x16x32_bf16 v[156:159], a[124:127], v[124:127], v[156:159]
ds_read_b64_tr_b16 a[60:61], v20 offset:61440
v_mfma_f32_16x16x32_bf16 v[152:155], a[124:127], v[120:123], v[152:155]
ds_read_b64_tr_b16 a[62:63], v20 offset:63488
s_waitcnt vmcnt(20) lgkmcnt(8)
s_barrier
v_mfma_f32_16x16x32_bf16 v[160:163], a[0:3], v[64:67], 0
ds_read_b64_tr_b16 a[64:65], v13 offset:49152
s_add_u32 m0, s33, 147456
v_mfma_f32_16x16x32_bf16 v[164:167], a[0:3], v[68:71], 0
ds_read_b64_tr_b16 a[66:67], v13 offset:51200
buffer_load_dwordx4 v41, s[20:23], s44 offen lds
v_mfma_f32_16x16x32_bf16 v[172:175], a[4:7], v[68:71], 0
ds_read_b64_tr_b16 a[80:81], v13 offset:53248
v_cvt_pk_bf16_f32 v192, v128, v129
v_mfma_f32_16x16x32_bf16 v[168:171], a[4:7], v[64:67], 0
ds_read_b64_tr_b16 a[82:83], v13 offset:55296
v_cvt_pk_bf16_f32 v193, v130, v131
v_mfma_f32_16x16x32_bf16 v[176:179], a[8:11], v[64:67], 0
ds_read_b64_tr_b16 a[96:97], v13 offset:57344
buffer_load_dwordx4 v42, s[20:23], s44 offen offset:1024 lds
v_mfma_f32_16x16x32_bf16 v[180:183], a[8:11], v[68:71], 0
ds_read_b64_tr_b16 a[98:99], v13 offset:59392
v_cvt_pk_bf16_f32 v194, v136, v137
v_mfma_f32_16x16x32_bf16 v[188:191], a[12:15], v[68:71], 0
ds_read_b64_tr_b16 a[112:113], v13 offset:61440
v_cvt_pk_bf16_f32 v195, v138, v139
v_mfma_f32_16x16x32_bf16 v[184:187], a[12:15], v[64:67], 0
ds_read_b64_tr_b16 a[114:115], v13 offset:63488
s_waitcnt lgkmcnt(8)
v_mfma_f32_16x16x32_bf16 v[160:163], a[16:19], v[72:75], v[160:163]
ds_read_b64_tr_b16 a[68:69], v14 offset:49152
buffer_load_dwordx4 v43, s[20:23], s44 offen offset:2048 lds
v_mfma_f32_16x16x32_bf16 v[164:167], a[16:19], v[76:79], v[164:167]
ds_read_b64_tr_b16 a[70:71], v14 offset:51200
v_cvt_pk_bf16_f32 v196, v132, v133
v_mfma_f32_16x16x32_bf16 v[172:175], a[20:23], v[76:79], v[172:175]
ds_read_b64_tr_b16 a[84:85], v14 offset:53248
v_cvt_pk_bf16_f32 v197, v134, v135
v_mfma_f32_16x16x32_bf16 v[168:171], a[20:23], v[72:75], v[168:171]
ds_read_b64_tr_b16 a[86:87], v14 offset:55296
buffer_load_dwordx4 v44, s[20:23], s44 offen offset:3072 lds
v_mfma_f32_16x16x32_bf16 v[176:179], a[24:27], v[72:75], v[176:179]
ds_read_b64_tr_b16 a[100:101], v14 offset:57344
s_sub_u32 s44, s44, 114560
v_mfma_f32_16x16x32_bf16 v[180:183], a[24:27], v[76:79], v[180:183]
ds_read_b64_tr_b16 a[102:103], v14 offset:59392
s_cmp_eq_u32 s44, 896
s_cselect_b32 s44, 0, s44
v_mfma_f32_16x16x32_bf16 v[188:191], a[28:31], v[76:79], v[188:191]
ds_read_b64_tr_b16 a[116:117], v14 offset:61440
s_add_u32 m0, s33, 65536
v_mfma_f32_16x16x32_bf16 v[184:187], a[28:31], v[72:75], v[184:187]
ds_read_b64_tr_b16 a[118:119], v14 offset:63488
buffer_load_dwordx4 v41, s[20:23], s44 offen lds
v_mfma_f32_16x16x32_bf16 v[160:163], a[32:35], v[80:83], v[160:163]
ds_read_b64_tr_b16 a[72:73], v15 offset:49152
v_cvt_pk_bf16_f32 v198, v140, v141
v_mfma_f32_16x16x32_bf16 v[164:167], a[32:35], v[84:87], v[164:167]
ds_read_b64_tr_b16 a[74:75], v15 offset:51200
v_cvt_pk_bf16_f32 v199, v142, v143
v_mfma_f32_16x16x32_bf16 v[172:175], a[36:39], v[84:87], v[172:175]
ds_read_b64_tr_b16 a[88:89], v15 offset:53248
buffer_load_dwordx4 v42, s[20:23], s44 offen offset:1024 lds
v_mfma_f32_16x16x32_bf16 v[168:171], a[36:39], v[80:83], v[168:171]
ds_read_b64_tr_b16 a[90:91], v15 offset:55296
v_cvt_pk_bf16_f32 v200, v144, v145
v_mfma_f32_16x16x32_bf16 v[176:179], a[40:43], v[80:83], v[176:179]
ds_read_b64_tr_b16 a[104:105], v15 offset:57344
v_cvt_pk_bf16_f32 v201, v146, v147
v_mfma_f32_16x16x32_bf16 v[180:183], a[40:43], v[84:87], v[180:183]
ds_read_b64_tr_b16 a[106:107], v15 offset:59392
v_cvt_pk_bf16_f32 v202, v152, v153
v_mfma_f32_16x16x32_bf16 v[188:191], a[44:47], v[84:87], v[188:191]
ds_read_b64_tr_b16 a[120:121], v15 offset:61440
buffer_load_dwordx4 v43, s[20:23], s44 offen offset:2048 lds
v_mfma_f32_16x16x32_bf16 v[184:187], a[44:47], v[80:83], v[184:187]
ds_read_b64_tr_b16 a[122:123], v15 offset:63488
v_cvt_pk_bf16_f32 v203, v154, v155
v_mfma_f32_16x16x32_bf16 v[160:163], a[48:51], v[88:91], v[160:163]
ds_read_b64_tr_b16 a[76:77], v16 offset:49152
v_cvt_pk_bf16_f32 v204, v148, v149
v_mfma_f32_16x16x32_bf16 v[164:167], a[48:51], v[92:95], v[164:167]
ds_read_b64_tr_b16 a[78:79], v16 offset:51200
buffer_load_dwordx4 v44, s[20:23], s44 offen offset:3072 lds
v_mfma_f32_16x16x32_bf16 v[172:175], a[52:55], v[92:95], v[172:175]
ds_read_b64_tr_b16 a[92:93], v16 offset:53248
s_add_u32 s44, s44, 114688
v_mfma_f32_16x16x32_bf16 v[168:171], a[52:55], v[88:91], v[168:171]
ds_read_b64_tr_b16 a[94:95], v16 offset:55296
v_cvt_pk_bf16_f32 v205, v150, v151
v_mfma_f32_16x16x32_bf16 v[176:179], a[56:59], v[88:91], v[176:179]
ds_read_b64_tr_b16 a[108:109], v16 offset:57344
v_cvt_pk_bf16_f32 v206, v156, v157
v_mfma_f32_16x16x32_bf16 v[180:183], a[56:59], v[92:95], v[180:183]
ds_read_b64_tr_b16 a[110:111], v16 offset:59392
v_cvt_pk_bf16_f32 v207, v158, v159
v_mfma_f32_16x16x32_bf16 v[188:191], a[60:63], v[92:95], v[188:191]
ds_read_b64_tr_b16 a[124:125], v16 offset:61440
v_mfma_f32_16x16x32_bf16 v[184:187], a[60:63], v[88:91], v[184:187]
ds_read_b64_tr_b16 a[126:127], v16 offset:63488
s_waitcnt vmcnt(24) lgkmcnt(8)
s_barrier
v_mfma_f32_16x16x32_bf16 v[160:163], a[64:67], v[96:99], v[160:163]
ds_read_b64_tr_b16 a[0:1], v13 offset:32768
s_add_u32 m0, s33, 114688
v_mfma_f32_16x16x32_bf16 v[164:167], a[64:67], v[100:103], v[164:167]
ds_read_b64_tr_b16 a[2:3], v13 offset:34816
buffer_load_dwordx4 v41, s[20:23], s44 offen lds
v_mfma_f32_16x16x32_bf16 v[160:163], a[80:83], v[104:107], v[160:163]
ds_read_b64_tr_b16 a[4:5], v14 offset:32768
v_mfma_f32_16x16x32_bf16 v[164:167], a[80:83], v[108:111], v[164:167]
ds_read_b64_tr_b16 a[6:7], v14 offset:34816
v_mfma_f32_16x16x32_bf16 v[160:163], a[96:99], v[112:115], v[160:163]
ds_read_b64_tr_b16 a[8:9], v15 offset:32768
v_mfma_f32_16x16x32_bf16 v[164:167], a[96:99], v[116:119], v[164:167]
ds_read_b64_tr_b16 a[10:11], v15 offset:34816
v_mfma_f32_16x16x32_bf16 v[160:163], a[112:115], v[120:123], v[160:163]
ds_read_b64_tr_b16 a[12:13], v16 offset:32768
v_mfma_f32_16x16x32_bf16 v[164:167], a[112:115], v[124:127], v[164:167]
ds_read_b64_tr_b16 a[14:15], v16 offset:34816
s_waitcnt lgkmcnt(8)
v_mfma_f32_16x16x32_bf16 v[172:175], a[68:71], v[100:103], v[172:175]
ds_read_b64_tr_b16 a[16:17], v13 offset:36864
buffer_load_dwordx4 v42, s[20:23], s44 offen offset:1024 lds
v_mfma_f32_16x16x32_bf16 v[168:171], a[68:71], v[96:99], v[168:171]
ds_read_b64_tr_b16 a[18:19], v13 offset:38912
v_mfma_f32_16x16x32_bf16 v[172:175], a[84:87], v[108:111], v[172:175]
ds_read_b64_tr_b16 a[20:21], v14 offset:36864
v_mfma_f32_16x16x32_bf16 v[168:171], a[84:87], v[104:107], v[168:171]
ds_read_b64_tr_b16 a[22:23], v14 offset:38912
v_mfma_f32_16x16x32_bf16 v[172:175], a[100:103], v[116:119], v[172:175]
ds_read_b64_tr_b16 a[24:25], v15 offset:36864
v_mfma_f32_16x16x32_bf16 v[168:171], a[100:103], v[112:115], v[168:171]
ds_read_b64_tr_b16 a[26:27], v15 offset:38912
v_mfma_f32_16x16x32_bf16 v[172:175], a[116:119], v[124:127], v[172:175]
ds_read_b64_tr_b16 a[28:29], v16 offset:36864
v_mfma_f32_16x16x32_bf16 v[168:171], a[116:119], v[120:123], v[168:171]
ds_read_b64_tr_b16 a[30:31], v16 offset:38912
buffer_load_dwordx4 v43, s[20:23], s44 offen offset:2048 lds
v_mfma_f32_16x16x32_bf16 v[176:179], a[72:75], v[96:99], v[176:179]
ds_read_b64_tr_b16 a[32:33], v13 offset:40960
v_mfma_f32_16x16x32_bf16 v[180:183], a[72:75], v[100:103], v[180:183]
ds_read_b64_tr_b16 a[34:35], v13 offset:43008
v_mfma_f32_16x16x32_bf16 v[176:179], a[88:91], v[104:107], v[176:179]
ds_read_b64_tr_b16 a[36:37], v14 offset:40960
v_mfma_f32_16x16x32_bf16 v[180:183], a[88:91], v[108:111], v[180:183]
ds_read_b64_tr_b16 a[38:39], v14 offset:43008
v_cvt_pk_bf16_f32 v208, v160, v161
v_mfma_f32_16x16x32_bf16 v[176:179], a[104:107], v[112:115], v[176:179]
ds_read_b64_tr_b16 a[40:41], v15 offset:40960
v_cvt_pk_bf16_f32 v209, v162, v163
v_mfma_f32_16x16x32_bf16 v[180:183], a[104:107], v[116:119], v[180:183]
ds_read_b64_tr_b16 a[42:43], v15 offset:43008
v_cvt_pk_bf16_f32 v210, v168, v169
v_mfma_f32_16x16x32_bf16 v[176:179], a[120:123], v[120:123], v[176:179]
ds_read_b64_tr_b16 a[44:45], v16 offset:40960
buffer_load_dwordx4 v44, s[20:23], s44 offen offset:3072 lds
v_mfma_f32_16x16x32_bf16 v[180:183], a[120:123], v[124:127], v[180:183]
ds_read_b64_tr_b16 a[46:47], v16 offset:43008
s_sub_u32 s44, s44, 114560
v_mfma_f32_16x16x32_bf16 v[188:191], a[76:79], v[100:103], v[188:191]
ds_read_b64_tr_b16 a[48:49], v13 offset:45056
s_cmp_eq_u32 s44, 896
s_cselect_b32 s44, 0, s44
v_mfma_f32_16x16x32_bf16 v[184:187], a[76:79], v[96:99], v[184:187]
ds_read_b64_tr_b16 a[50:51], v13 offset:47104
v_cvt_pk_bf16_f32 v211, v170, v171
v_mfma_f32_16x16x32_bf16 v[188:191], a[92:95], v[108:111], v[188:191]
ds_read_b64_tr_b16 a[52:53], v14 offset:45056
v_cvt_pk_bf16_f32 v212, v164, v165
v_mfma_f32_16x16x32_bf16 v[184:187], a[92:95], v[104:107], v[184:187]
ds_read_b64_tr_b16 a[54:55], v14 offset:47104
v_cvt_pk_bf16_f32 v213, v166, v167
v_mfma_f32_16x16x32_bf16 v[188:191], a[108:111], v[116:119], v[188:191]
ds_read_b64_tr_b16 a[56:57], v15 offset:45056
v_cvt_pk_bf16_f32 v214, v172, v173
v_mfma_f32_16x16x32_bf16 v[184:187], a[108:111], v[112:115], v[184:187]
ds_read_b64_tr_b16 a[58:59], v15 offset:47104
v_cvt_pk_bf16_f32 v215, v174, v175
v_mfma_f32_16x16x32_bf16 v[188:191], a[124:127], v[124:127], v[188:191]
ds_read_b64_tr_b16 a[60:61], v16 offset:45056
v_mfma_f32_16x16x32_bf16 v[184:187], a[124:127], v[120:123], v[184:187]
ds_read_b64_tr_b16 a[62:63], v16 offset:47104
s_cmp_gt_u32 s101, s55
s_cselect_b32 s3, 8192, 0
v_add_u32 v59, s3, v59
s_cmp_eq_u32 s101, s55
s_cselect_b32 s3, s33, 0
s_and_b32 s3, s3, 0x2000
v_add_u32 v59, s3, v59
v_bfe_u32 v61, v0, 0, 1
v_xor_b32 v61, 1, v61
v_lshl_add_u32 v58, v61, 13, v58
v_lshl_add_u32 v60, v61, 13, v60
s_waitcnt vmcnt(24) lgkmcnt(8)
s_barrier
v_mfma_f32_16x16x32_bf16 v[128:131], a[0:3], v[64:67], 0
ds_read_b64_tr_b16 a[64:65], v17 offset:32768
s_add_u32 m0, s33, 49152
v_mfma_f32_16x16x32_bf16 v[132:135], a[0:3], v[68:71], 0
ds_read_b64_tr_b16 a[66:67], v17 offset:34816
buffer_load_dwordx4 v41, s[20:23], s44 offen lds
v_mfma_f32_16x16x32_bf16 v[140:143], a[4:7], v[68:71], 0
ds_read_b64_tr_b16 a[80:81], v17 offset:36864
buffer_store_dwordx4 v[192:195], v45, s[24:27], s45 offen sc1
v_mfma_f32_16x16x32_bf16 v[136:139], a[4:7], v[64:67], 0
ds_read_b64_tr_b16 a[82:83], v17 offset:38912
v_cvt_pk_bf16_f32 v216, v176, v177
v_mfma_f32_16x16x32_bf16 v[144:147], a[8:11], v[64:67], 0
ds_read_b64_tr_b16 a[96:97], v17 offset:40960
v_cvt_pk_bf16_f32 v217, v178, v179
v_mfma_f32_16x16x32_bf16 v[148:151], a[8:11], v[68:71], 0
ds_read_b64_tr_b16 a[98:99], v17 offset:43008
v_cvt_pk_bf16_f32 v218, v184, v185
v_mfma_f32_16x16x32_bf16 v[156:159], a[12:15], v[68:71], 0
ds_read_b64_tr_b16 a[112:113], v17 offset:45056
v_cvt_pk_bf16_f32 v219, v186, v187
v_mfma_f32_16x16x32_bf16 v[152:155], a[12:15], v[64:67], 0
ds_read_b64_tr_b16 a[114:115], v17 offset:47104
s_waitcnt lgkmcnt(8)
v_mfma_f32_16x16x32_bf16 v[128:131], a[16:19], v[72:75], v[128:131]
ds_read_b64_tr_b16 a[68:69], v18 offset:32768
buffer_load_dwordx4 v42, s[20:23], s44 offen offset:1024 lds
v_mfma_f32_16x16x32_bf16 v[132:135], a[16:19], v[76:79], v[132:135]
ds_read_b64_tr_b16 a[70:71], v18 offset:34816
v_cvt_pk_bf16_f32 v220, v180, v181
v_mfma_f32_16x16x32_bf16 v[140:143], a[20:23], v[76:79], v[140:143]
ds_read_b64_tr_b16 a[84:85], v18 offset:36864
v_cvt_pk_bf16_f32 v221, v182, v183
v_mfma_f32_16x16x32_bf16 v[136:139], a[20:23], v[72:75], v[136:139]
ds_read_b64_tr_b16 a[86:87], v18 offset:38912
v_cvt_pk_bf16_f32 v222, v188, v189
v_mfma_f32_16x16x32_bf16 v[144:147], a[24:27], v[72:75], v[144:147]
ds_read_b64_tr_b16 a[100:101], v18 offset:40960
v_cvt_pk_bf16_f32 v223, v190, v191
v_mfma_f32_16x16x32_bf16 v[148:151], a[24:27], v[76:79], v[148:151]
ds_read_b64_tr_b16 a[102:103], v18 offset:43008
buffer_store_dwordx4 v[196:199], v46, s[24:27], s45 offen sc1
v_mfma_f32_16x16x32_bf16 v[156:159], a[28:31], v[76:79], v[156:159]
ds_read_b64_tr_b16 a[116:117], v18 offset:45056
s_add_u32 s45, s45, s54
v_mfma_f32_16x16x32_bf16 v[152:155], a[28:31], v[72:75], v[152:155]
ds_read_b64_tr_b16 a[118:119], v18 offset:47104
buffer_load_dwordx4 v43, s[20:23], s44 offen offset:2048 lds
v_mfma_f32_16x16x32_bf16 v[128:131], a[32:35], v[80:83], v[128:131]
ds_read_b64_tr_b16 a[72:73], v19 offset:32768
v_mfma_f32_16x16x32_bf16 v[132:135], a[32:35], v[84:87], v[132:135]
ds_read_b64_tr_b16 a[74:75], v19 offset:34816
v_mfma_f32_16x16x32_bf16 v[140:143], a[36:39], v[84:87], v[140:143]
ds_read_b64_tr_b16 a[88:89], v19 offset:36864
v_mfma_f32_16x16x32_bf16 v[136:139], a[36:39], v[80:83], v[136:139]
ds_read_b64_tr_b16 a[90:91], v19 offset:38912
v_mfma_f32_16x16x32_bf16 v[144:147], a[40:43], v[80:83], v[144:147]
ds_read_b64_tr_b16 a[104:105], v19 offset:40960
v_mfma_f32_16x16x32_bf16 v[148:151], a[40:43], v[84:87], v[148:151]
ds_read_b64_tr_b16 a[106:107], v19 offset:43008
v_mfma_f32_16x16x32_bf16 v[156:159], a[44:47], v[84:87], v[156:159]
ds_read_b64_tr_b16 a[120:121], v19 offset:45056
buffer_load_dwordx4 v44, s[20:23], s44 offen offset:3072 lds
v_mfma_f32_16x16x32_bf16 v[152:155], a[44:47], v[80:83], v[152:155]
ds_read_b64_tr_b16 a[122:123], v19 offset:47104
s_add_u32 s44, s44, 114688
v_mfma_f32_16x16x32_bf16 v[128:131], a[48:51], v[88:91], v[128:131]
ds_read_b64_tr_b16 a[76:77], v20 offset:32768
buffer_store_dwordx4 v[200:203], v45, s[24:27], s45 offen sc1
v_mfma_f32_16x16x32_bf16 v[132:135], a[48:51], v[92:95], v[132:135]
ds_read_b64_tr_b16 a[78:79], v20 offset:34816
v_mfma_f32_16x16x32_bf16 v[140:143], a[52:55], v[92:95], v[140:143]
ds_read_b64_tr_b16 a[92:93], v20 offset:36864
v_mfma_f32_16x16x32_bf16 v[136:139], a[52:55], v[88:91], v[136:139]
ds_read_b64_tr_b16 a[94:95], v20 offset:38912
v_mfma_f32_16x16x32_bf16 v[144:147], a[56:59], v[88:91], v[144:147]
ds_read_b64_tr_b16 a[108:109], v20 offset:40960
v_mfma_f32_16x16x32_bf16 v[148:151], a[56:59], v[92:95], v[148:151]
ds_read_b64_tr_b16 a[110:111], v20 offset:43008
v_mfma_f32_16x16x32_bf16 v[156:159], a[60:63], v[92:95], v[156:159]
ds_read_b64_tr_b16 a[124:125], v20 offset:45056
v_mfma_f32_16x16x32_bf16 v[152:155], a[60:63], v[88:91], v[152:155]
ds_read_b64_tr_b16 a[126:127], v20 offset:47104
s_waitcnt vmcnt(27) lgkmcnt(8)
s_barrier
v_mfma_f32_16x16x32_bf16 v[128:131], a[64:67], v[96:99], v[128:131]
ds_read_b64_tr_b16 a[0:1], v17 offset:16384
s_add_u32 m0, s33, 32768
v_mfma_f32_16x16x32_bf16 v[132:135], a[64:67], v[100:103], v[132:135]
ds_read_b64_tr_b16 a[2:3], v17 offset:18432
buffer_load_dwordx4 v41, s[20:23], s44 offen lds
v_mfma_f32_16x16x32_bf16 v[128:131], a[80:83], v[104:107], v[128:131]
ds_read_b64_tr_b16 a[4:5], v18 offset:16384
v_mfma_f32_16x16x32_bf16 v[132:135], a[80:83], v[108:111], v[132:135]
ds_read_b64_tr_b16 a[6:7], v18 offset:18432
buffer_store_dwordx4 v[204:207], v46, s[24:27], s45 offen sc1
v_mfma_f32_16x16x32_bf16 v[128:131], a[96:99], v[112:115], v[128:131]
ds_read_b64_tr_b16 a[8:9], v19 offset:16384
s_add_u32 s45, s45, s50
v_mfma_f32_16x16x32_bf16 v[132:135], a[96:99], v[116:119], v[132:135]
ds_read_b64_tr_b16 a[10:11], v19 offset:18432
v_mfma_f32_16x16x32_bf16 v[128:131], a[112:115], v[120:123], v[128:131]
ds_read_b64_tr_b16 a[12:13], v20 offset:16384
v_mfma_f32_16x16x32_bf16 v[132:135], a[112:115], v[124:127], v[132:135]
ds_read_b64_tr_b16 a[14:15], v20 offset:18432
s_waitcnt lgkmcnt(8)
v_mfma_f32_16x16x32_bf16 v[140:143], a[68:71], v[100:103], v[140:143]
ds_read_b64_tr_b16 a[16:17], v17 offset:20480
buffer_load_dwordx4 v42, s[20:23], s44 offen offset:1024 lds
v_mfma_f32_16x16x32_bf16 v[136:139], a[68:71], v[96:99], v[136:139]
ds_read_b64_tr_b16 a[18:19], v17 offset:22528
v_mfma_f32_16x16x32_bf16 v[140:143], a[84:87], v[108:111], v[140:143]
ds_read_b64_tr_b16 a[20:21], v18 offset:20480
v_mfma_f32_16x16x32_bf16 v[136:139], a[84:87], v[104:107], v[136:139]
ds_read_b64_tr_b16 a[22:23], v18 offset:22528
v_mfma_f32_16x16x32_bf16 v[140:143], a[100:103], v[116:119], v[140:143]
ds_read_b64_tr_b16 a[24:25], v19 offset:20480
v_mfma_f32_16x16x32_bf16 v[136:139], a[100:103], v[112:115], v[136:139]
ds_read_b64_tr_b16 a[26:27], v19 offset:22528
v_mfma_f32_16x16x32_bf16 v[140:143], a[116:119], v[124:127], v[140:143]
ds_read_b64_tr_b16 a[28:29], v20 offset:20480
buffer_store_dwordx4 v[208:211], v45, s[24:27], s45 offen sc1
v_mfma_f32_16x16x32_bf16 v[136:139], a[116:119], v[120:123], v[136:139]
ds_read_b64_tr_b16 a[30:31], v20 offset:22528
buffer_load_dwordx4 v43, s[20:23], s44 offen offset:2048 lds
v_mfma_f32_16x16x32_bf16 v[144:147], a[72:75], v[96:99], v[144:147]
ds_read_b64_tr_b16 a[32:33], v17 offset:24576
v_mfma_f32_16x16x32_bf16 v[148:151], a[72:75], v[100:103], v[148:151]
ds_read_b64_tr_b16 a[34:35], v17 offset:26624
v_mfma_f32_16x16x32_bf16 v[144:147], a[88:91], v[104:107], v[144:147]
ds_read_b64_tr_b16 a[36:37], v18 offset:24576
v_mfma_f32_16x16x32_bf16 v[148:151], a[88:91], v[108:111], v[148:151]
ds_read_b64_tr_b16 a[38:39], v18 offset:26624
v_cvt_pk_bf16_f32 v224, v128, v129
v_mfma_f32_16x16x32_bf16 v[144:147], a[104:107], v[112:115], v[144:147]
ds_read_b64_tr_b16 a[40:41], v19 offset:24576
v_cvt_pk_bf16_f32 v225, v130, v131
v_mfma_f32_16x16x32_bf16 v[148:151], a[104:107], v[116:119], v[148:151]
ds_read_b64_tr_b16 a[42:43], v19 offset:26624
v_cvt_pk_bf16_f32 v226, v136, v137
v_mfma_f32_16x16x32_bf16 v[144:147], a[120:123], v[120:123], v[144:147]
ds_read_b64_tr_b16 a[44:45], v20 offset:24576
buffer_load_dwordx4 v44, s[20:23], s44 offen offset:3072 lds
v_mfma_f32_16x16x32_bf16 v[148:151], a[120:123], v[124:127], v[148:151]
ds_read_b64_tr_b16 a[46:47], v20 offset:26624
s_sub_u32 s44, s44, 114560
v_mfma_f32_16x16x32_bf16 v[156:159], a[76:79], v[100:103], v[156:159]
ds_read_b64_tr_b16 a[48:49], v17 offset:28672
s_cmp_eq_u32 s44, 896
s_cselect_b32 s44, 0, s44
v_mfma_f32_16x16x32_bf16 v[152:155], a[76:79], v[96:99], v[152:155]
ds_read_b64_tr_b16 a[50:51], v17 offset:30720
buffer_store_dwordx4 v[212:215], v46, s[24:27], s45 offen sc1
v_mfma_f32_16x16x32_bf16 v[156:159], a[92:95], v[108:111], v[156:159]
ds_read_b64_tr_b16 a[52:53], v18 offset:28672
s_add_u32 s45, s45, s54
v_mfma_f32_16x16x32_bf16 v[152:155], a[92:95], v[104:107], v[152:155]
ds_read_b64_tr_b16 a[54:55], v18 offset:30720
v_cvt_pk_bf16_f32 v227, v138, v139
v_mfma_f32_16x16x32_bf16 v[156:159], a[108:111], v[116:119], v[156:159]
ds_read_b64_tr_b16 a[56:57], v19 offset:28672
v_cvt_pk_bf16_f32 v228, v132, v133
v_mfma_f32_16x16x32_bf16 v[152:155], a[108:111], v[112:115], v[152:155]
ds_read_b64_tr_b16 a[58:59], v19 offset:30720
v_cvt_pk_bf16_f32 v229, v134, v135
v_mfma_f32_16x16x32_bf16 v[156:159], a[124:127], v[124:127], v[156:159]
ds_read_b64_tr_b16 a[60:61], v20 offset:28672
v_cvt_pk_bf16_f32 v230, v140, v141
v_mfma_f32_16x16x32_bf16 v[152:155], a[124:127], v[120:123], v[152:155]
ds_read_b64_tr_b16 a[62:63], v20 offset:30720
s_waitcnt vmcnt(30) lgkmcnt(8)
s_barrier
v_mfma_f32_16x16x32_bf16 v[160:163], a[0:3], v[64:67], 0
ds_read_b64_tr_b16 a[64:65], v21 offset:0
v_cvt_pk_bf16_f32 v231, v142, v143
v_mfma_f32_16x16x32_bf16 v[164:167], a[0:3], v[68:71], 0
ds_read_b64_tr_b16 a[66:67], v21 offset:2048
v_mfma_f32_16x16x32_bf16 v[172:175], a[4:7], v[68:71], 0
ds_read_b64_tr_b16 a[80:81], v21 offset:4096
v_mfma_f32_16x16x32_bf16 v[168:171], a[4:7], v[64:67], 0
ds_read_b64_tr_b16 a[82:83], v21 offset:6144
v_cvt_pk_bf16_f32 v232, v144, v145
v_mfma_f32_16x16x32_bf16 v[176:179], a[8:11], v[64:67], 0
ds_read_b64_tr_b16 a[96:97], v21 offset:8192
buffer_store_dwordx4 v[216:219], v45, s[24:27], s45 offen sc1
v_mfma_f32_16x16x32_bf16 v[180:183], a[8:11], v[68:71], 0
ds_read_b64_tr_b16 a[98:99], v21 offset:10240
v_cvt_pk_bf16_f32 v233, v146, v147
v_mfma_f32_16x16x32_bf16 v[188:191], a[12:15], v[68:71], 0
ds_read_b64_tr_b16 a[112:113], v21 offset:12288
v_cvt_pk_bf16_f32 v234, v152, v153
v_mfma_f32_16x16x32_bf16 v[184:187], a[12:15], v[64:67], 0
ds_read_b64_tr_b16 a[114:115], v21 offset:14336
s_waitcnt lgkmcnt(8)
v_mfma_f32_16x16x32_bf16 v[160:163], a[16:19], v[72:75], v[160:163]
ds_read_b64_tr_b16 a[68:69], v22 offset:0
v_cvt_pk_bf16_f32 v235, v154, v155
v_mfma_f32_16x16x32_bf16 v[164:167], a[16:19], v[76:79], v[164:167]
ds_read_b64_tr_b16 a[70:71], v22 offset:2048
v_cvt_pk_bf16_f32 v236, v148, v149
v_mfma_f32_16x16x32_bf16 v[172:175], a[20:23], v[76:79], v[172:175]
ds_read_b64_tr_b16 a[84:85], v22 offset:4096
v_cvt_pk_bf16_f32 v237, v150, v151
v_mfma_f32_16x16x32_bf16 v[168:171], a[20:23], v[72:75], v[168:171]
ds_read_b64_tr_b16 a[86:87], v22 offset:6144
v_cvt_pk_bf16_f32 v238, v156, v157
v_mfma_f32_16x16x32_bf16 v[176:179], a[24:27], v[72:75], v[176:179]
ds_read_b64_tr_b16 a[100:101], v22 offset:8192
v_cvt_pk_bf16_f32 v239, v158, v159
v_mfma_f32_16x16x32_bf16 v[180:183], a[24:27], v[76:79], v[180:183]
ds_read_b64_tr_b16 a[102:103], v22 offset:10240
v_mfma_f32_16x16x32_bf16 v[188:191], a[28:31], v[76:79], v[188:191]
ds_read_b64_tr_b16 a[116:117], v22 offset:12288
v_mfma_f32_16x16x32_bf16 v[184:187], a[28:31], v[72:75], v[184:187]
ds_read_b64_tr_b16 a[118:119], v22 offset:14336
buffer_store_dwordx4 v[220:223], v46, s[24:27], s45 offen sc1
v_mfma_f32_16x16x32_bf16 v[160:163], a[32:35], v[80:83], v[160:163]
ds_read_b64_tr_b16 a[72:73], v23 offset:0
s_add_u32 s45, s45, s50
v_mfma_f32_16x16x32_bf16 v[164:167], a[32:35], v[84:87], v[164:167]
ds_read_b64_tr_b16 a[74:75], v23 offset:2048
v_mfma_f32_16x16x32_bf16 v[172:175], a[36:39], v[84:87], v[172:175]
ds_read_b64_tr_b16 a[88:89], v23 offset:4096
v_mfma_f32_16x16x32_bf16 v[168:171], a[36:39], v[80:83], v[168:171]
ds_read_b64_tr_b16 a[90:91], v23 offset:6144
v_mfma_f32_16x16x32_bf16 v[176:179], a[40:43], v[80:83], v[176:179]
ds_read_b64_tr_b16 a[104:105], v23 offset:8192
v_mfma_f32_16x16x32_bf16 v[180:183], a[40:43], v[84:87], v[180:183]
ds_read_b64_tr_b16 a[106:107], v23 offset:10240
v_mfma_f32_16x16x32_bf16 v[188:191], a[44:47], v[84:87], v[188:191]
ds_read_b64_tr_b16 a[120:121], v23 offset:12288
v_mfma_f32_16x16x32_bf16 v[184:187], a[44:47], v[80:83], v[184:187]
ds_read_b64_tr_b16 a[122:123], v23 offset:14336
v_mfma_f32_16x16x32_bf16 v[160:163], a[48:51], v[88:91], v[160:163]
ds_read_b64_tr_b16 a[76:77], v24 offset:0
v_mfma_f32_16x16x32_bf16 v[164:167], a[48:51], v[92:95], v[164:167]
ds_read_b64_tr_b16 a[78:79], v24 offset:2048
v_mfma_f32_16x16x32_bf16 v[172:175], a[52:55], v[92:95], v[172:175]
ds_read_b64_tr_b16 a[92:93], v24 offset:4096
buffer_store_dwordx4 v[224:227], v45, s[24:27], s45 offen sc1
v_mfma_f32_16x16x32_bf16 v[168:171], a[52:55], v[88:91], v[168:171]
ds_read_b64_tr_b16 a[94:95], v24 offset:6144
v_mfma_f32_16x16x32_bf16 v[176:179], a[56:59], v[88:91], v[176:179]
ds_read_b64_tr_b16 a[108:109], v24 offset:8192
v_mfma_f32_16x16x32_bf16 v[180:183], a[56:59], v[92:95], v[180:183]
ds_read_b64_tr_b16 a[110:111], v24 offset:10240
v_mfma_f32_16x16x32_bf16 v[188:191], a[60:63], v[92:95], v[188:191]
ds_read_b64_tr_b16 a[124:125], v24 offset:12288
v_mfma_f32_16x16x32_bf16 v[184:187], a[60:63], v[88:91], v[184:187]
ds_read_b64_tr_b16 a[126:127], v24 offset:14336
s_waitcnt vmcnt(29) lgkmcnt(8)
s_barrier
v_mfma_f32_16x16x32_bf16 v[160:163], a[64:67], v[96:99], v[160:163]
ds_read_b64_tr_b16 a[0:1], v13 offset:16384
L_pad10:
s_cbranch_execz L_hr2
v_mfma_f32_16x16x32_bf16 v[164:167], a[64:67], v[100:103], v[164:167]
ds_read_b64_tr_b16 a[2:3], v13 offset:18432
v_mfma_f32_16x16x32_bf16 v[160:163], a[80:83], v[104:107], v[160:163]
ds_read_b64_tr_b16 a[4:5], v14 offset:16384
v_mfma_f32_16x16x32_bf16 v[164:167], a[80:83], v[108:111], v[164:167]
ds_read_b64_tr_b16 a[6:7], v14 offset:18432
v_mfma_f32_16x16x32_bf16 v[160:163], a[96:99], v[112:115], v[160:163]
ds_read_b64_tr_b16 a[8:9], v15 offset:16384
v_mfma_f32_16x16x32_bf16 v[164:167], a[96:99], v[116:119], v[164:167]
ds_read_b64_tr_b16 a[10:11], v15 offset:18432
buffer_store_dwordx4 v[228:231], v46, s[24:27], s45 offen sc1
v_mfma_f32_16x16x32_bf16 v[160:163], a[112:115], v[120:123], v[160:163]
ds_read_b64_tr_b16 a[12:13], v16 offset:16384
s_add_u32 s45, s45, s54
v_mfma_f32_16x16x32_bf16 v[164:167], a[112:115], v[124:127], v[164:167]
ds_read_b64_tr_b16 a[14:15], v16 offset:18432
s_waitcnt lgkmcnt(8)
v_mfma_f32_16x16x32_bf16 v[172:175], a[68:71], v[100:103], v[172:175]
ds_read_b64_tr_b16 a[16:17], v13 offset:20480
v_mfma_f32_16x16x32_bf16 v[168:171], a[68:71], v[96:99], v[168:171]
ds_read_b64_tr_b16 a[18:19], v13 offset:22528
v_mfma_f32_16x16x32_bf16 v[172:175], a[84:87], v[108:111], v[172:175]
ds_read_b64_tr_b16 a[20:21], v14 offset:20480
v_mfma_f32_16x16x32_bf16 v[168:171], a[84:87], v[104:107], v[168:171]
ds_read_b64_tr_b16 a[22:23], v14 offset:22528
v_mfma_f32_16x16x32_bf16 v[172:175], a[100:103], v[116:119], v[172:175]
ds_read_b64_tr_b16 a[24:25], v15 offset:20480
v_mfma_f32_16x16x32_bf16 v[168:171], a[100:103], v[112:115], v[168:171]
ds_read_b64_tr_b16 a[26:27], v15 offset:22528
v_mfma_f32_16x16x32_bf16 v[172:175], a[116:119], v[124:127], v[172:175]
ds_read_b64_tr_b16 a[28:29], v16 offset:20480
v_mfma_f32_16x16x32_bf16 v[168:171], a[116:119], v[120:123], v[168:171]
ds_read_b64_tr_b16 a[30:31], v16 offset:22528
v_mfma_f32_16x16x32_bf16 v[176:179], a[72:75], v[96:99], v[176:179]
ds_read_b64_tr_b16 a[32:33], v13 offset:24576
buffer_store_dwordx4 v[232:235], v45, s[24:27], s45 offen sc1
v_mfma_f32_16x16x32_bf16 v[180:183], a[72:75], v[100:103], v[180:183]
ds_read_b64_tr_b16 a[34:35], v13 offset:26624
v_mfma_f32_16x16x32_bf16 v[176:179], a[88:91], v[104:107], v[176:179]
ds_read_b64_tr_b16 a[36:37], v14 offset:24576
v_mfma_f32_16x16x32_bf16 v[180:183], a[88:91], v[108:111], v[180:183]
ds_read_b64_tr_b16 a[38:39], v14 offset:26624
v_cvt_pk_bf16_f32 v240, v160, v161
v_mfma_f32_16x16x32_bf16 v[176:179], a[104:107], v[112:115], v[176:179]
ds_read_b64_tr_b16 a[40:41], v15 offset:24576
v_cvt_pk_bf16_f32 v241, v162, v163
v_mfma_f32_16x16x32_bf16 v[180:183], a[104:107], v[116:119], v[180:183]
ds_read_b64_tr_b16 a[42:43], v15 offset:26624
v_cvt_pk_bf16_f32 v242, v168, v169
v_mfma_f32_16x16x32_bf16 v[176:179], a[120:123], v[120:123], v[176:179]
ds_read_b64_tr_b16 a[44:45], v16 offset:24576
v_cvt_pk_bf16_f32 v243, v170, v171
v_mfma_f32_16x16x32_bf16 v[180:183], a[120:123], v[124:127], v[180:183]
ds_read_b64_tr_b16 a[46:47], v16 offset:26624
v_cvt_pk_bf16_f32 v244, v164, v165
v_mfma_f32_16x16x32_bf16 v[188:191], a[76:79], v[100:103], v[188:191]
ds_read_b64_tr_b16 a[48:49], v13 offset:28672
v_cvt_pk_bf16_f32 v245, v166, v167
v_mfma_f32_16x16x32_bf16 v[184:187], a[76:79], v[96:99], v[184:187]
ds_read_b64_tr_b16 a[50:51], v13 offset:30720
v_cvt_pk_bf16_f32 v246, v172, v173
v_mfma_f32_16x16x32_bf16 v[188:191], a[92:95], v[108:111], v[188:191]
ds_read_b64_tr_b16 a[52:53], v14 offset:28672
v_cvt_pk_bf16_f32 v247, v174, v175
v_mfma_f32_16x16x32_bf16 v[184:187], a[92:95], v[104:107], v[184:187]
ds_read_b64_tr_b16 a[54:55], v14 offset:30720
buffer_store_dwordx4 v[236:239], v46, s[24:27], s45 offen sc1
v_mfma_f32_16x16x32_bf16 v[188:191], a[108:111], v[116:119], v[188:191]
ds_read_b64_tr_b16 a[56:57], v15 offset:28672
s_add_u32 s45, s45, s50
v_mfma_f32_16x16x32_bf16 v[184:187], a[108:111], v[112:115], v[184:187]
ds_read_b64_tr_b16 a[58:59], v15 offset:30720
v_mfma_f32_16x16x32_bf16 v[188:191], a[124:127], v[124:127], v[188:191]
ds_read_b64_tr_b16 a[60:61], v16 offset:28672
v_mfma_f32_16x16x32_bf16 v[184:187], a[124:127], v[120:123], v[184:187]
ds_read_b64_tr_b16 a[62:63], v16 offset:30720
s_waitcnt vmcnt(28) lgkmcnt(8)
s_barrier
v_mfma_f32_16x16x32_bf16 v[128:131], a[0:3], v[64:67], 0
ds_read_b64_tr_b16 a[64:65], v21 offset:16384
v_mfma_f32_16x16x32_bf16 v[132:135], a[0:3], v[68:71], 0
ds_read_b64_tr_b16 a[66:67], v21 offset:18432
v_mfma_f32_16x16x32_bf16 v[140:143], a[4:7], v[68:71], 0
ds_read_b64_tr_b16 a[80:81], v21 offset:20480
v_mfma_f32_16x16x32_bf16 v[136:139], a[4:7], v[64:67], 0
ds_read_b64_tr_b16 a[82:83], v21 offset:22528
v_cvt_pk_bf16_f32 v248, v176, v177
v_mfma_f32_16x16x32_bf16 v[144:147], a[8:11], v[64:67], 0
ds_read_b64_tr_b16 a[96:97], v21 offset:24576
v_cvt_pk_bf16_f32 v249, v178, v179
v_mfma_f32_16x16x32_bf16 v[148:151], a[8:11], v[68:71], 0
ds_read_b64_tr_b16 a[98:99], v21 offset:26624
v_cvt_pk_bf16_f32 v250, v184, v185
v_mfma_f32_16x16x32_bf16 v[156:159], a[12:15], v[68:71], 0
ds_read_b64_tr_b16 a[112:113], v21 offset:28672
buffer_store_dwordx4 v[240:243], v45, s[24:27], s45 offen sc1
v_mfma_f32_16x16x32_bf16 v[152:155], a[12:15], v[64:67], 0
ds_read_b64_tr_b16 a[114:115], v21 offset:30720
s_waitcnt lgkmcnt(8)
v_mfma_f32_16x16x32_bf16 v[128:131], a[16:19], v[72:75], v[128:131]
ds_read_b64_tr_b16 a[68:69], v22 offset:16384
v_cvt_pk_bf16_f32 v251, v186, v187
v_mfma_f32_16x16x32_bf16 v[132:135], a[16:19], v[76:79], v[132:135]
ds_read_b64_tr_b16 a[70:71], v22 offset:18432
v_cvt_pk_bf16_f32 v252, v180, v181
v_mfma_f32_16x16x32_bf16 v[140:143], a[20:23], v[76:79], v[140:143]
ds_read_b64_tr_b16 a[84:85], v22 offset:20480
v_cvt_pk_bf16_f32 v253, v182, v183
v_mfma_f32_16x16x32_bf16 v[136:139], a[20:23], v[72:75], v[136:139]
ds_read_b64_tr_b16 a[86:87], v22 offset:22528
v_cvt_pk_bf16_f32 v254, v188, v189
v_mfma_f32_16x16x32_bf16 v[144:147], a[24:27], v[72:75], v[144:147]
ds_read_b64_tr_b16 a[100:101], v22 offset:24576
v_cvt_pk_bf16_f32 v255, v190, v191
v_mfma_f32_16x16x32_bf16 v[148:151], a[24:27], v[76:79], v[148:151]
ds_read_b64_tr_b16 a[102:103], v22 offset:26624
v_mfma_f32_16x16x32_bf16 v[156:159], a[28:31], v[76:79], v[156:159]
ds_read_b64_tr_b16 a[116:117], v22 offset:28672
v_mfma_f32_16x16x32_bf16 v[152:155], a[28:31], v[72:75], v[152:155]
ds_read_b64_tr_b16 a[118:119], v22 offset:30720
v_mfma_f32_16x16x32_bf16 v[128:131], a[32:35], v[80:83], v[128:131]
ds_read_b64_tr_b16 a[72:73], v23 offset:16384
v_mfma_f32_16x16x32_bf16 v[132:135], a[32:35], v[84:87], v[132:135]
ds_read_b64_tr_b16 a[74:75], v23 offset:18432
buffer_store_dwordx4 v[244:247], v46, s[24:27], s45 offen sc1
v_mfma_f32_16x16x32_bf16 v[140:143], a[36:39], v[84:87], v[140:143]
ds_read_b64_tr_b16 a[88:89], v23 offset:20480
s_add_u32 s45, s45, s54
v_mfma_f32_16x16x32_bf16 v[136:139], a[36:39], v[80:83], v[136:139]
ds_read_b64_tr_b16 a[90:91], v23 offset:22528
v_mfma_f32_16x16x32_bf16 v[144:147], a[40:43], v[80:83], v[144:147]
ds_read_b64_tr_b16 a[104:105], v23 offset:24576
v_mfma_f32_16x16x32_bf16 v[148:151], a[40:43], v[84:87], v[148:151]
ds_read_b64_tr_b16 a[106:107], v23 offset:26624
v_mfma_f32_16x16x32_bf16 v[156:159], a[44:47], v[84:87], v[156:159]
ds_read_b64_tr_b16 a[120:121], v23 offset:28672
v_mfma_f32_16x16x32_bf16 v[152:155], a[44:47], v[80:83], v[152:155]
ds_read_b64_tr_b16 a[122:123], v23 offset:30720
v_mfma_f32_16x16x32_bf16 v[128:131], a[48:51], v[88:91], v[128:131]
ds_read_b64_tr_b16 a[76:77], v24 offset:16384
v_mfma_f32_16x16x32_bf16 v[132:135], a[48:51], v[92:95], v[132:135]
ds_read_b64_tr_b16 a[78:79], v24 offset:18432
v_mfma_f32_16x16x32_bf16 v[140:143], a[52:55], v[92:95], v[140:143]
ds_read_b64_tr_b16 a[92:93], v24 offset:20480
v_mfma_f32_16x16x32_bf16 v[136:139], a[52:55], v[88:91], v[136:139]
ds_read_b64_tr_b16 a[94:95], v24 offset:22528
v_mfma_f32_16x16x32_bf16 v[144:147], a[56:59], v[88:91], v[144:147]
ds_read_b64_tr_b16 a[108:109], v24 offset:24576
buffer_store_dwordx4 v[248:251], v45, s[24:27], s45 offen sc1
v_mfma_f32_16x16x32_bf16 v[148:151], a[56:59], v[92:95], v[148:151]
ds_read_b64_tr_b16 a[110:111], v24 offset:26624
v_mfma_f32_16x16x32_bf16 v[156:159], a[60:63], v[92:95], v[156:159]
ds_read_b64_tr_b16 a[124:125], v24 offset:28672
v_mfma_f32_16x16x32_bf16 v[152:155], a[60:63], v[88:91], v[152:155]
ds_read_b64_tr_b16 a[126:127], v24 offset:30720
s_waitcnt vmcnt(27) lgkmcnt(8)
s_barrier
v_mfma_f32_16x16x32_bf16 v[128:131], a[64:67], v[96:99], v[128:131]
ds_read_b64_tr_b16 a[0:1], v17 offset:0
v_mfma_f32_16x16x32_bf16 v[132:135], a[64:67], v[100:103], v[132:135]
ds_read_b64_tr_b16 a[2:3], v17 offset:2048
v_mfma_f32_16x16x32_bf16 v[128:131], a[80:83], v[104:107], v[128:131]
ds_read_b64_tr_b16 a[4:5], v18 offset:0
v_mfma_f32_16x16x32_bf16 v[132:135], a[80:83], v[108:111], v[132:135]
ds_read_b64_tr_b16 a[6:7], v18 offset:2048
v_mfma_f32_16x16x32_bf16 v[128:131], a[96:99], v[112:115], v[128:131]
ds_read_b64_tr_b16 a[8:9], v19 offset:0
v_mfma_f32_16x16x32_bf16 v[132:135], a[96:99], v[116:119], v[132:135]
ds_read_b64_tr_b16 a[10:11], v19 offset:2048
v_mfma_f32_16x16x32_bf16 v[128:131], a[112:115], v[120:123], v[128:131]
ds_read_b64_tr_b16 a[12:13], v20 offset:0
v_mfma_f32_16x16x32_bf16 v[132:135], a[112:115], v[124:127], v[132:135]
ds_read_b64_tr_b16 a[14:15], v20 offset:2048
s_waitcnt lgkmcnt(8)
v_mfma_f32_16x16x32_bf16 v[140:143], a[68:71], v[100:103], v[140:143]
ds_read_b64_tr_b16 a[16:17], v17 offset:4096
buffer_store_dwordx4 v[252:255], v46, s[24:27], s45 offen sc1
v_mfma_f32_16x16x32_bf16 v[136:139], a[68:71], v[96:99], v[136:139]
ds_read_b64_tr_b16 a[18:19], v17 offset:6144
s_add_u32 s45, s45, s50
v_mfma_f32_16x16x32_bf16 v[140:143], a[84:87], v[108:111], v[140:143]
ds_read_b64_tr_b16 a[20:21], v18 offset:4096
v_mfma_f32_16x16x32_bf16 v[136:139], a[84:87], v[104:107], v[136:139]
ds_read_b64_tr_b16 a[22:23], v18 offset:6144
v_mfma_f32_16x16x32_bf16 v[140:143], a[100:103], v[116:119], v[140:143]
ds_read_b64_tr_b16 a[24:25], v19 offset:4096
v_mfma_f32_16x16x32_bf16 v[136:139], a[100:103], v[112:115], v[136:139]
ds_read_b64_tr_b16 a[26:27], v19 offset:6144
v_mfma_f32_16x16x32_bf16 v[140:143], a[116:119], v[124:127], v[140:143]
ds_read_b64_tr_b16 a[28:29], v20 offset:4096
v_mfma_f32_16x16x32_bf16 v[136:139], a[116:119], v[120:123], v[136:139]
ds_read_b64_tr_b16 a[30:31], v20 offset:6144
v_mfma_f32_16x16x32_bf16 v[144:147], a[72:75], v[96:99], v[144:147]
ds_read_b64_tr_b16 a[32:33], v17 offset:8192
v_mfma_f32_16x16x32_bf16 v[148:151], a[72:75], v[100:103], v[148:151]
ds_read_b64_tr_b16 a[34:35], v17 offset:10240
v_mfma_f32_16x16x32_bf16 v[144:147], a[88:91], v[104:107], v[144:147]
ds_read_b64_tr_b16 a[36:37], v18 offset:8192
v_mfma_f32_16x16x32_bf16 v[148:151], a[88:91], v[108:111], v[148:151]
ds_read_b64_tr_b16 a[38:39], v18 offset:10240
v_cvt_pk_bf16_f32 v192, v128, v129
v_mfma_f32_16x16x32_bf16 v[144:147], a[104:107], v[112:115], v[144:147]
ds_read_b64_tr_b16 a[40:41], v19 offset:8192
v_cvt_pk_bf16_f32 v193, v130, v131
v_mfma_f32_16x16x32_bf16 v[148:151], a[104:107], v[116:119], v[148:151]
ds_read_b64_tr_b16 a[42:43], v19 offset:10240
v_cvt_pk_bf16_f32 v194, v136, v137
v_mfma_f32_16x16x32_bf16 v[144:147], a[120:123], v[120:123], v[144:147]
ds_read_b64_tr_b16 a[44:45], v20 offset:8192
v_cvt_pk_bf16_f32 v195, v138, v139
v_mfma_f32_16x16x32_bf16 v[148:151], a[120:123], v[124:127], v[148:151]
ds_read_b64_tr_b16 a[46:47], v20 offset:10240
buffer_store_dwordx4 v[192:195], v45, s[24:27], s45 offen sc1
v_mfma_f32_16x16x32_bf16 v[156:159], a[76:79], v[100:103], v[156:159]
ds_read_b64_tr_b16 a[48:49], v17 offset:12288
v_cvt_pk_bf16_f32 v196, v132, v133
v_mfma_f32_16x16x32_bf16 v[152:155], a[76:79], v[96:99], v[152:155]
ds_read_b64_tr_b16 a[50:51], v17 offset:14336
v_cvt_pk_bf16_f32 v197, v134, v135
v_mfma_f32_16x16x32_bf16 v[156:159], a[92:95], v[108:111], v[156:159]
ds_read_b64_tr_b16 a[52:53], v18 offset:12288
v_cvt_pk_bf16_f32 v198, v140, v141
v_mfma_f32_16x16x32_bf16 v[152:155], a[92:95], v[104:107], v[152:155]
ds_read_b64_tr_b16 a[54:55], v18 offset:14336
v_cvt_pk_bf16_f32 v199, v142, v143
v_mfma_f32_16x16x32_bf16 v[156:159], a[108:111], v[116:119], v[156:159]
ds_read_b64_tr_b16 a[56:57], v19 offset:12288
v_mfma_f32_16x16x32_bf16 v[152:155], a[108:111], v[112:115], v[152:155]
ds_read_b64_tr_b16 a[58:59], v19 offset:14336
v_mfma_f32_16x16x32_bf16 v[156:159], a[124:127], v[124:127], v[156:159]
ds_read_b64_tr_b16 a[60:61], v20 offset:12288
v_mfma_f32_16x16x32_bf16 v[152:155], a[124:127], v[120:123], v[152:155]
ds_read_b64_tr_b16 a[62:63], v20 offset:14336
s_waitcnt vmcnt(25) lgkmcnt(8)
s_barrier
v_mfma_f32_16x16x32_bf16 v[160:163], a[0:3], v[64:67], 0
ds_read_b64_tr_b16 a[64:65], v17 offset:49152
v_mfma_f32_16x16x32_bf16 v[164:167], a[0:3], v[68:71], 0
ds_read_b64_tr_b16 a[66:67], v17 offset:51200
v_mfma_f32_16x16x32_bf16 v[172:175], a[4:7], v[68:71], 0
ds_read_b64_tr_b16 a[80:81], v17 offset:53248
buffer_store_dwordx4 v[196:199], v46, s[24:27], s45 offen sc1
v_mfma_f32_16x16x32_bf16 v[168:171], a[4:7], v[64:67], 0
ds_read_b64_tr_b16 a[82:83], v17 offset:55296
s_add_u32 s45, s45, s54
v_mfma_f32_16x16x32_bf16 v[176:179], a[8:11], v[64:67], 0
ds_read_b64_tr_b16 a[96:97], v17 offset:57344
v_cvt_pk_bf16_f32 v200, v144, v145
v_mfma_f32_16x16x32_bf16 v[180:183], a[8:11], v[68:71], 0
ds_read_b64_tr_b16 a[98:99], v17 offset:59392
v_cvt_pk_bf16_f32 v201, v146, v147
v_mfma_f32_16x16x32_bf16 v[188:191], a[12:15], v[68:71], 0
ds_read_b64_tr_b16 a[112:113], v17 offset:61440
v_cvt_pk_bf16_f32 v202, v152, v153
v_mfma_f32_16x16x32_bf16 v[184:187], a[12:15], v[64:67], 0
ds_read_b64_tr_b16 a[114:115], v17 offset:63488
s_waitcnt lgkmcnt(8)
v_mfma_f32_16x16x32_bf16 v[160:163], a[16:19], v[72:75], v[160:163]
ds_read_b64_tr_b16 a[68:69], v18 offset:49152
v_cvt_pk_bf16_f32 v203, v154, v155
v_mfma_f32_16x16x32_bf16 v[164:167], a[16:19], v[76:79], v[164:167]
ds_read_b64_tr_b16 a[70:71], v18 offset:51200
v_cvt_pk_bf16_f32 v204, v148, v149
v_mfma_f32_16x16x32_bf16 v[172:175], a[20:23], v[76:79], v[172:175]
ds_read_b64_tr_b16 a[84:85], v18 offset:53248
v_cvt_pk_bf16_f32 v205, v150, v151
v_mfma_f32_16x16x32_bf16 v[168:171], a[20:23], v[72:75], v[168:171]
ds_read_b64_tr_b16 a[86:87], v18 offset:55296
v_cvt_pk_bf16_f32 v206, v156, v157
v_mfma_f32_16x16x32_bf16 v[176:179], a[24:27], v[72:75], v[176:179]
ds_read_b64_tr_b16 a[100:101], v18 offset:57344
v_cvt_pk_bf16_f32 v207, v158, v159
v_mfma_f32_16x16x32_bf16 v[180:183], a[24:27], v[76:79], v[180:183]
ds_read_b64_tr_b16 a[102:103], v18 offset:59392
buffer_store_dwordx4 v[200:203], v45, s[24:27], s45 offen sc1
v_mfma_f32_16x16x32_bf16 v[188:191], a[28:31], v[76:79], v[188:191]
ds_read_b64_tr_b16 a[116:117], v18 offset:61440
v_mfma_f32_16x16x32_bf16 v[184:187], a[28:31], v[72:75], v[184:187]
ds_read_b64_tr_b16 a[118:119], v18 offset:63488
v_mfma_f32_16x16x32_bf16 v[160:163], a[32:35], v[80:83], v[160:163]
ds_read_b64_tr_b16 a[72:73], v19 offset:49152
v_mfma_f32_16x16x32_bf16 v[164:167], a[32:35], v[84:87], v[164:167]
ds_read_b64_tr_b16 a[74:75], v19 offset:51200
v_mfma_f32_16x16x32_bf16 v[172:175], a[36:39], v[84:87], v[172:175]
ds_read_b64_tr_b16 a[88:89], v19 offset:53248
v_mfma_f32_16x16x32_bf16 v[168:171], a[36:39], v[80:83], v[168:171]
ds_read_b64_tr_b16 a[90:91], v19 offset:55296
v_mfma_f32_16x16x32_bf16 v[176:179], a[40:43], v[80:83], v[176:179]
ds_read_b64_tr_b16 a[104:105], v19 offset:57344
v_mfma_f32_16x16x32_bf16 v[180:183], a[40:43], v[84:87], v[180:183]
ds_read_b64_tr_b16 a[106:107], v19 offset:59392
v_mfma_f32_16x16x32_bf16 v[188:191], a[44:47], v[84:87], v[188:191]
ds_read_b64_tr_b16 a[120:121], v19 offset:61440
v_mfma_f32_16x16x32_bf16 v[184:187], a[44:47], v[80:83], v[184:187]
ds_read_b64_tr_b16 a[122:123], v19 offset:63488
v_mfma_f32_16x16x32_bf16 v[160:163], a[48:51], v[88:91], v[160:163]
ds_read_b64_tr_b16 a[76:77], v20 offset:49152
buffer_store_dwordx4 v[204:207], v46, s[24:27], s45 offen sc1
v_mfma_f32_16x16x32_bf16 v[164:167], a[48:51], v[92:95], v[164:167]
ds_read_b64_tr_b16 a[78:79], v20 offset:51200
s_add_u32 s45, s45, s50
v_mfma_f32_16x16x32_bf16 v[172:175], a[52:55], v[92:95], v[172:175]
ds_read_b64_tr_b16 a[92:93], v20 offset:53248
v_mfma_f32_16x16x32_bf16 v[168:171], a[52:55], v[88:91], v[168:171]
ds_read_b64_tr_b16 a[94:95], v20 offset:55296
v_mfma_f32_16x16x32_bf16 v[176:179], a[56:59], v[88:91], v[176:179]
ds_read_b64_tr_b16 a[108:109], v20 offset:57344
v_mfma_f32_16x16x32_bf16 v[180:183], a[56:59], v[92:95], v[180:183]
ds_read_b64_tr_b16 a[110:111], v20 offset:59392
v_mfma_f32_16x16x32_bf16 v[188:191], a[60:63], v[92:95], v[188:191]
ds_read_b64_tr_b16 a[124:125], v20 offset:61440
v_mfma_f32_16x16x32_bf16 v[184:187], a[60:63], v[88:91], v[184:187]
ds_read_b64_tr_b16 a[126:127], v20 offset:63488
s_waitcnt vmcnt(4) lgkmcnt(8)
s_barrier
buffer_atomic_add v40, v58, s[56:59], s46 offen sc1
s_add_u32 s46, s46, 4
v_mfma_f32_16x16x32_bf16 v[160:163], a[64:67], v[96:99], v[160:163]
ds_read_b64_tr_b16 a[0:1], v13 offset:49152
v_mfma_f32_16x16x32_bf16 v[164:167], a[64:67], v[100:103], v[164:167]
ds_read_b64_tr_b16 a[2:3], v13 offset:51200
v_mfma_f32_16x16x32_bf16 v[160:163], a[80:83], v[104:107], v[160:163]
ds_read_b64_tr_b16 a[4:5], v14 offset:49152
v_mfma_f32_16x16x32_bf16 v[164:167], a[80:83], v[108:111], v[164:167]
ds_read_b64_tr_b16 a[6:7], v14 offset:51200
v_mfma_f32_16x16x32_bf16 v[160:163], a[96:99], v[112:115], v[160:163]
ds_read_b64_tr_b16 a[8:9], v15 offset:49152
v_mfma_f32_16x16x32_bf16 v[164:167], a[96:99], v[116:119], v[164:167]
ds_read_b64_tr_b16 a[10:11], v15 offset:51200
v_mfma_f32_16x16x32_bf16 v[160:163], a[112:115], v[120:123], v[160:163]
ds_read_b64_tr_b16 a[12:13], v16 offset:49152
v_mfma_f32_16x16x32_bf16 v[164:167], a[112:115], v[124:127], v[164:167]
ds_read_b64_tr_b16 a[14:15], v16 offset:51200
s_waitcnt lgkmcnt(8)
v_mfma_f32_16x16x32_bf16 v[172:175], a[68:71], v[100:103], v[172:175]
ds_read_b64_tr_b16 a[16:17], v13 offset:53248
v_mfma_f32_16x16x32_bf16 v[168:171], a[68:71], v[96:99], v[168:171]
ds_read_b64_tr_b16 a[18:19], v13 offset:55296
v_mfma_f32_16x16x32_bf16 v[172:175], a[84:87], v[108:111], v[172:175]
ds_read_b64_tr_b16 a[20:21], v14 offset:53248
v_mfma_f32_16x16x32_bf16 v[168:171], a[84:87], v[104:107], v[168:171]
ds_read_b64_tr_b16 a[22:23], v14 offset:55296
v_mfma_f32_16x16x32_bf16 v[172:175], a[100:103], v[116:119], v[172:175]
ds_read_b64_tr_b16 a[24:25], v15 offset:53248
v_mfma_f32_16x16x32_bf16 v[168:171], a[100:103], v[112:115], v[168:171]
ds_read_b64_tr_b16 a[26:27], v15 offset:55296
v_mfma_f32_16x16x32_bf16 v[172:175], a[116:119], v[124:127], v[172:175]
ds_read_b64_tr_b16 a[28:29], v16 offset:53248
v_mfma_f32_16x16x32_bf16 v[168:171], a[116:119], v[120:123], v[168:171]
ds_read_b64_tr_b16 a[30:31], v16 offset:55296
v_mfma_f32_16x16x32_bf16 v[176:179], a[72:75], v[96:99], v[176:179]
ds_read_b64_tr_b16 a[32:33], v13 offset:57344
v_mfma_f32_16x16x32_bf16 v[180:183], a[72:75], v[100:103], v[180:183]
ds_read_b64_tr_b16 a[34:35], v13 offset:59392
v_mfma_f32_16x16x32_bf16 v[176:179], a[88:91], v[104:107], v[176:179]
ds_read_b64_tr_b16 a[36:37], v14 offset:57344
v_mfma_f32_16x16x32_bf16 v[180:183], a[88:91], v[108:111], v[180:183]
ds_read_b64_tr_b16 a[38:39], v14 offset:59392
v_cvt_pk_bf16_f32 v208, v160, v161
v_mfma_f32_16x16x32_bf16 v[176:179], a[104:107], v[112:115], v[176:179]
ds_read_b64_tr_b16 a[40:41], v15 offset:57344
v_cvt_pk_bf16_f32 v209, v162, v163
v_mfma_f32_16x16x32_bf16 v[180:183], a[104:107], v[116:119], v[180:183]
ds_read_b64_tr_b16 a[42:43], v15 offset:59392
v_cvt_pk_bf16_f32 v210, v168, v169
v_mfma_f32_16x16x32_bf16 v[176:179], a[120:123], v[120:123], v[176:179]
ds_read_b64_tr_b16 a[44:45], v16 offset:57344
v_cvt_pk_bf16_f32 v211, v170, v171
v_mfma_f32_16x16x32_bf16 v[180:183], a[120:123], v[124:127], v[180:183]
ds_read_b64_tr_b16 a[46:47], v16 offset:59392
buffer_store_dwordx4 v[208:211], v45, s[24:27], s45 offen sc1
v_mfma_f32_16x16x32_bf16 v[188:191], a[76:79], v[100:103], v[188:191]
ds_read_b64_tr_b16 a[48:49], v13 offset:61440
v_cvt_pk_bf16_f32 v212, v164, v165
v_mfma_f32_16x16x32_bf16 v[184:187], a[76:79], v[96:99], v[184:187]
ds_read_b64_tr_b16 a[50:51], v13 offset:63488
v_cvt_pk_bf16_f32 v213, v166, v167
v_mfma_f32_16x16x32_bf16 v[188:191], a[92:95], v[108:111], v[188:191]
ds_read_b64_tr_b16 a[52:53], v14 offset:61440
v_cvt_pk_bf16_f32 v214, v172, v173
v_mfma_f32_16x16x32_bf16 v[184:187], a[92:95], v[104:107], v[184:187]
ds_read_b64_tr_b16 a[54:55], v14 offset:63488
v_cvt_pk_bf16_f32 v215, v174, v175
v_mfma_f32_16x16x32_bf16 v[188:191], a[108:111], v[116:119], v[188:191]
ds_read_b64_tr_b16 a[56:57], v15 offset:61440
v_mfma_f32_16x16x32_bf16 v[184:187], a[108:111], v[112:115], v[184:187]
ds_read_b64_tr_b16 a[58:59], v15 offset:63488
v_mfma_f32_16x16x32_bf16 v[188:191], a[124:127], v[124:127], v[188:191]
ds_read_b64_tr_b16 a[60:61], v16 offset:61440
v_mfma_f32_16x16x32_bf16 v[184:187], a[124:127], v[120:123], v[184:187]
ds_read_b64_tr_b16 a[62:63], v16 offset:63488
s_waitcnt vmcnt(6) lgkmcnt(8)
s_barrier
v_mfma_f32_16x16x32_bf16 v[128:131], a[0:3], v[64:67], 0
ds_read_b64_tr_b16 a[64:65], v13 offset:32768
v_mfma_f32_16x16x32_bf16 v[132:135], a[0:3], v[68:71], 0
ds_read_b64_tr_b16 a[66:67], v13 offset:34816
v_mfma_f32_16x16x32_bf16 v[140:143], a[4:7], v[68:71], 0
ds_read_b64_tr_b16 a[80:81], v13 offset:36864
buffer_store_dwordx4 v[212:215], v46, s[24:27], s45 offen sc1
v_mfma_f32_16x16x32_bf16 v[136:139], a[4:7], v[64:67], 0
ds_read_b64_tr_b16 a[82:83], v13 offset:38912
s_add_u32 s45, s45, s54
v_mfma_f32_16x16x32_bf16 v[144:147], a[8:11], v[64:67], 0
ds_read_b64_tr_b16 a[96:97], v13 offset:40960
v_cvt_pk_bf16_f32 v216, v176, v177
v_mfma_f32_16x16x32_bf16 v[148:151], a[8:11], v[68:71], 0
ds_read_b64_tr_b16 a[98:99], v13 offset:43008
v_cvt_pk_bf16_f32 v217, v178, v179
v_mfma_f32_16x16x32_bf16 v[156:159], a[12:15], v[68:71], 0
ds_read_b64_tr_b16 a[112:113], v13 offset:45056
v_cvt_pk_bf16_f32 v218, v184, v185
v_mfma_f32_16x16x32_bf16 v[152:155], a[12:15], v[64:67], 0
ds_read_b64_tr_b16 a[114:115], v13 offset:47104
s_waitcnt lgkmcnt(8)
v_mfma_f32_16x16x32_bf16 v[128:131], a[16:19], v[72:75], v[128:131]
ds_read_b64_tr_b16 a[68:69], v14 offset:32768
v_cvt_pk_bf16_f32 v219, v186, v187
v_mfma_f32_16x16x32_bf16 v[132:135], a[16:19], v[76:79], v[132:135]
ds_read_b64_tr_b16 a[70:71], v14 offset:34816
v_cvt_pk_bf16_f32 v220, v180, v181
v_mfma_f32_16x16x32_bf16 v[140:143], a[20:23], v[76:79], v[140:143]
ds_read_b64_tr_b16 a[84:85], v14 offset:36864
v_cvt_pk_bf16_f32 v221, v182, v183
v_mfma_f32_16x16x32_bf16 v[136:139], a[20:23], v[72:75], v[136:139]
ds_read_b64_tr_b16 a[86:87], v14 offset:38912
v_cvt_pk_bf16_f32 v222, v188, v189
v_mfma_f32_16x16x32_bf16 v[144:147], a[24:27], v[72:75], v[144:147]
ds_read_b64_tr_b16 a[100:101], v14 offset:40960
v_cvt_pk_bf16_f32 v223, v190, v191
v_mfma_f32_16x16x32_bf16 v[148:151], a[24:27], v[76:79], v[148:151]
ds_read_b64_tr_b16 a[102:103], v14 offset:43008
buffer_store_dwordx4 v[216:219], v45, s[24:27], s45 offen sc1
v_mfma_f32_16x16x32_bf16 v[156:159], a[28:31], v[76:79], v[156:159]
ds_read_b64_tr_b16 a[116:117], v14 offset:45056
v_mfma_f32_16x16x32_bf16 v[152:155], a[28:31], v[72:75], v[152:155]
ds_read_b64_tr_b16 a[118:119], v14 offset:47104
v_mfma_f32_16x16x32_bf16 v[128:131], a[32:35], v[80:83], v[128:131]
ds_read_b64_tr_b16 a[72:73], v15 offset:32768
v_mfma_f32_16x16x32_bf16 v[132:135], a[32:35], v[84:87], v[132:135]
ds_read_b64_tr_b16 a[74:75], v15 offset:34816
v_mfma_f32_16x16x32_bf16 v[140:143], a[36:39], v[84:87], v[140:143]
ds_read_b64_tr_b16 a[88:89], v15 offset:36864
v_mfma_f32_16x16x32_bf16 v[136:139], a[36:39], v[80:83], v[136:139]
ds_read_b64_tr_b16 a[90:91], v15 offset:38912
v_mfma_f32_16x16x32_bf16 v[144:147], a[40:43], v[80:83], v[144:147]
ds_read_b64_tr_b16 a[104:105], v15 offset:40960
v_mfma_f32_16x16x32_bf16 v[148:151], a[40:43], v[84:87], v[148:151]
ds_read_b64_tr_b16 a[106:107], v15 offset:43008
v_mfma_f32_16x16x32_bf16 v[156:159], a[44:47], v[84:87], v[156:159]
ds_read_b64_tr_b16 a[120:121], v15 offset:45056
v_mfma_f32_16x16x32_bf16 v[152:155], a[44:47], v[80:83], v[152:155]
ds_read_b64_tr_b16 a[122:123], v15 offset:47104
v_mfma_f32_16x16x32_bf16 v[128:131], a[48:51], v[88:91], v[128:131]
ds_read_b64_tr_b16 a[76:77], v16 offset:32768
buffer_store_dwordx4 v[220:223], v46, s[24:27], s45 offen sc1
v_mfma_f32_16x16x32_bf16 v[132:135], a[48:51], v[92:95], v[132:135]
ds_read_b64_tr_b16 a[78:79], v16 offset:34816
s_add_u32 s45, s45, s50
v_mfma_f32_16x16x32_bf16 v[140:143], a[52:55], v[92:95], v[140:143]
ds_read_b64_tr_b16 a[92:93], v16 offset:36864
v_mfma_f32_16x16x32_bf16 v[136:139], a[52:55], v[88:91], v[136:139]
ds_read_b64_tr_b16 a[94:95], v16 offset:38912
v_mfma_f32_16x16x32_bf16 v[144:147], a[56:59], v[88:91], v[144:147]
ds_read_b64_tr_b16 a[108:109], v16 offset:40960
v_mfma_f32_16x16x32_bf16 v[148:151], a[56:59], v[92:95], v[148:151]
ds_read_b64_tr_b16 a[110:111], v16 offset:43008
v_mfma_f32_16x16x32_bf16 v[156:159], a[60:63], v[92:95], v[156:159]
ds_read_b64_tr_b16 a[124:125], v16 offset:45056
v_mfma_f32_16x16x32_bf16 v[152:155], a[60:63], v[88:91], v[152:155]
ds_read_b64_tr_b16 a[126:127], v16 offset:47104
s_waitcnt lgkmcnt(8)
v_mfma_f32_16x16x32_bf16 v[128:131], a[64:67], v[96:99], v[128:131]
v_mfma_f32_16x16x32_bf16 v[132:135], a[64:67], v[100:103], v[132:135]
v_mfma_f32_16x16x32_bf16 v[128:131], a[80:83], v[104:107], v[128:131]
v_mfma_f32_16x16x32_bf16 v[132:135], a[80:83], v[108:111], v[132:135]
v_mfma_f32_16x16x32_bf16 v[128:131], a[96:99], v[112:115], v[128:131]
v_mfma_f32_16x16x32_bf16 v[132:135], a[96:99], v[116:119], v[132:135]
v_mfma_f32_16x16x32_bf16 v[128:131], a[112:115], v[120:123], v[128:131]
v_mfma_f32_16x16x32_bf16 v[132:135], a[112:115], v[124:127], v[132:135]
s_waitcnt lgkmcnt(0)
v_mfma_f32_16x16x32_bf16 v[140:143], a[68:71], v[100:103], v[140:143]
v_mfma_f32_16x16x32_bf16 v[136:139], a[68:71], v[96:99], v[136:139]
v_mfma_f32_16x16x32_bf16 v[140:143], a[84:87], v[108:111], v[140:143]
v_mfma_f32_16x16x32_bf16 v[136:139], a[84:87], v[104:107], v[136:139]
v_mfma_f32_16x16x32_bf16 v[140:143], a[100:103], v[116:119], v[140:143]
v_mfma_f32_16x16x32_bf16 v[136:139], a[100:103], v[112:115], v[136:139]
v_mfma_f32_16x16x32_bf16 v[140:143], a[116:119], v[124:127], v[140:143]
v_mfma_f32_16x16x32_bf16 v[136:139], a[116:119], v[120:123], v[136:139]
v_mfma_f32_16x16x32_bf16 v[144:147], a[72:75], v[96:99], v[144:147]
v_mfma_f32_16x16x32_bf16 v[148:151], a[72:75], v[100:103], v[148:151]
v_mfma_f32_16x16x32_bf16 v[144:147], a[88:91], v[104:107], v[144:147]
v_mfma_f32_16x16x32_bf16 v[148:151], a[88:91], v[108:111], v[148:151]
v_cvt_pk_bf16_f32 v224, v128, v129
v_cvt_pk_bf16_f32 v225, v130, v131
v_mfma_f32_16x16x32_bf16 v[144:147], a[104:107], v[112:115], v[144:147]
s_nop 0
v_cvt_pk_bf16_f32 v226, v136, v137
v_cvt_pk_bf16_f32 v227, v138, v139
v_mfma_f32_16x16x32_bf16 v[148:151], a[104:107], v[116:119], v[148:151]
buffer_store_dwordx4 v[224:227], v45, s[24:27], s45 offen sc1
v_cvt_pk_bf16_f32 v228, v132, v133
v_mfma_f32_16x16x32_bf16 v[144:147], a[120:123], v[120:123], v[144:147]
v_cvt_pk_bf16_f32 v229, v134, v135
v_cvt_pk_bf16_f32 v230, v140, v141
v_mfma_f32_16x16x32_bf16 v[148:151], a[120:123], v[124:127], v[148:151]
v_cvt_pk_bf16_f32 v231, v142, v143
v_mfma_f32_16x16x32_bf16 v[156:159], a[76:79], v[100:103], v[156:159]
v_mfma_f32_16x16x32_bf16 v[152:155], a[76:79], v[96:99], v[152:155]
v_mfma_f32_16x16x32_bf16 v[156:159], a[92:95], v[108:111], v[156:159]
v_mfma_f32_16x16x32_bf16 v[152:155], a[92:95], v[104:107], v[152:155]
v_mfma_f32_16x16x32_bf16 v[156:159], a[108:111], v[116:119], v[156:159]
v_mfma_f32_16x16x32_bf16 v[152:155], a[108:111], v[112:115], v[152:155]
v_mfma_f32_16x16x32_bf16 v[156:159], a[124:127], v[124:127], v[156:159]
v_mfma_f32_16x16x32_bf16 v[152:155], a[124:127], v[120:123], v[152:155]
buffer_store_dwordx4 v[228:231], v46, s[24:27], s45 offen sc1
s_add_u32 s45, s45, s54
v_cvt_pk_bf16_f32 v232, v144, v145
v_cvt_pk_bf16_f32 v233, v146, v147
s_nop 3
v_cvt_pk_bf16_f32 v234, v152, v153
v_cvt_pk_bf16_f32 v235, v154, v155
buffer_store_dwordx4 v[232:235], v45, s[24:27], s45 offen sc1
v_cvt_pk_bf16_f32 v236, v148, v149
v_cvt_pk_bf16_f32 v237, v150, v151
v_cvt_pk_bf16_f32 v238, v156, v157
L_pad11:
s_cbranch_execz L_hr2
v_cvt_pk_bf16_f32 v239, v158, v159
buffer_store_dwordx4 v[236:239], v46, s[24:27], s45 offen sc1
s_waitcnt vmcnt(0)
s_barrier
buffer_atomic_add v40, v58, s[56:59], s46 offen sc1
s_add_u32 s46, s46, 4
s_cmp_lg_u32 s32, 0
s_cbranch_scc1 L_nop0
buffer_load_dword v57, v60, s[56:59], 0 offen sc1
L_nop0:
s_add_u32 s3, s93, 128
s_cmp_eq_u32 s3, 896
s_cselect_b32 s3, 0, s3
v_mov_b32 v48, s93
v_mov_b32 v49, s3
v_cndmask_b32 v48, v48, v49, s[96:97]
v_add_u32 v50, v56, v48
s_add_u32 s93, s3, 128
s_cmp_eq_u32 s93, 896
s_cselect_b32 s93, 0, s93
s_add_u32 s3, s93, 128
s_cmp_eq_u32 s3, 896
s_cselect_b32 s3, 0, s3
v_mov_b32 v48, s93
v_mov_b32 v49, s3
v_cndmask_b32 v48, v48, v49, s[96:97]
v_add_u32 v51, v56, v48
s_add_u32 s93, s3, 128
s_cmp_eq_u32 s93, 896
s_cselect_b32 s93, 0, s93
s_add_u32 s3, s93, 128
s_cmp_eq_u32 s3, 896
s_cselect_b32 s3, 0, s3
v_mov_b32 v48, s93
v_mov_b32 v49, s3
v_cndmask_b32 v48, v48, v49, s[96:97]
v_add_u32 v52, v56, v48
s_add_u32 s93, s3, 128
s_cmp_eq_u32 s93, 896
s_cselect_b32 s93, 0, s93
s_add_u32 s3, s93, 128
s_cmp_eq_u32 s3, 896
s_cselect_b32 s3, 0, s3
v_mov_b32 v48, s93
v_mov_b32 v49, 0x7fff0000
v_cndmask_b32 v48, v48, v49, s[96:97]
v_add_u32 v53, v56, v48
s_waitcnt vmcnt(0)
s_cmp_lg_u32 s32, 0
s_cbranch_scc1 L_pw0
L_pb0:
v_cmp_le_u32 vcc, 16, v57
s_bitcmp0_b32 vcc_lo, 0
s_cbranch_scc1 L_poll0
L_pw0:
s_barrier
s_mov_b32 s92, 0
buffer_load_dwordx4 a[128:131], v59, s[64:67], s92 offen sc1
buffer_load_dwordx4 a[132:135], v59, s[64:67], s92 offen offset:1024 sc1
buffer_load_dwordx4 a[136:139], v59, s[64:67], s92 offen offset:2048 sc1
buffer_load_dwordx4 a[140:143], v59, s[64:67], s92 offen offset:3072 sc1
s_mov_b32 s92, 32768
buffer_load_dwordx4 a[144:147], v59, s[64:67], s92 offen sc1
buffer_load_dwordx4 a[148:151], v59, s[64:67], s92 offen offset:1024 sc1
buffer_load_dwordx4 a[152:155], v59, s[64:67], s92 offen offset:2048 sc1
buffer_load_dwordx4 a[156:159], v59, s[64:67], s92 offen offset:3072 sc1
s_mov_b32 s92, 65536
buffer_load_dwordx4 a[160:163], v59, s[64:67], s92 offen sc1
buffer_load_dwordx4 a[164:167], v59, s[64:67], s92 offen offset:1024 sc1
buffer_load_dwordx4 a[168:171], v59, s[64:67], s92 offen offset:2048 sc1
buffer_load_dwordx4 a[172:175], v59, s[64:67], s92 offen offset:3072 sc1
s_mov_b32 s92, 98304
buffer_load_dwordx4 a[176:179], v59, s[64:67], s92 offen sc1
buffer_load_dwordx4 a[180:183], v59, s[64:67], s92 offen offset:1024 sc1
buffer_load_dwordx4 a[184:187], v59, s[64:67], s92 offen offset:2048 sc1
buffer_load_dwordx4 a[188:191], v59, s[64:67], s92 offen offset:3072 sc1
s_cmp_lg_u32 s32, 0
s_cbranch_scc1 L_pw1
L_pb1:
v_cmp_le_u32 vcc, 16, v57
s_bitcmp0_b32 vcc_lo, 1
s_cbranch_scc1 L_poll1
L_pw1:
s_barrier
s_mov_b32 s92, 131072
buffer_load_dwordx4 a[192:195], v59, s[64:67], s92 offen sc1
buffer_load_dwordx4 a[196:199], v59, s[64:67], s92 offen offset:1024 sc1
buffer_load_dwordx4 a[200:203], v59, s[64:67], s92 offen offset:2048 sc1
buffer_load_dwordx4 a[204:207], v59, s[64:67], s92 offen offset:3072 sc1
s_mov_b32 s92, 163840
buffer_load_dwordx4 a[208:211], v59, s[64:67], s92 offen sc1
buffer_load_dwordx4 a[212:215], v59, s[64:67], s92 offen offset:1024 sc1
buffer_load_dwordx4 a[216:219], v59, s[64:67], s92 offen offset:2048 sc1
buffer_load_dwordx4 a[220:223], v59, s[64:67], s92 offen offset:3072 sc1
s_mov_b32 s92, 196608
buffer_load_dwordx4 a[224:227], v59, s[64:67], s92 offen sc1
buffer_load_dwordx4 a[228:231], v59, s[64:67], s92 offen offset:1024 sc1
buffer_load_dwordx4 a[232:235], v59, s[64:67], s92 offen offset:2048 sc1
buffer_load_dwordx4 a[236:239], v59, s[64:67], s92 offen offset:3072 sc1
s_waitcnt vmcnt(27)
v_mfma_f32_16x16x32_bf16 v[176:179], a[244:247], a[128:131], 0
s_waitcnt vmcnt(26)
v_mfma_f32_16x16x32_bf16 v[176:179], a[244:247], a[132:135], v[176:179]
s_waitcnt vmcnt(25)
v_mfma_f32_16x16x32_bf16 v[176:179], a[244:247], a[136:139], v[176:179]
s_waitcnt vmcnt(24)
v_mfma_f32_16x16x32_bf16 v[176:179], a[244:247], a[140:143], v[176:179]
s_waitcnt vmcnt(23)
v_mfma_f32_16x16x32_bf16 v[176:179], a[248:251], a[144:147], v[176:179]
s_waitcnt vmcnt(22)
v_mfma_f32_16x16x32_bf16 v[176:179], a[248:251], a[148:151], v[176:179]
s_waitcnt vmcnt(21)
v_mfma_f32_16x16x32_bf16 v[176:179], a[248:251], a[152:155], v[176:179]
s_waitcnt vmcnt(20)
v_mfma_f32_16x16x32_bf16 v[176:179], a[248:251], a[156:159], v[176:179]
s_nop 7
v_cvt_pk_bf16_f32 v176, v176, v177
v_cvt_pk_bf16_f32 v177, v178, v179
buffer_store_dwordx2 v[176:177], v50, s[68:71], s94 offen
s_waitcnt vmcnt(20)
v_mfma_f32_16x16x32_bf16 v[180:183], a[244:247], a[160:163], 0
s_waitcnt vmcnt(19)
v_mfma_f32_16x16x32_bf16 v[180:183], a[244:247], a[164:167], v[180:183]
s_waitcnt vmcnt(18)
v_mfma_f32_16x16x32_bf16 v[180:183], a[244:247], a[168:171], v[180:183]
s_waitcnt vmcnt(17)
v_mfma_f32_16x16x32_bf16 v[180:183], a[244:247], a[172:175], v[180:183]
s_waitcnt vmcnt(16)
v_mfma_f32_16x16x32_bf16 v[180:183], a[248:251], a[176:179], v[180:183]
s_waitcnt vmcnt(15)
v_mfma_f32_16x16x32_bf16 v[180:183], a[248:251], a[180:183], v[180:183]
s_waitcnt vmcnt(14)
v_mfma_f32_16x16x32_bf16 v[180:183], a[248:251], a[184:187], v[180:183]
s_waitcnt vmcnt(13)
v_mfma_f32_16x16x32_bf16 v[180:183], a[248:251], a[188:191], v[180:183]
s_nop 7
v_cvt_pk_bf16_f32 v180, v180, v181
v_cvt_pk_bf16_f32 v181, v182, v183
buffer_store_dwordx2 v[180:181], v51, s[68:71], s94 offen
s_waitcnt vmcnt(13)
v_mfma_f32_16x16x32_bf16 v[184:187], a[244:247], a[192:195], 0
s_waitcnt vmcnt(12)
v_mfma_f32_16x16x32_bf16 v[184:187], a[244:247], a[196:199], v[184:187]
s_waitcnt vmcnt(11)
v_mfma_f32_16x16x32_bf16 v[184:187], a[244:247], a[200:203], v[184:187]
s_waitcnt vmcnt(10)
v_mfma_f32_16x16x32_bf16 v[184:187], a[244:247], a[204:207], v[184:187]
s_waitcnt vmcnt(9)
v_mfma_f32_16x16x32_bf16 v[184:187], a[248:251], a[208:211], v[184:187]
s_waitcnt vmcnt(8)
v_mfma_f32_16x16x32_bf16 v[184:187], a[248:251], a[212:215], v[184:187]
s_waitcnt vmcnt(7)
v_mfma_f32_16x16x32_bf16 v[184:187], a[248:251], a[216:219], v[184:187]
s_waitcnt vmcnt(6)
v_mfma_f32_16x16x32_bf16 v[184:187], a[248:251], a[220:223], v[184:187]
s_nop 7
v_cvt_pk_bf16_f32 v184, v184, v185
v_cvt_pk_bf16_f32 v185, v186, v187
buffer_store_dwordx2 v[184:185], v52, s[68:71], s94 offen
s_waitcnt vmcnt(6)
v_mfma_f32_16x16x32_bf16 v[188:191], a[244:247], a[224:227], 0
s_waitcnt vmcnt(5)
v_mfma_f32_16x16x32_bf16 v[188:191], a[244:247], a[228:231], v[188:191]
s_waitcnt vmcnt(4)
v_mfma_f32_16x16x32_bf16 v[188:191], a[244:247], a[232:235], v[188:191]
s_waitcnt vmcnt(3)
v_mfma_f32_16x16x32_bf16 v[188:191], a[244:247], a[236:239], v[188:191]
s_nop 7
v_cvt_pk_bf16_f32 v188, v188, v189
v_cvt_pk_bf16_f32 v189, v190, v191
buffer_store_dwordx2 v[188:189], v53, s[68:71], s94 offen
L_end:
s_endpgm
L_poll0:
s_sleep 1
buffer_load_dword v57, v60, s[56:59], 0 offen sc1
s_waitcnt vmcnt(0)
s_branch L_pb0
L_poll1:
s_sleep 1
buffer_load_dword v57, v60, s[56:59], 0 offen sc1
s_waitcnt vmcnt(0)
s_branch L_pb1
L_chk:
s_sleep 4
buffer_load_dword v0, v61, s[60:63], 0 offen sc1
s_waitcnt vmcnt(0)
v_readfirstlane_b32 s3, v0
s_cmp_lt_u32 s3, 0x100000
s_cbranch_scc1 L_chk
s_branch L_chkb
L_r1_1:
s_call_b64 s[52:53], L_rare1_1
s_branch L_b1_1
L_r2_1:
s_call_b64 s[52:53], L_rare2
s_branch L_b2_1
L_r1_2:
s_call_b64 s[52:53], L_rare1_0
s_branch L_b1_2
L_r2_2:
s_call_b64 s[52:53], L_rare2
s_branch L_b2_2
L_r1_3:
s_call_b64 s[52:53], L_rare1_1
s_branch L_b1_3
L_r2_3:
s_call_b64 s[52:53], L_rare2
s_branch L_b2_3
L_r1_4:
s_call_b64 s[52:53], L_rare1_0
s_branch L_b1_4
L_r2_4:
s_call_b64 s[52:53], L_rare2
s_branch L_b2_4
L_r1_5:
s_call_b64 s[52:53], L_rare1_1
s_branch L_b1_5
L_r2_5:
s_call_b64 s[52:53], L_rare2
s_branch L_b2_5
L_r1_6:
s_call_b64 s[52:53], L_rare1_0
s_branch L_b1_6
L_r2_6:
s_call_b64 s[52:53], L_rare2
s_branch L_b2_6
L_r1_7:
s_call_b64 s[52:53], L_rare1_1
s_branch L_b1_7
L_r2_7:
s_call_b64 s[52:53], L_rare2
s_branch L_b2_7
L_r1_8:
s_call_b64 s[52:53], L_rare1_0
s_branch L_b1_8
L_r2_8:
s_call_b64 s[52:53], L_rare2
s_branch L_b2_8
L_r1_9:
s_call_b64 s[52:53], L_rare1_1
s_branch L_b1_9
L_r2_9:
s_call_b64 s[52:53], L_rare2
s_branch L_b2_9
L_r1_10:
s_call_b64 s[52:53], L_rare1_0
s_branch L_b1_10
L_r2_10:
s_call_b64 s[52:53], L_rare2
s_branch L_b2_10
L_r1_11:
s_call_b64 s[52:53], L_rare1_1
s_branch L_b1_11
L_r2_11:
s_call_b64 s[52:53], L_rare2
s_branch L_b2_11
L_r1_12:
s_call_b64 s[52:53], L_rare1_0
s_branch L_b1_12
L_r2_12:
s_call_b64 s[52:53], L_rare2
s_branch L_b2_12
L_r1_13:
s_call_b64 s[52:53], L_rare1_1
s_branch L_b1_13
L_r2_13:
s_call_b64 s[52:53], L_rare2
s_branch L_b2_13
L_r1_14:
s_call_b64 s[52:53], L_rare1_0
s_branch L_b1_14
L_r2_14:
s_call_b64 s[52:53], L_rare2
s_branch L_b2_14
L_r1_15:
s_call_b64 s[52:53], L_rare1_1
s_branch L_b1_15
L_r2_15:
s_call_b64 s[52:53], L_rare2
s_branch L_b2_15
L_rare1:
L_rare1_0:
s_nop 7
v_max3_f32 v47, v64, v65, v66
v_max3_f32 v47, v47, v67, v68
v_max3_f32 v47, v47, v69, v70
v_max_f32 v47, v47, v71
v_mov_b32 v34, v47
s_nop 1
v_permlane16_swap_b32 v47, v34
v_max_f32 v47, v47, v34
v_mov_b32 v34, v47
s_nop 1
v_permlane32_swap_b32 v47, v34
v_max_f32 v47, v47, v34
v_max_f32 v47, 0, v47
v_exp_f32 v35, -v47
v_sub_f32 v64, v64, v47
v_sub_f32 v65, v65, v47
v_sub_f32 v66, v66, v47
v_sub_f32 v67, v67, v47
v_sub_f32 v68, v68, v47
v_sub_f32 v69, v69, v47
v_sub_f32 v70, v70, v47
v_sub_f32 v71, v71, v47
v_mul_f32 v47, s49, v47
v_sub_f32 v48, v48, v47
v_sub_f32 v49, v49, v47
v_sub_f32 v50, v50, v47
v_sub_f32 v51, v51, v47
v_max3_f32 v33, v72, v73, v74
v_max3_f32 v33, v33, v75, v76
v_max3_f32 v33, v33, v77, v78
v_max_f32 v33, v33, v79
v_mov_b32 v34, v33
s_nop 1
v_permlane16_swap_b32 v33, v34
v_max_f32 v33, v33, v34
v_mov_b32 v34, v33
s_nop 1
v_permlane32_swap_b32 v33, v34
v_max_f32 v33, v33, v34
v_max_f32 v33, 0, v33
v_exp_f32 v36, -v33
v_sub_f32 v72, v72, v33
v_sub_f32 v73, v73, v33
v_sub_f32 v74, v74, v33
v_sub_f32 v75, v75, v33
v_sub_f32 v76, v76, v33
v_sub_f32 v77, v77, v33
v_sub_f32 v78, v78, v33
v_sub_f32 v79, v79, v33
v_mul_f32 v33, s49, v33
v_sub_f32 v52, v52, v33
v_sub_f32 v53, v53, v33
v_sub_f32 v54, v54, v33
v_sub_f32 v55, v55, v33
s_mov_b32 s51, 1
s_nop 1
s_setpc_b64 s[52:53]
L_rare1_1:
s_nop 7
v_max3_f32 v47, v80, v81, v82
v_max3_f32 v47, v47, v83, v84
v_max3_f32 v47, v47, v85, v86
v_max_f32 v47, v47, v87
v_mov_b32 v34, v47
s_nop 1
v_permlane16_swap_b32 v47, v34
v_max_f32 v47, v47, v34
v_mov_b32 v34, v47
s_nop 1
v_permlane32_swap_b32 v47, v34
v_max_f32 v47, v47, v34
v_max_f32 v47, 0, v47
v_exp_f32 v35, -v47
v_sub_f32 v80, v80, v47
v_sub_f32 v81, v81, v47
v_sub_f32 v82, v82, v47
v_sub_f32 v83, v83, v47
v_sub_f32 v84, v84, v47
v_sub_f32 v85, v85, v47
v_sub_f32 v86, v86, v47
v_sub_f32 v87, v87, v47
v_mul_f32 v47, s49, v47
v_sub_f32 v48, v48, v47
v_sub_f32 v49, v49, v47
v_sub_f32 v50, v50, v47
v_sub_f32 v51, v51, v47
v_max3_f32 v33, v88, v89, v90
v_max3_f32 v33, v33, v91, v92
v_max3_f32 v33, v33, v93, v94
v_max_f32 v33, v33, v95
v_mov_b32 v34, v33
s_nop 1
v_permlane16_swap_b32 v33, v34
v_max_f32 v33, v33, v34
v_mov_b32 v34, v33
s_nop 1
v_permlane32_swap_b32 v33, v34
v_max_f32 v33, v33, v34
v_max_f32 v33, 0, v33
v_exp_f32 v36, -v33
v_sub_f32 v88, v88, v33
v_sub_f32 v89, v89, v33
v_sub_f32 v90, v90, v33
v_sub_f32 v91, v91, v33
v_sub_f32 v92, v92, v33
v_sub_f32 v93, v93, v33
v_sub_f32 v94, v94, v33
v_sub_f32 v95, v95, v33
v_mul_f32 v33, s49, v33
v_sub_f32 v52, v52, v33
v_sub_f32 v53, v53, v33
v_sub_f32 v54, v54, v33
v_sub_f32 v55, v55, v33
s_mov_b32 s51, 1
s_nop 1
s_setpc_b64 s[52:53]
L_rare2:
s_nop 15
v_mul_f32 v128, v128, v35
v_mul_f32 v129, v129, v35
v_mul_f32 v130, v130, v35
v_mul_f32 v131, v131, v35
v_mul_f32 v132, v132, v36
v_mul_f32 v133, v133, v36
v_mul_f32 v134, v134, v36
v_mul_f32 v135, v135, v36
v_mul_f32 v136, v136, v35
v_mul_f32 v137, v137, v35
v_mul_f32 v138, v138, v35
v_mul_f32 v139, v139, v35
v_mul_f32 v140, v140, v36
v_mul_f32 v141, v141, v36
v_mul_f32 v142, v142, v36
v_mul_f32 v143, v143, v36
v_mul_f32 v144, v144, v35
v_mul_f32 v145, v145, v35
v_mul_f32 v146, v146, v35
v_mul_f32 v147, v147, v35
v_mul_f32 v148, v148, v36
v_mul_f32 v149, v149, v36
v_mul_f32 v150, v150, v36
v_mul_f32 v151, v151, v36
v_mul_f32 v152, v152, v35
v_mul_f32 v153, v153, v35
v_mul_f32 v154, v154, v35
v_mul_f32 v155, v155, v35
v_mul_f32 v156, v156, v36
v_mul_f32 v157, v157, v36
v_mul_f32 v158, v158, v36
v_mul_f32 v159, v159, v36
v_mul_f32 v160, v160, v35
v_mul_f32 v161, v161, v35
v_mul_f32 v162, v162, v35
v_mul_f32 v163, v163, v35
v_mul_f32 v164, v164, v36
v_mul_f32 v165, v165, v36
v_mul_f32 v166, v166, v36
v_mul_f32 v167, v167, v36
v_mul_f32 v168, v168, v35
v_mul_f32 v169, v169, v35
v_mul_f32 v170, v170, v35
v_mul_f32 v171, v171, v35
v_mul_f32 v172, v172, v36
v_mul_f32 v173, v173, v36
v_mul_f32 v174, v174, v36
v_mul_f32 v175, v175, v36
v_mul_f32 v176, v176, v35
v_mul_f32 v177, v177, v35
v_mul_f32 v178, v178, v35
v_mul_f32 v179, v179, v35
v_mul_f32 v180, v180, v36
v_mul_f32 v181, v181, v36
v_mul_f32 v182, v182, v36
v_mul_f32 v183, v183, v36
v_mul_f32 v184, v184, v35
v_mul_f32 v185, v185, v35
v_mul_f32 v186, v186, v35
v_mul_f32 v187, v187, v35
v_mul_f32 v188, v188, v36
v_mul_f32 v189, v189, v36
v_mul_f32 v190, v190, v36
v_mul_f32 v191, v191, v36
v_mul_f32 v192, v192, v35
v_mul_f32 v193, v193, v35
v_mul_f32 v194, v194, v35
v_mul_f32 v195, v195, v35
v_mul_f32 v196, v196, v36
v_mul_f32 v197, v197, v36
v_mul_f32 v198, v198, v36
v_mul_f32 v199, v199, v36
v_mul_f32 v200, v200, v35
v_mul_f32 v201, v201, v35
v_mul_f32 v202, v202, v35
v_mul_f32 v203, v203, v35
v_mul_f32 v204, v204, v36
v_mul_f32 v205, v205, v36
v_mul_f32 v206, v206, v36
v_mul_f32 v207, v207, v36
v_mul_f32 v208, v208, v35
v_mul_f32 v209, v209, v35
v_mul_f32 v210, v210, v35
v_mul_f32 v211, v211, v35
v_mul_f32 v212, v212, v36
v_mul_f32 v213, v213, v36
v_mul_f32 v214, v214, v36
v_mul_f32 v215, v215, v36
v_mul_f32 v216, v216, v35
v_mul_f32 v217, v217, v35
v_mul_f32 v218, v218, v35
v_mul_f32 v219, v219, v35
v_mul_f32 v220, v220, v36
v_mul_f32 v221, v221, v36
v_mul_f32 v222, v222, v36
v_mul_f32 v223, v223, v36
v_mul_f32 v224, v224, v35
v_mul_f32 v225, v225, v35
v_mul_f32 v226, v226, v35
v_mul_f32 v227, v227, v35
v_mul_f32 v228, v228, v36
v_mul_f32 v229, v229, v36
v_mul_f32 v230, v230, v36
v_mul_f32 v231, v231, v36
v_mul_f32 v232, v232, v35
v_mul_f32 v233, v233, v35
v_mul_f32 v234, v234, v35
v_mul_f32 v235, v235, v35
v_mul_f32 v236, v236, v36
v_mul_f32 v237, v237, v36
v_mul_f32 v238, v238, v36
v_mul_f32 v239, v239, v36
v_mul_f32 v240, v240, v35
v_mul_f32 v241, v241, v35
v_mul_f32 v242, v242, v35
v_mul_f32 v243, v243, v35
v_mul_f32 v244, v244, v36
v_mul_f32 v245, v245, v36
v_mul_f32 v246, v246, v36
v_mul_f32 v247, v247, v36
v_mul_f32 v248, v248, v35
v_mul_f32 v249, v249, v35
v_mul_f32 v250, v250, v35
v_mul_f32 v251, v251, v35
v_mul_f32 v252, v252, v36
v_mul_f32 v253, v253, v36
v_mul_f32 v254, v254, v36
v_mul_f32 v255, v255, v36
v_mul_f32 v96, v96, v35
v_mul_f32 v97, v97, v35
v_mul_f32 v98, v98, v35
v_mul_f32 v99, v99, v35
v_mul_f32 v100, v100, v36
v_mul_f32 v101, v101, v36
v_mul_f32 v102, v102, v36
v_mul_f32 v103, v103, v36
s_mov_b32 s51, 0
s_nop 1
s_setpc_b64 s[52:53]
.section .rodata,"a"
.p2align 6
.amdhsa_kernel concat_heads__mha_block_cached__mha_block_cached__near_ridge_kernel
  .amdhsa_next_free_vgpr 512
  .amdhsa_next_free_sgpr 102
  .amdhsa_accum_offset 256
  .amdhsa_group_segment_fixed_size 0
  .amdhsa_kernarg_size 104
  .amdhsa_user_sgpr_count 2
  .amdhsa_user_sgpr_kernarg_segment_ptr 1
  .amdhsa_system_sgpr_workgroup_id_x 1
  .amdhsa_float_denorm_mode_32 3
.end_amdhsa_kernel
```
